```python
import torch

def _softmax(x, axis=-1):
    return torch.softmax(x, dim=axis)
def _gelu(x):
    return torch.nn.functional.gelu(x, approximate="tanh")
def _silu(x):
    return torch.nn.functional.silu(x)
def _sigmoid(x):
    return torch.sigmoid(x)
def _layernorm(x, axis=-1, eps=1e-5):
    m = x.mean(dim=axis, keepdim=True)
    v = x.var(dim=axis, keepdim=True, unbiased=False)
    return (x - m) / torch.sqrt(v + eps)
def _scatter_add(tgt, idx, src, axis=0):
    return tgt.clone().index_add_(axis, idx, src)
def _segment_sum(src, seg, n):
    out = torch.zeros((n,) + src.shape[1:], dtype=src.dtype)
    return out.index_add_(0, seg, src)
def _pad(x, pw):
    flat = tuple(v for pair in reversed(pw) for v in pair)
    return torch.nn.functional.pad(x, flat)

kernel_name = 'recurrent_scan__sliding_block__glu_gated_bilinear__prompt'

def setup_inputs():

    _w = (lambda a: (lambda t: t.to(torch.bfloat16) if t.is_floating_point() else t)(torch.as_tensor(a)))
    def _A_setup():
        B, S, D = 1, 2048, 512
        return {
            "x": _w((lambda *s: torch.randn(*s, dtype=torch.bfloat16) * 0.05)(B, S, D)),
            "wqkv": _w((lambda *s: torch.randn(*s, dtype=torch.bfloat16) * 0.2)(D, 3 * D)),
            "wo": _w((lambda *s: torch.randn(*s, dtype=torch.bfloat16) * 0.2)(D, D)),
        }
    _A_in = _A_setup()

    def _B_setup():
        B, S, D, F = 1, 2048, 512, 1792
        return {
            "x": _w((lambda *s: torch.randn(*s, dtype=torch.bfloat16) * 0.05)(B, S, D)),
            "w_gate": _w((lambda *s: torch.randn(*s, dtype=torch.bfloat16) * 0.1)(D, F) * (D ** -0.5)),
            "w_up": _w((lambda *s: torch.randn(*s, dtype=torch.bfloat16) * 0.1)(D, F) * (D ** -0.5)),
            "w_down": _w((lambda *s: torch.randn(*s, dtype=torch.bfloat16) * 0.1)(F, D) * (F ** -0.5)),
        }
    _B_in = _B_setup()

    return {
        "A_x": _A_in["x"],
        "A_wqkv": _A_in["wqkv"],
        "A_wo": _A_in["wo"],
        "B_x": _B_in["x"],
        "B_w_gate": _B_in["w_gate"],
        "B_w_up": _B_in["w_up"],
        "B_w_down": _B_in["w_down"],
    }

def reference(A_x, A_wqkv, A_wo, B_x, B_w_gate, B_w_up, B_w_down):
    def _A_ref(x, wqkv, wo):
        B, S, D = x.shape
        H = 32; Dh = D // H; W = 256
        qkv = (lambda x, *d: x.permute(*d))((x @ wqkv).reshape(B, S, 3, H, Dh), 2, 0, 3, 1, 4)
        q, k, v = qkv[0], qkv[1], qkv[2]
        scores = torch.einsum("bhqd,bhkd->bhqk", q, k) * (Dh ** -0.5)
        idx = torch.arange(S)
        mask = (idx[:, None] - idx[None, :] >= 0) & (idx[:, None] - idx[None, :] < W)
        scores = torch.where(mask[None, None], scores, -1e9)
        p = _softmax(scores, axis=-1)
        o = torch.einsum("bhqk,bhkd->bhqd", p, v)
        return (lambda x, *d: x.permute(*d))(o, 0, 2, 1, 3).reshape(B, S, D) @ wo

    def _B_ref(x, w_gate, w_up, w_down):
        g = torch.einsum("bsd,df->bsf", x, w_gate)
        u = torch.einsum("bsd,df->bsf", x, w_up)
        h = g * u
        return torch.einsum("bsf,fd->bsd", h, w_down)

    x = A_x
    xn = _layernorm(x, axis=-1)
    s = _A_ref(xn, A_wqkv, A_wo)
    g = _silu(_B_ref(xn, B_w_gate, B_w_up, B_w_down))
    return x + s * g
```

```asm
; @launch grid=(256,1,1) block=(512,1,1) lds=163840
.amdgcn_target "amdgcn-amd-amdhsa--gfx950"
.text
.globl recurrent_scan__sliding_block__glu_gated_bilinear__prompt_kernel
.p2align 8
.type recurrent_scan__sliding_block__glu_gated_bilinear__prompt_kernel,@function
recurrent_scan__sliding_block__glu_gated_bilinear__prompt_kernel:
    s_cmp_ge_u32 s2, 256
    s_cbranch_scc1 L_exit
    s_load_dwordx16 s[4:19], s[0:1], 0
    s_load_dwordx4 s[20:23], s[0:1], 64
    s_setprio 3
    s_getpc_b64 s[76:77]
L_pc:
    v_lshrrev_b32 v50, 6, v0
    v_lshlrev_b32 v1, 7, v0
    v_readfirstlane_b32 s3, v50
    v_min_u32 v1, L_end-L_pc-4, v1
    s_bfe_u32 s91, s2, 0x30003
    s_cmp_lg_u32 s91, s3
    s_cbranch_scc1 L_nct
    global_load_dword v255, v1, s[76:77]
L_nct:
    v_and_b32 v0, 63, v0
    s_and_b32 s91, s2, 7
    s_lshr_b32 s92, s2, 3
    s_and_b32 s93, s2, 1
    s_lshl_b32 s93, s93, 3
    s_and_b32 s94, s92, 7
    s_add_u32 s93, s93, s94
    s_lshr_b32 s96, s92, 3
    s_lshr_b32 s97, s91, 1
    s_lshl_b32 s94, s96, 2
    s_add_u32 s94, s94, s97
    v_lshrrev_b32 v48, 3, v0
    v_and_b32 v49, 7, v0
    v_lshl_add_u32 v51, v50, 3, v48
    v_bfe_u32 v52, v51, 1, 3
    v_xor_b32 v52, v52, v49
    v_lshlrev_b32 v52, 4, v52
    v_lshl_add_u32 v10, v51, 10, v52
    s_xor_b32 s99, s92, s96
    s_and_b32 s99, s99, 1
    s_lshl_b32 s99, s99, 2
    v_lshl_add_u32 v10, s99, 7, v10
    s_mul_i32 s78, s3, 3072
    s_lshl_b32 s79, s3, 11
    s_add_u32 s79, s79, 98304
    s_lshl_b32 s80, s93, 17
    s_add_u32 s81, s80, 64512
    s_mov_b32 s30, 2097152
    s_mov_b32 s31, 0x20000
    s_mov_b32 m0, s79
    s_waitcnt lgkmcnt(0)
    s_mov_b32 s28, s4
    s_mov_b32 s29, s5
    buffer_load_dwordx4 v10, s[28:31], s80 offen lds
    buffer_load_dwordx4 v10, s[28:31], s81 offen offset:1024 lds
    s_and_b32 s66, s3, 1
    s_lshl_b32 s66, s66, 6
    v_and_b32 v52, 2, v48
    v_xor_b32 v52, v52, v49
    v_lshlrev_b32 v52, 4, v52
    v_xor_b32 v52, s66, v52
    s_sub_u32 s100, s94, 4
    s_mul_i32 s95, s100, 11
    s_lshr_b32 s95, s95, 5
    s_lshl_b32 s95, s95, 2
    s_add_u32 s100, s100, s95
    s_lshl_b32 s95, s96, 10
    s_sub_u32 s95, s95, 512
    s_lshl_b32 s97, s97, 7
    s_cmp_lt_u32 s94, 4
    s_cselect_b32 s95, 2048, s95
    s_cselect_b32 s96, s94, s100
    s_cselect_b32 s101, 6, 7
    s_cselect_b32 s98, 256, 0
    s_lshl_b32 s101, s101, 9
    s_xor_b32 s98, s98, s97
    s_add_u32 s95, s95, s98
    s_lshl_b32 s96, s96, 7
    s_add_u32 s97, s97, 128
    s_and_b32 s97, s97, 384
    s_add_u32 s97, s97, 1024
    s_cmp_lt_u32 s94, 4
    s_cselect_b32 s97, s97, s96
    s_sub_u32 s96, s96, 1024
    s_sub_u32 s97, s97, 2048
    v_mul_u32_u24 v11, 3072, v51
    v_add_u32 v11, v11, v52
    v_mul_u32_u24 v12, s101, v51
    v_add_u32 v12, v12, v52
    s_mov_b32 s46, 1837056
    s_mov_b32 s47, 0x20000
    s_mov_b32 s50, 1837056
    s_mov_b32 s51, 0x20000
    s_mov_b32 s54, 1837056
    s_mov_b32 s55, 0x20000
    s_ashr_i32 s49, s96, 31
    s_ashr_i32 s53, s97, 31
    s_mul_i32 s98, s101, s99
    s_lshl_b32 s98, s98, 6
    s_mul_i32 s0, s99, 196608
    s_add_u32 s44, s6, s95
    s_addc_u32 s45, s7, 0
    s_mov_b32 m0, s78
    s_cmp_lt_u32 s94, 4
    buffer_load_dwordx4 v11, s[44:47], s0 offen lds
    s_cselect_b32 s48, s6, s12
    s_cselect_b32 s64, s7, s13
    s_cselect_b32 s52, s6, s14
    s_cselect_b32 s65, s7, s15
    s_add_u32 s48, s48, s96
    s_addc_u32 s49, s49, s64
    buffer_load_dwordx4 v12, s[48:51], s98 offen offset:1024 lds
    s_add_u32 s52, s52, s97
    s_addc_u32 s53, s53, s65
    buffer_load_dwordx4 v12, s[52:55], s98 offen offset:2048 lds
    s_setprio 0
    s_add_u32 s64, s0, 196608
    s_lshl_b32 s1, s101, 6
    s_add_u32 s77, s98, s1
    s_add_u32 m0, s79, 16256
    s_nop 0
    buffer_load_dwordx4 v10, s[28:31], s80 offen offset:128 lds
    s_or_b32 s96, s2, s3
    s_mov_b32 s2, s99
    s_mov_b32 s24, s22
    s_mov_b32 s25, s23
    s_mov_b32 s26, 18874368
    s_mov_b32 s27, 0x20000
    buffer_load_dword v60, off, s[24:27], 0 sc1
    v_mul_u32_u24 v8, 3584, v51
    v_add_u32 v8, v8, v52
    v_lshlrev_b32 v9, 4, v0
    s_lshr_b32 s74, s94, 2
    s_mul_i32 s85, s74, 3
    s_add_u32 s85, s85, s94
    s_add_u32 s85, s85, 3
    s_lshl_b32 s74, s85, 7
    s_sub_u32 s75, s74, 1024
    s_add_u32 s56, s12, s74
    s_addc_u32 s57, s13, 0
    s_mov_b32 s58, 1837056
    s_mov_b32 s59, 0x20000
    s_ashr_i32 s61, s75, 31
    s_add_u32 s60, s14, s75
    s_addc_u32 s61, s61, s15
    s_mov_b32 s62, 1837056
    s_mov_b32 s63, 0x20000
    s_mov_b64 s[36:37], s[8:9]
    s_mov_b64 s[32:33], s[16:17]
    s_mov_b64 s[40:41], s[18:19]
    s_mov_b32 s4, s3
    s_mov_b32 s12, s96
    s_lshl_b32 s7, s94, 3
    s_add_u32 s7, s7, s4
    s_lshl_b32 s8, s93, 7
    s_add_u32 s7, s7, s8
    s_lshl_b32 s87, s7, 4
    s_add_u32 s87, s87, 65536
    s_lshl_b32 s11, s7, 10
    v_and_b32 v53, 1, v50
    v_bfe_u32 v57, v0, 3, 1
    v_lshl_add_u32 v53, v53, 2, v57
    v_bfe_u32 v54, v50, 1, 1
    v_lshl_add_u32 v53, v53, 1, v54
    v_lshl_add_u32 v53, v53, 3, v49
    v_bfe_u32 v55, v0, 1, 3
    v_lshrrev_b32 v58, 4, v0
    v_xor_b32 v55, v55, v58
    v_lshlrev_b32 v55, 4, v55
    v_lshrrev_b32 v54, 5, v0
    v_lshl_add_u32 v53, v53, 7, v55
    v_add_u32 v1, 98304, v53
    v_xor_b32 v2, 64, v1
    v_lshrrev_b32 v56, 2, v50
    v_xor_b32 v56, v56, v58
    v_and_b32 v56, 1, v56
    v_lshl_add_u32 v55, v56, 1, v57
    v_and_b32 v56, 3, v0
    v_lshl_add_u32 v55, v55, 2, v56
    v_bfe_u32 v53, v0, 2, 2
    v_lshlrev_b32 v55, 3, v55
    v_lshl_add_u32 v55, v53, 7, v55
    v_mul_u32_u24 v56, 3072, v58
    v_add_u32 v5, v55, v56
    v_xor_b32 v6, 32, v5
    v_add_u32 v3, 49152, v5
    v_add_u32 v4, 49152, v6
    s_cmp_lt_u32 s94, 4
    s_cselect_b32 s18, 0, 1
    s_cmp_ge_u32 s94, 12
    s_cselect_b32 s18, 2, s18
    buffer_load_dwordx4 v10, s[28:31], s81 offen offset:1152 lds
    s_add_u32 m0, s78, 24576
    s_nop 0
    buffer_load_dwordx4 v11, s[44:47], s64 offen lds
    buffer_load_dwordx4 v12, s[48:51], s77 offen offset:1024 lds
    buffer_load_dwordx4 v12, s[52:55], s77 offen offset:2048 lds
    buffer_load_dwordx4 v[48:51], v9, s[28:31], s11 offen
    s_mul_i32 s1, s2, 229376
    s_add_u32 s65, s0, 393216
    s_add_u32 s72, s1, 458752
    s_cmp_eq_u32 s18, 0
    s_cbranch_scc1 L_V_Q
    s_cmp_eq_u32 s18, 2
    s_cbranch_scc1 L_V_PV
    s_waitcnt vmcnt(7)
    s_barrier
    ds_read_b128 v[128:131], v1 offset:0
    ds_read_b64_tr_b16 v[28:29], v5 offset:0
    ds_read_b64_tr_b16 v[30:31], v5 offset:512
    ds_read_b128 v[132:135], v1 offset:4096
    ds_read_b64_tr_b16 v[32:33], v6 offset:0
    ds_read_b64_tr_b16 v[34:35], v6 offset:512
    ds_read_b128 v[136:139], v2 offset:0
    ds_read_b64_tr_b16 v[36:37], v5 offset:1024
    ds_read_b64_tr_b16 v[38:39], v5 offset:1536
    ds_read_b128 v[140:143], v2 offset:4096
    ds_read_b64_tr_b16 v[40:41], v6 offset:1024
    ds_read_b64_tr_b16 v[42:43], v6 offset:1536
    s_waitcnt lgkmcnt(6)
    v_mfma_f32_16x16x32_bf16 v[80:83], v[28:31], v[128:131], 0
    s_add_u32 m0, s78, 49152
    ds_read_b64_tr_b16 v[44:45], v5 offset:2048
    ds_read_b64_tr_b16 v[46:47], v5 offset:2560
    v_mfma_f32_16x16x32_bf16 v[88:91], v[28:31], v[132:135], 0
    buffer_load_dwordx4 v11, s[44:47], s65 offen lds
    s_add_u32 s66, s0, 589824
    s_cmp_ge_u32 s93, 5
    s_cselect_b32 s82, 1, 0
    s_mul_i32 s86, s82, 5
    s_sub_u32 s83, s93, s86
    v_mfma_f32_16x16x32_bf16 v[84:87], v[32:35], v[128:131], 0
    ds_read_b64_tr_b16 v[28:29], v6 offset:2048
    ds_read_b64_tr_b16 v[30:31], v6 offset:2560
    v_mfma_f32_16x16x32_bf16 v[92:95], v[32:35], v[132:135], 0
    buffer_load_dwordx4 v8, s[48:51], s72 offen offset:1024 lds
    s_add_u32 s73, s1, 688128
    s_sub_u32 s67, 786432, s0
    s_cmp_lt_u32 s94, 4
    s_cselect_b32 s86, 3, 1
    s_cmp_lt_u32 s83, s86
    s_cselect_b32 s9, 6, 7
    s_lshl_b32 s9, s9, 9
    s_waitcnt lgkmcnt(4)
    v_mfma_f32_16x16x32_bf16 v[96:99], v[36:39], v[128:131], 0
    ds_read_b64_tr_b16 v[32:33], v5 offset:12288
    ds_read_b64_tr_b16 v[34:35], v5 offset:12800
    v_mfma_f32_16x16x32_bf16 v[112:115], v[36:39], v[132:135], 0
    buffer_load_dwordx4 v8, s[52:55], s72 offen offset:2048 lds
    s_sub_u32 s74, 917504, s1
    s_add_u32 s68, s67, 196608
    s_lshl_b32 s86, s4, 5
    v_lshrrev_b32 v27, 3, v0
    v_add_u32 v25, s86, v27
    v_and_b32 v26, 7, v0
    v_mul_u32_u24 v25, s9, v25
    v_mfma_f32_16x16x32_bf16 v[100:103], v[40:43], v[128:131], 0
    s_add_u32 m0, s79, 32512
    ds_read_b64_tr_b16 v[36:37], v6 offset:12288
    ds_read_b64_tr_b16 v[38:39], v6 offset:12800
    v_mfma_f32_16x16x32_bf16 v[116:119], v[40:43], v[132:135], 0
    buffer_load_dwordx4 v10, s[28:31], s80 offen offset:256 lds
    s_add_u32 s75, s74, 229376
    v_lshl_add_u32 v25, v26, 4, v25
    s_cmp_ge_u32 s93, 10
    s_cselect_b32 s84, 2146435072, 0
    v_or_b32 v25, s84, v25
    s_mov_b64 s[20:21], s[44:45]
    s_waitcnt lgkmcnt(4)
    v_mfma_f32_16x16x32_bf16 v[104:107], v[44:47], v[128:131], 0
    ds_read_b64_tr_b16 v[40:41], v5 offset:13312
    ds_read_b64_tr_b16 v[42:43], v5 offset:13824
    v_mfma_f32_16x16x32_bf16 v[120:123], v[44:47], v[132:135], 0
    buffer_load_dwordx4 v10, s[28:31], s81 offen offset:1280 lds
    s_add_u32 s69, s67, 393216
    s_add_u32 s76, s74, 458752
    s_mov_b32 s22, 1837056
    s_mov_b32 s23, 0x20000
    s_cmp_eq_u32 s83, 1
    s_cselect_b64 s[20:21], s[48:49], s[20:21]
    v_mfma_f32_16x16x32_bf16 v[108:111], v[28:31], v[128:131], 0
    ds_read_b64_tr_b16 v[44:45], v6 offset:13312
    ds_read_b64_tr_b16 v[46:47], v6 offset:13824
    v_mfma_f32_16x16x32_bf16 v[124:127], v[28:31], v[132:135], 0
    s_add_u32 s70, s67, 589824
    s_add_u32 s77, s74, 688128
    s_add_u32 s71, s1, 229376
    s_cmp_eq_u32 s83, 2
    s_cselect_b64 s[20:21], s[52:53], s[20:21]
    s_cmp_eq_u32 s83, 3
    s_cselect_b64 s[20:21], s[56:57], s[20:21]
    s_waitcnt lgkmcnt(4)
    v_mfma_f32_16x16x32_bf16 v[80:83], v[32:35], v[136:139], v[80:83]
    s_waitcnt vmcnt(6)
    s_barrier
    ds_read_b64_tr_b16 v[28:29], v5 offset:14336
    ds_read_b64_tr_b16 v[30:31], v5 offset:14848
    v_mfma_f32_16x16x32_bf16 v[88:91], v[32:35], v[140:143], v[88:91]
    s_cmp_eq_u32 s83, 4
    s_cselect_b64 s[20:21], s[60:61], s[20:21]
    s_cmp_ge_u32 s83, 3
    s_cselect_b32 s11, 3, 0
    s_sub_u32 s11, s83, s11
    s_lshl_b32 s11, s11, 10
    v_mfma_f32_16x16x32_bf16 v[84:87], v[36:39], v[136:139], v[84:87]
    ds_read_b64_tr_b16 v[32:33], v6 offset:14336
    ds_read_b64_tr_b16 v[34:35], v6 offset:14848
    v_mfma_f32_16x16x32_bf16 v[92:95], v[36:39], v[140:143], v[92:95]
    ds_read_b128 v[144:147], v1 offset:16384
    s_mul_i32 s86, s9, s82
    s_lshl_b32 s86, s86, 8
    s_add_u32 s11, s11, s86
    s_lshl_b32 s9, s9, 3
    s_mul_i32 s88, s94, 5
    s_add_u32 s88, s88, s83
    s_lshl_b32 s88, s88, 9
    s_waitcnt lgkmcnt(5)
    v_mfma_f32_16x16x32_bf16 v[96:99], v[40:43], v[136:139], v[96:99]
    ds_read_b64_tr_b16 v[36:37], v5 offset:24576
    ds_read_b64_tr_b16 v[38:39], v5 offset:25088
    v_mfma_f32_16x16x32_bf16 v[112:115], v[40:43], v[140:143], v[112:115]
    ds_read_b128 v[148:151], v1 offset:20480
    buffer_load_dwordx4 v[64:67], v25, s[20:23], s11 offen
    s_add_u32 s11, s11, s9
    s_mul_i32 s86, s82, 40960
    s_add_u32 s88, s88, s86
    s_add_u32 s88, s88, 131072
    v_and_b32 v23, 1, v27
    v_lshl_add_u32 v22, v26, 1, v23
    v_mfma_f32_16x16x32_bf16 v[100:103], v[44:47], v[136:139], v[100:103]
    ds_read_b64_tr_b16 v[40:41], v6 offset:24576
    ds_read_b64_tr_b16 v[42:43], v6 offset:25088
    v_mfma_f32_16x16x32_bf16 v[116:119], v[44:47], v[140:143], v[116:119]
    ds_read_b128 v[152:155], v2 offset:16384
    buffer_load_dwordx4 v[68:71], v25, s[20:23], s11 offen
    s_add_u32 s11, s11, s9
    v_mov_b32 v56, 0x3f803f80
    v_mov_b32 v57, 0x3f803f80
    v_bfe_u32 v23, v0, 4, 1
    v_lshl_add_u32 v22, v22, 1, v23
    v_lshrrev_b32 v23, 5, v0
    s_waitcnt lgkmcnt(7)
    v_mfma_f32_16x16x32_bf16 v[104:107], v[28:31], v[136:139], v[104:107]
    ds_read_b64_tr_b16 v[44:45], v5 offset:25600
    ds_read_b64_tr_b16 v[46:47], v5 offset:26112
    v_mfma_f32_16x16x32_bf16 v[120:123], v[28:31], v[140:143], v[120:123]
    ds_read_b128 v[156:159], v2 offset:20480
    buffer_load_dwordx4 v[72:75], v25, s[20:23], s11 offen
    s_add_u32 s11, s11, s9
    s_waitcnt vmcnt(8)
    v_readfirstlane_b32 s5, v60
    v_lshl_add_u32 v22, v22, 1, v23
    s_lshl_b32 s86, s4, 8
    s_add_u32 s86, s86, 147456
    v_lshl_add_u32 v22, v22, 2, s86
    v_mfma_f32_16x16x32_bf16 v[108:111], v[32:35], v[136:139], v[108:111]
    ds_read_b64_tr_b16 v[28:29], v6 offset:25600
    ds_read_b64_tr_b16 v[30:31], v6 offset:26112
    v_mfma_f32_16x16x32_bf16 v[124:127], v[32:35], v[140:143], v[124:127]
    buffer_load_dwordx4 v[76:79], v25, s[20:23], s11 offen
    s_mov_b32 s20, 0x0000ffff
    s_mov_b32 s21, 0x0000ffff
    v_mfma_f32_4x4x4_16b_bf16 v[52:55], v[56:57], v[48:49], 0
    s_mul_i32 s5, s5, 0x9E3779B1
    s_lshl_b32 s86, s4, 3
    v_add_u32 v26, s86, v26
    v_lshlrev_b32 v24, 3, v26
    v_lshl_add_u32 v24, v27, 28, v24
    s_waitcnt lgkmcnt(6)
    v_mfma_f32_16x16x32_bf16 v[80:83], v[36:39], v[144:147], v[80:83]
    ds_read_b64_tr_b16 v[32:33], v5 offset:26624
    ds_read_b64_tr_b16 v[34:35], v5 offset:27136
    v_mfma_f32_16x16x32_bf16 v[88:91], v[36:39], v[148:151], v[88:91]
    v_and_b32 v20, 0x30, v9
    s_mov_b64 vcc, 0x3f80
    v_lshlrev_b64 v[20:21], v20, vcc
    v_or_b32 v24, s84, v24
    v_lshlrev_b32 v27, 8, v27
    v_lshl_add_u32 v23, v26, 2, v27
    v_add_u32 v23, 147456, v23
    s_lshl_b32 s8, s91, 2
    s_lshr_b32 s3, s92, 3
    s_add_u32 s8, s8, s3
    v_mfma_f32_16x16x32_bf16 v[84:87], v[40:43], v[144:147], v[84:87]
    s_add_u32 m0, s78, 73728
    ds_read_b64_tr_b16 v[36:37], v6 offset:26624
    ds_read_b64_tr_b16 v[38:39], v6 offset:27136
    v_mfma_f32_16x16x32_bf16 v[92:95], v[40:43], v[148:151], v[92:95]
    buffer_load_dwordx4 v11, s[44:47], s66 offen lds
    v_mfma_f32_4x4x4_16b_bf16 v[52:55], v[56:57], v[50:51], v[52:55]
    s_add_u32 s5, s5, 0x7F4A7C15
    s_lshl_b32 s8, s8, 1
    s_lshr_b32 s19, s4, 2
    s_add_u32 s8, s8, s19
    s_and_b32 s9, s92, 7
    s_lshl_b32 s9, s9, 7
    s_lshl_b32 s11, s19, 15
    s_waitcnt lgkmcnt(4)
    v_mfma_f32_16x16x32_bf16 v[96:99], v[44:47], v[144:147], v[96:99]
    ds_read_b64_tr_b16 v[40:41], v5 offset:36864
    ds_read_b64_tr_b16 v[42:43], v5 offset:37376
    v_mfma_f32_16x16x32_bf16 v[112:115], v[44:47], v[148:151], v[112:115]
    v_add_f32_dpp v52, v52, v52 row_ror:1 row_mask:0xf bank_mask:0xf
    s_nop 1
    v_add_f32_dpp v52, v52, v52 row_ror:2 row_mask:0xf bank_mask:0xf
    s_add_u32 s11, s11, s9
    s_and_b32 s16, s4, 3
    s_lshl_b32 s22, s16, 17
    s_add_u32 s22, s22, s11
    s_add_u32 s36, s36, s22
    s_addc_u32 s37, s37, 0
    s_sub_u32 s38, 524288, s22
    s_mov_b32 s39, 0x20000
    v_mfma_f32_16x16x32_bf16 v[100:103], v[28:31], v[144:147], v[100:103]
    ds_read_b64_tr_b16 v[44:45], v6 offset:36864
    ds_read_b64_tr_b16 v[46:47], v6 offset:37376
    v_mfma_f32_16x16x32_bf16 v[116:119], v[28:31], v[148:151], v[116:119]
    buffer_load_dwordx4 v8, s[48:51], s73 offen offset:1024 lds
    v_add_f32_dpp v52, v52, v52 row_ror:4 row_mask:0xf bank_mask:0xf
    s_nop 1
    v_add_f32_dpp v52, v52, v52 row_ror:8 row_mask:0xf bank_mask:0xf
    s_mul_i32 s22, s16, 458752
    s_add_u32 s22, s22, s11
    s_add_u32 s32, s32, s22
    s_addc_u32 s33, s33, 0
    s_sub_u32 s34, 1835008, s22
    s_mov_b32 s35, 0x20000
    s_lshl_b32 s6, s16, 13
    s_waitcnt lgkmcnt(4)
    v_mfma_f32_16x16x32_bf16 v[104:107], v[32:35], v[144:147], v[104:107]
    ds_read_b64_tr_b16 v[28:29], v5 offset:37888
    ds_read_b64_tr_b16 v[30:31], v5 offset:38400
    v_mfma_f32_16x16x32_bf16 v[120:123], v[32:35], v[148:151], v[120:123]
    v_mov_b32 v56, v52
    s_nop 1
    v_permlane16_swap_b32 v52, v56
    v_add_f32 v52, v52, v56
    s_lshl_b32 s3, s19, 12
    s_add_u32 s6, s6, s3
    s_mul_i32 s17, s8, 147456
    s_mul_i32 s3, s16, 28672
    s_add_u32 s17, s17, s3
    s_add_u32 s17, s17, 7340032
    s_lshl_b32 s14, s8, 14
    v_mfma_f32_16x16x32_bf16 v[108:111], v[36:39], v[144:147], v[108:111]
    ds_read_b64_tr_b16 v[32:33], v6 offset:37888
    ds_read_b64_tr_b16 v[34:35], v6 offset:38400
    v_mfma_f32_16x16x32_bf16 v[124:127], v[36:39], v[148:151], v[124:127]
    buffer_load_dwordx4 v8, s[52:55], s73 offen offset:2048 lds
    v_mov_b32 v56, v52
    s_nop 1
    v_permlane32_swap_b32 v52, v56
    v_add_f32 v52, v52, v56
    v_mul_f32 v60, 0xbb000000, v52
    s_add_u32 s14, s14, 16782336
    s_lshl_b32 s15, s8, 2
    s_add_u32 s15, s15, s16
    s_lshl_b32 s15, s15, 10
    s_add_u32 s15, s15, 17825792
    s_waitcnt lgkmcnt(4)
    v_mfma_f32_16x16x32_bf16 v[80:83], v[40:43], v[152:155], v[80:83]
    s_waitcnt vmcnt(7)
    s_barrier
    ds_read_b64_tr_b16 v[36:37], v5 offset:38912
    ds_read_b64_tr_b16 v[38:39], v5 offset:39424
    v_mfma_f32_16x16x32_bf16 v[88:91], v[40:43], v[156:159], v[88:91]
    v_mul_f32 v61, 0xbb000000, v52
    v_mov_b64 v[62:63], v[60:61]
    s_lshr_b32 s3, s8, 1
    s_lshl_b32 s3, s3, 3
    s_add_u32 s3, s3, s4
    s_lshl_b32 s13, s3, 13
    s_add_u32 s13, s13, s9
    s_lshl_b32 s23, s3, 7
    v_mfma_f32_16x16x32_bf16 v[84:87], v[44:47], v[152:155], v[84:87]
    s_add_u32 m0, s79, -384
    ds_read_b64_tr_b16 v[40:41], v6 offset:38912
    ds_read_b64_tr_b16 v[42:43], v6 offset:39424
    v_mfma_f32_16x16x32_bf16 v[92:95], v[44:47], v[156:159], v[92:95]
    buffer_load_dwordx4 v10, s[28:31], s80 offen offset:384 lds
    ds_read_b128 v[160:163], v1 offset:32768
    v_mfma_f32_4x4x4_16b_bf16 v[52:55], v[20:21], v[48:49], v[60:63]
    v_mfma_f32_4x4x4_16b_bf16 v[56:59], v[20:21], v[50:51], v[60:63]
    s_waitcnt vmcnt(4)
    v_mfma_f32_4x4x4_16b_bf16 v[12:15], v[20:21], v[64:65], 0
    v_mfma_f32_4x4x4_16b_bf16 v[16:19], v[20:21], v[66:67], 0
    s_add_u32 s23, s23, 65544
    s_lshl_b32 s8, s93, 2
    s_add_u32 s8, s8, s16
    s_waitcnt lgkmcnt(5)
    v_mfma_f32_16x16x32_bf16 v[96:99], v[28:31], v[152:155], v[96:99]
    ds_read_b64_tr_b16 v[44:45], v3 offset:0
    ds_read_b64_tr_b16 v[46:47], v3 offset:512
    v_mfma_f32_16x16x32_bf16 v[112:115], v[28:31], v[156:159], v[112:115]
    ds_read_b128 v[164:167], v1 offset:36864
    v_mul_f32 v50, v52, v52
    v_mul_f32 v51, v53, v53
    v_fmac_f32 v50, v54, v54
    v_fmac_f32 v51, v55, v55
    v_mfma_f32_4x4x4_16b_bf16 v[12:15], v[20:21], v[68:69], v[12:15]
    v_mfma_f32_4x4x4_16b_bf16 v[16:19], v[20:21], v[70:71], v[16:19]
    s_lshl_b32 s89, s8, 9
    s_add_u32 s89, s89, 65536
    s_mul_i32 s90, s94, 2560
    v_mfma_f32_16x16x32_bf16 v[100:103], v[32:35], v[152:155], v[100:103]
    ds_read_b64_tr_b16 v[28:29], v4 offset:0
    ds_read_b64_tr_b16 v[30:31], v4 offset:512
    v_mfma_f32_16x16x32_bf16 v[116:119], v[32:35], v[156:159], v[116:119]
    buffer_load_dwordx4 v10, s[28:31], s81 offen offset:1408 lds
    ds_read_b128 v[168:171], v2 offset:32768
    v_fmac_f32 v50, v56, v56
    v_fmac_f32 v51, v57, v57
    v_fmac_f32 v50, v58, v58
    v_mfma_f32_4x4x4_16b_bf16 v[12:15], v[20:21], v[72:73], v[12:15]
    v_mfma_f32_4x4x4_16b_bf16 v[16:19], v[20:21], v[74:75], v[16:19]
    s_lshl_b32 s9, s19, 8
    s_add_u32 s90, s90, s9
    s_add_u32 s90, s90, 131072
    s_waitcnt lgkmcnt(7)
    v_mfma_f32_16x16x32_bf16 v[104:107], v[36:39], v[152:155], v[104:107]
    ds_read_b64_tr_b16 v[32:33], v3 offset:1024
    ds_read_b64_tr_b16 v[34:35], v3 offset:1536
    v_mfma_f32_16x16x32_bf16 v[120:123], v[36:39], v[156:159], v[120:123]
    ds_read_b128 v[172:175], v2 offset:36864
    v_fmac_f32 v51, v59, v59
    v_add_f32 v50, v50, v51
    v_mfma_f32_4x4x4_16b_bf16 v[12:15], v[20:21], v[76:77], v[12:15]
    v_mfma_f32_4x4x4_16b_bf16 v[16:19], v[20:21], v[78:79], v[16:19]
    s_bfe_u32 s9, s95, 0x30007
    s_lshl_b32 s9, s9, 1
    s_add_u32 s9, s9, s19
    s_lshl_b32 s9, s9, 17
    s_lshl_b32 s11, s8, 11
    v_mfma_f32_16x16x32_bf16 v[108:111], v[40:43], v[152:155], v[108:111]
    s_mov_b32 m0, s78
    ds_read_b64_tr_b16 v[36:37], v4 offset:1024
    ds_read_b64_tr_b16 v[38:39], v4 offset:1536
    v_mfma_f32_16x16x32_bf16 v[124:127], v[40:43], v[156:159], v[124:127]
    buffer_load_dwordx4 v11, s[44:47], s67 offen lds
    v_add_f32_dpp v50, v50, v50 row_ror:1 row_mask:0xf bank_mask:0xf
    s_nop 1
    v_add_f32_dpp v50, v50, v50 row_ror:2 row_mask:0xf bank_mask:0xf
    v_and_b32 v64, 8, v0
    s_add_u32 s9, s9, s11
    s_lshr_b32 s11, s95, 10
    s_lshl_b32 s11, s11, 21
    s_add_u32 s82, s9, s11
    s_add_u32 s82, s82, 1048576
    s_waitcnt lgkmcnt(6)
    v_mfma_f32_16x16x32_bf16 v[80:83], v[44:47], v[160:163], v[80:83]
    ds_read_b64_tr_b16 v[40:41], v3 offset:2048
    ds_read_b64_tr_b16 v[42:43], v3 offset:2560
    v_mfma_f32_16x16x32_bf16 v[88:91], v[44:47], v[164:167], v[88:91]
    v_add_f32_dpp v50, v50, v50 row_ror:4 row_mask:0xf bank_mask:0xf
    s_nop 1
    v_add_f32_dpp v50, v50, v50 row_ror:8 row_mask:0xf bank_mask:0xf
    v_permlane32_swap_b32 v12, v13
    v_permlane32_swap_b32 v14, v15
    v_permlane32_swap_b32 v16, v17
    v_permlane32_swap_b32 v18, v19
    v_add_f32 v12, v12, v13
    v_add_f32 v14, v14, v15
    s_add_u32 s84, s9, 786432
    s_and_b32 s84, s84, 1048575
    v_mfma_f32_16x16x32_bf16 v[84:87], v[28:31], v[160:163], v[84:87]
    ds_read_b64_tr_b16 v[44:45], v4 offset:2048
    ds_read_b64_tr_b16 v[46:47], v4 offset:2560
    v_mfma_f32_16x16x32_bf16 v[92:95], v[28:31], v[164:167], v[92:95]
    buffer_load_dwordx4 v8, s[48:51], s74 offen offset:1024 lds
    v_mov_b32 v49, v50
    s_nop 1
    v_permlane16_swap_b32 v50, v49
    v_add_f32 v50, v50, v49
    v_add_f32 v16, v16, v17
    v_add_f32 v18, v18, v19
    v_cmp_eq_u32 vcc, 0, v64
    s_add_u32 s84, s84, 3145728
    s_xor_b32 s9, s9, 524288
    s_add_u32 s9, s9, 1048576
    s_waitcnt lgkmcnt(4)
    v_mfma_f32_16x16x32_bf16 v[96:99], v[32:35], v[160:163], v[96:99]
    ds_read_b64_tr_b16 v[28:29], v3 offset:12288
    ds_read_b64_tr_b16 v[30:31], v3 offset:12800
    v_mfma_f32_16x16x32_bf16 v[112:115], v[32:35], v[164:167], v[112:115]
    v_mov_b32 v49, v50
    s_nop 1
    v_permlane32_swap_b32 v50, v49
    v_add_f32 v50, v50, v49
    v_mov_b32 v49, 0x3727c5ac
    v_fmac_f32 v49, 0x3b000000, v50
    v_permlane16_swap_b32 v12, v14
    v_permlane16_swap_b32 v16, v18
    v_add_f32 v12, v12, v14
    s_mul_i32 s11, s8, 147456
    s_lshl_b32 s22, s19, 11
    v_mfma_f32_16x16x32_bf16 v[100:103], v[36:39], v[160:163], v[100:103]
    ds_read_b64_tr_b16 v[32:33], v4 offset:12288
    ds_read_b64_tr_b16 v[34:35], v4 offset:12800
    v_mfma_f32_16x16x32_bf16 v[116:119], v[36:39], v[164:167], v[116:119]
    buffer_load_dwordx4 v8, s[52:55], s74 offen offset:2048 lds
    v_rsq_f32 v54, v49
    v_mov_b32 v52, v60
    v_mov_b32 v53, s5
    v_mov_b32 v55, s5
    v_add_f32 v16, v16, v18
    s_add_u32 s11, s11, s22
    s_add_u32 s11, s11, 7340032
    s_lshl_b32 s85, s85, 12
    s_add_u32 s85, s85, s11
    s_waitcnt lgkmcnt(4)
    v_mfma_f32_16x16x32_bf16 v[104:107], v[40:43], v[160:163], v[104:107]
    ds_read_b64_tr_b16 v[36:37], v3 offset:13312
    ds_read_b64_tr_b16 v[38:39], v3 offset:13824
    v_mfma_f32_16x16x32_bf16 v[120:123], v[40:43], v[164:167], v[120:123]
    s_cmp_eq_u32 s2, 4
    s_cselect_b32 s7, 1024, 0
    v_subrev_u32 v10, s7, v10
    v_add_f32_dpp v12, v12, v12 row_ror:8 row_mask:0xf bank_mask:0xf
    v_add_f32_dpp v16, v16, v16 row_ror:8 row_mask:0xf bank_mask:0xf
    v_cndmask_b32 v12, v16, v12, vcc
    ds_write_b32 v22, v12
    s_lshl_b32 s100, s100, 12
    s_add_u32 s11, s11, s100
    v_mfma_f32_16x16x32_bf16 v[108:111], v[44:47], v[160:163], v[108:111]
    s_add_u32 m0, s79, 15872
    ds_read_b64_tr_b16 v[40:41], v4 offset:13312
    ds_read_b64_tr_b16 v[42:43], v4 offset:13824
    v_mfma_f32_16x16x32_bf16 v[124:127], v[44:47], v[164:167], v[124:127]
    buffer_load_dwordx4 v10, s[28:31], s80 offen offset:512 lds
    s_mov_b64 exec, 1
    buffer_store_dwordx4 v[52:55], off, s[24:27], s87 sc1
    s_mov_b64 exec, -1
    s_cmp_lt_u32 s94, 4
    s_cselect_b32 s83, s9, s11
    s_lshl_b32 s86, s8, 7
    s_lshl_b32 s9, s94, 1
    s_add_u32 s9, s9, s19
    s_waitcnt lgkmcnt(5)
    v_mfma_f32_16x16x32_bf16 v[80:83], v[28:31], v[168:171], v[80:83]
    s_waitcnt vmcnt(5) lgkmcnt(2)
    s_barrier
    ds_read_b64_tr_b16 v[44:45], v3 offset:14336
    ds_read_b64_tr_b16 v[46:47], v3 offset:14848
    v_mfma_f32_16x16x32_bf16 v[88:91], v[28:31], v[172:175], v[88:91]
    ds_read_b32 v12, v23
    s_add_u32 s86, s86, s9
    s_lshl_b32 s86, s86, 7
    s_add_u32 s86, s86, 16777216
    v_mfma_f32_16x16x32_bf16 v[84:87], v[32:35], v[168:171], v[84:87]
    ds_read_b64_tr_b16 v[28:29], v4 offset:14336
    ds_read_b64_tr_b16 v[30:31], v4 offset:14848
    v_mfma_f32_16x16x32_bf16 v[92:95], v[32:35], v[172:175], v[92:95]
    buffer_load_dwordx4 v10, s[28:31], s81 offen offset:1536 lds
    ds_read_b128 v[176:179], v1 offset:0
    s_and_b32 s8, s92, 3
    s_waitcnt lgkmcnt(6)
    v_mfma_f32_16x16x32_bf16 v[96:99], v[36:39], v[168:171], v[96:99]
    ds_read_b64_tr_b16 v[32:33], v3 offset:24576
    ds_read_b64_tr_b16 v[34:35], v3 offset:25088
    v_mfma_f32_16x16x32_bf16 v[112:115], v[36:39], v[172:175], v[112:115]
    ds_read_b128 v[180:183], v1 offset:4096
    s_lshl_b32 s22, s91, 2
    s_add_u32 s8, s8, s22
    v_mfma_f32_16x16x32_bf16 v[100:103], v[40:43], v[168:171], v[100:103]
    s_add_u32 m0, s78, 24576
    ds_read_b64_tr_b16 v[36:37], v4 offset:24576
    ds_read_b64_tr_b16 v[38:39], v4 offset:25088
    v_mfma_f32_16x16x32_bf16 v[116:119], v[40:43], v[172:175], v[116:119]
    buffer_load_dwordx4 v11, s[44:47], s68 offen lds
    ds_read_b128 v[184:187], v2 offset:0
    s_waitcnt lgkmcnt(9)
    v_mov_b32 v13, v12
    s_waitcnt lgkmcnt(7)
    v_mfma_f32_16x16x32_bf16 v[104:107], v[44:47], v[168:171], v[104:107]
    ds_read_b64_tr_b16 v[40:41], v3 offset:25600
    ds_read_b64_tr_b16 v[42:43], v3 offset:26112
    v_mfma_f32_16x16x32_bf16 v[120:123], v[44:47], v[172:175], v[120:123]
    ds_read_b128 v[188:191], v2 offset:4096
    v_permlane32_swap_b32 v12, v13
    v_add_f32 v12, v12, v13
    v_mov_b32 v13, v12
    v_mfma_f32_16x16x32_bf16 v[108:111], v[28:31], v[168:171], v[108:111]
    ds_read_b64_tr_b16 v[44:45], v4 offset:25600
    ds_read_b64_tr_b16 v[46:47], v4 offset:26112
    v_mfma_f32_16x16x32_bf16 v[124:127], v[28:31], v[172:175], v[124:127]
    buffer_load_dwordx4 v8, s[48:51], s75 offen offset:1024 lds
    v_permlane16_swap_b32 v12, v13
    v_add_f32 v12, v12, v13
    v_mov_b32 v15, s5
    s_waitcnt lgkmcnt(6)
    v_mfma_f32_16x16x32_bf16 v[80:83], v[32:35], v[176:179], v[80:83]
    ds_read_b64_tr_b16 v[28:29], v3 offset:26624
    ds_read_b64_tr_b16 v[30:31], v3 offset:27136
    v_mfma_f32_16x16x32_bf16 v[88:91], v[32:35], v[180:183], v[88:91]
    v_add_f32_dpp v14, v12, v12 row_ror:8 row_mask:0xf bank_mask:0xf
    buffer_store_dwordx2 v[14:15], v24, s[24:27], s88 offen sc1
    v_mfma_f32_16x16x32_bf16 v[84:87], v[36:39], v[176:179], v[84:87]
    ds_read_b64_tr_b16 v[32:33], v4 offset:26624
    ds_read_b64_tr_b16 v[34:35], v4 offset:27136
    v_mfma_f32_16x16x32_bf16 v[92:95], v[36:39], v[180:183], v[92:95]
    buffer_load_dwordx4 v8, s[52:55], s75 offen offset:2048 lds
    v_and_b32 v49, 31, v0
    v_lshlrev_b32 v49, 3, v49
    s_waitcnt lgkmcnt(4)
    v_mfma_f32_16x16x32_bf16 v[96:99], v[40:43], v[176:179], v[96:99]
    ds_read_b64_tr_b16 v[36:37], v3 offset:36864
    ds_read_b64_tr_b16 v[38:39], v3 offset:37376
    v_mfma_f32_16x16x32_bf16 v[112:115], v[40:43], v[180:183], v[112:115]
    v_and_b32 v48, 0xf0, v9
    v_lshrrev_b32 v50, 5, v0
    v_lshl_add_u32 v48, v50, 8, v48
    v_mfma_f32_16x16x32_bf16 v[100:103], v[44:47], v[176:179], v[100:103]
    s_add_u32 m0, s79, 32128
    ds_read_b64_tr_b16 v[40:41], v4 offset:36864
    ds_read_b64_tr_b16 v[42:43], v4 offset:37376
    v_mfma_f32_16x16x32_bf16 v[116:119], v[44:47], v[180:183], v[116:119]
    buffer_load_dwordx4 v10, s[28:31], s80 offen offset:640 lds
    v_mul_u32_u24 v50, 40960, v50
    s_waitcnt lgkmcnt(4)
    v_mfma_f32_16x16x32_bf16 v[104:107], v[28:31], v[176:179], v[104:107]
    ds_read_b64_tr_b16 v[44:45], v3 offset:37888
    ds_read_b64_tr_b16 v[46:47], v3 offset:38400
    v_mfma_f32_16x16x32_bf16 v[120:123], v[28:31], v[180:183], v[120:123]
    v_add_u32 v49, v49, v50
    v_lshrrev_b32 v51, 4, v0
    v_lshlrev_b32 v51, 10, v51
    v_mfma_f32_16x16x32_bf16 v[108:111], v[32:35], v[176:179], v[108:111]
    ds_read_b64_tr_b16 v[28:29], v4 offset:37888
    ds_read_b64_tr_b16 v[30:31], v4 offset:38400
    v_mfma_f32_16x16x32_bf16 v[124:127], v[32:35], v[180:183], v[124:127]
    buffer_load_dwordx4 v10, s[28:31], s81 offen offset:1664 lds
    s_lshr_b32 s19, s92, 2
    s_lshl_b32 s19, s19, 3
    s_waitcnt lgkmcnt(4)
    v_mfma_f32_16x16x32_bf16 v[80:83], v[36:39], v[184:187], v[80:83]
    s_waitcnt vmcnt(6)
    s_barrier
    ds_read_b64_tr_b16 v[32:33], v3 offset:38912
    ds_read_b64_tr_b16 v[34:35], v3 offset:39424
    v_mfma_f32_16x16x32_bf16 v[88:91], v[36:39], v[188:191], v[88:91]
    s_lshl_b32 s9, s4, 1
    v_mfma_f32_16x16x32_bf16 v[84:87], v[40:43], v[184:187], v[84:87]
    s_add_u32 m0, s78, 49152
    ds_read_b64_tr_b16 v[36:37], v4 offset:38912
    ds_read_b64_tr_b16 v[38:39], v4 offset:39424
    v_mfma_f32_16x16x32_bf16 v[92:95], v[40:43], v[188:191], v[92:95]
    buffer_load_dwordx4 v11, s[44:47], s69 offen lds
    ds_read_b128 v[192:195], v1 offset:16384
    s_waitcnt lgkmcnt(5)
    v_mfma_f32_16x16x32_bf16 v[96:99], v[44:47], v[184:187], v[96:99]
    ds_read_b64_tr_b16 v[40:41], v5 offset:0
    ds_read_b64_tr_b16 v[42:43], v5 offset:512
    v_mfma_f32_16x16x32_bf16 v[112:115], v[44:47], v[188:191], v[112:115]
    ds_read_b128 v[196:199], v1 offset:20480
    s_add_u32 s9, s9, s19
    s_add_u32 s19, s19, s4
    v_mfma_f32_16x16x32_bf16 v[100:103], v[28:31], v[184:187], v[100:103]
    ds_read_b64_tr_b16 v[44:45], v6 offset:0
    ds_read_b64_tr_b16 v[46:47], v6 offset:512
    v_mfma_f32_16x16x32_bf16 v[116:119], v[28:31], v[188:191], v[116:119]
    buffer_load_dwordx4 v8, s[48:51], s76 offen offset:1024 lds
    ds_read_b128 v[200:203], v2 offset:16384
    s_waitcnt lgkmcnt(7)
    v_mfma_f32_16x16x32_bf16 v[104:107], v[32:35], v[184:187], v[104:107]
    ds_read_b64_tr_b16 v[28:29], v5 offset:1024
    ds_read_b64_tr_b16 v[30:31], v5 offset:1536
    v_mfma_f32_16x16x32_bf16 v[120:123], v[32:35], v[188:191], v[120:123]
    ds_read_b128 v[204:207], v2 offset:20480
    s_cmp_lt_u32 s9, 8
    s_cselect_b32 s22, 0, 8
    v_mfma_f32_16x16x32_bf16 v[108:111], v[36:39], v[184:187], v[108:111]
    ds_read_b64_tr_b16 v[32:33], v6 offset:1024
    ds_read_b64_tr_b16 v[34:35], v6 offset:1536
    v_mfma_f32_16x16x32_bf16 v[124:127], v[36:39], v[188:191], v[124:127]
    buffer_load_dwordx4 v8, s[52:55], s76 offen offset:2048 lds
    s_sub_u32 s9, s9, s22
    s_mul_i32 s3, s19, 144
    s_waitcnt lgkmcnt(6)
    v_mfma_f32_16x16x32_bf16 v[80:83], v[40:43], v[192:195], v[80:83]
    ds_read_b64_tr_b16 v[36:37], v5 offset:2048
    ds_read_b64_tr_b16 v[38:39], v5 offset:2560
    v_mfma_f32_16x16x32_bf16 v[88:91], v[40:43], v[196:199], v[88:91]
    s_add_u32 s3, s3, s8
    s_lshl_b32 s3, s3, 10
    s_add_u32 s3, s3, 7454720
    v_mfma_f32_16x16x32_bf16 v[84:87], v[44:47], v[192:195], v[84:87]
    s_add_u32 m0, s79, -768
    ds_read_b64_tr_b16 v[40:41], v6 offset:2048
    ds_read_b64_tr_b16 v[42:43], v6 offset:2560
    v_mfma_f32_16x16x32_bf16 v[92:95], v[44:47], v[196:199], v[92:95]
    buffer_load_dwordx4 v10, s[28:31], s80 offen offset:768 lds
    s_and_b32 s22, s8, 1
    s_waitcnt lgkmcnt(4)
    v_mfma_f32_16x16x32_bf16 v[96:99], v[28:31], v[192:195], v[96:99]
    ds_read_b64_tr_b16 v[44:45], v5 offset:12288
    ds_read_b64_tr_b16 v[46:47], v5 offset:12800
    v_mfma_f32_16x16x32_bf16 v[112:115], v[28:31], v[196:199], v[112:115]
    s_lshl_b32 s22, s22, 9
    s_sub_u32 s3, s3, s22
    s_lshl_b32 s16, s19, 5
    v_mfma_f32_16x16x32_bf16 v[100:103], v[32:35], v[192:195], v[100:103]
    ds_read_b64_tr_b16 v[28:29], v6 offset:12288
    ds_read_b64_tr_b16 v[30:31], v6 offset:12800
    v_mfma_f32_16x16x32_bf16 v[116:119], v[32:35], v[196:199], v[116:119]
    buffer_load_dwordx4 v10, s[28:31], s81 offen offset:1792 lds
    s_add_u32 s16, s16, s8
    s_lshl_b32 s16, s16, 7
    s_waitcnt lgkmcnt(4)
    v_mfma_f32_16x16x32_bf16 v[104:107], v[36:39], v[192:195], v[104:107]
    ds_read_b64_tr_b16 v[32:33], v5 offset:13312
    ds_read_b64_tr_b16 v[34:35], v5 offset:13824
    v_mfma_f32_16x16x32_bf16 v[120:123], v[36:39], v[196:199], v[120:123]
    v_lshlrev_b32 v59, 16, v0
    s_bfe_u32 s10, s14, 0x5000f
    s_lshl_b32 s10, s10, 10
    v_mfma_f32_16x16x32_bf16 v[108:111], v[40:43], v[192:195], v[108:111]
    ds_read_b64_tr_b16 v[36:37], v6 offset:13312
    ds_read_b64_tr_b16 v[38:39], v6 offset:13824
    v_mfma_f32_16x16x32_bf16 v[124:127], v[40:43], v[196:199], v[124:127]
    s_mov_b64 exec, 0x7f
    buffer_load_dword v58, v59, s[32:35], s10 offen
    s_mov_b64 exec, 3
    buffer_load_dword v58, v59, s[36:39], s10 offen
    s_mov_b64 exec, -1
    s_waitcnt lgkmcnt(4)
    v_mfma_f32_16x16x32_bf16 v[80:83], v[44:47], v[200:203], v[80:83]
    s_waitcnt vmcnt(7)
    s_barrier
    ds_read_b64_tr_b16 v[40:41], v5 offset:14336
    ds_read_b64_tr_b16 v[42:43], v5 offset:14848
    v_mfma_f32_16x16x32_bf16 v[88:91], v[44:47], v[204:207], v[88:91]
    s_add_u32 s16, s16, 17825792
    v_mfma_f32_16x16x32_bf16 v[84:87], v[28:31], v[200:203], v[84:87]
    s_add_u32 m0, s78, 73728
    ds_read_b64_tr_b16 v[44:45], v6 offset:14336
    ds_read_b64_tr_b16 v[46:47], v6 offset:14848
    v_mfma_f32_16x16x32_bf16 v[92:95], v[28:31], v[204:207], v[92:95]
    buffer_load_dwordx4 v11, s[44:47], s70 offen lds
    ds_read_b128 v[208:211], v1 offset:32768
    s_waitcnt lgkmcnt(5)
    v_mfma_f32_16x16x32_bf16 v[96:99], v[32:35], v[200:203], v[96:99]
    ds_read_b64_tr_b16 v[28:29], v5 offset:24576
    ds_read_b64_tr_b16 v[30:31], v5 offset:25088
    v_mfma_f32_16x16x32_bf16 v[112:115], v[32:35], v[204:207], v[112:115]
    ds_read_b128 v[212:215], v1 offset:36864
    s_cmp_lt_u32 s95, 1024
    s_cselect_b32 s101, 0x3eb8aa3b, 1.0
    v_mfma_f32_16x16x32_bf16 v[100:103], v[36:39], v[200:203], v[100:103]
    ds_read_b64_tr_b16 v[32:33], v6 offset:24576
    ds_read_b64_tr_b16 v[34:35], v6 offset:25088
    v_mfma_f32_16x16x32_bf16 v[116:119], v[36:39], v[204:207], v[116:119]
    buffer_load_dwordx4 v8, s[48:51], s77 offen offset:1024 lds
    ds_read_b128 v[216:219], v2 offset:32768
    s_add_u32 s22, s91, 3
    s_waitcnt lgkmcnt(7)
    v_mfma_f32_16x16x32_bf16 v[104:107], v[40:43], v[200:203], v[104:107]
    ds_read_b64_tr_b16 v[36:37], v5 offset:25600
    ds_read_b64_tr_b16 v[38:39], v5 offset:26112
    v_mfma_f32_16x16x32_bf16 v[120:123], v[40:43], v[204:207], v[120:123]
    ds_read_b128 v[220:223], v2 offset:36864
    s_and_b32 s22, s22, 3
    s_add_u32 s42, s91, 4
    v_mfma_f32_16x16x32_bf16 v[108:111], v[44:47], v[200:203], v[108:111]
    ds_read_b64_tr_b16 v[40:41], v6 offset:25600
    ds_read_b64_tr_b16 v[42:43], v6 offset:26112
    v_mfma_f32_16x16x32_bf16 v[124:127], v[44:47], v[204:207], v[124:127]
    buffer_load_dwordx4 v8, s[52:55], s77 offen offset:2048 lds
    s_xor_b32 s43, s91, 2
    s_add_u32 s97, s91, 8
    s_waitcnt lgkmcnt(6)
    v_mfma_f32_16x16x32_bf16 v[80:83], v[28:31], v[208:211], v[80:83]
    ds_read_b64_tr_b16 v[44:45], v5 offset:26624
    ds_read_b64_tr_b16 v[46:47], v5 offset:27136
    v_mfma_f32_16x16x32_bf16 v[88:91], v[28:31], v[212:215], v[88:91]
    s_cmp_lt_u32 s91, 4
    s_cselect_b32 s22, s22, s42
    s_cselect_b32 s43, s43, s97
    v_mfma_f32_16x16x32_bf16 v[84:87], v[32:35], v[208:211], v[84:87]
    s_add_u32 m0, s79, 15488
    ds_read_b64_tr_b16 v[28:29], v6 offset:26624
    ds_read_b64_tr_b16 v[30:31], v6 offset:27136
    v_mfma_f32_16x16x32_bf16 v[92:95], v[32:35], v[212:215], v[92:95]
    buffer_load_dwordx4 v10, s[28:31], s80 offen offset:896 lds
    s_lshl_b32 s22, s22, 8
    s_waitcnt lgkmcnt(4)
    v_mfma_f32_16x16x32_bf16 v[96:99], v[36:39], v[208:211], v[96:99]
    ds_read_b64_tr_b16 v[32:33], v5 offset:36864
    ds_read_b64_tr_b16 v[34:35], v5 offset:37376
    v_mfma_f32_16x16x32_bf16 v[112:115], v[36:39], v[212:215], v[112:115]
    s_lshl_b32 s43, s43, 8
    s_lshl_b32 s42, s91, 8
    s_bfe_u32 s11, s8, 0x10001
    v_mfma_f32_16x16x32_bf16 v[100:103], v[40:43], v[208:211], v[100:103]
    ds_read_b64_tr_b16 v[36:37], v6 offset:36864
    ds_read_b64_tr_b16 v[38:39], v6 offset:37376
    v_mfma_f32_16x16x32_bf16 v[116:119], v[40:43], v[212:215], v[116:119]
    buffer_load_dwordx4 v10, s[28:31], s81 offen offset:1920 lds
    s_lshl_b32 s11, s11, 7
    s_add_u32 s11, s11, 16777216
    s_waitcnt lgkmcnt(4)
    v_mfma_f32_16x16x32_bf16 v[104:107], v[44:47], v[208:211], v[104:107]
    ds_read_b64_tr_b16 v[40:41], v5 offset:37888
    ds_read_b64_tr_b16 v[42:43], v5 offset:38400
    v_mfma_f32_16x16x32_bf16 v[120:123], v[44:47], v[212:215], v[120:123]
    s_lshl_b32 s91, s19, 14
    s_add_u32 s91, s91, s11
    s_add_u32 s91, s91, s42
    v_mfma_f32_16x16x32_bf16 v[108:111], v[28:31], v[208:211], v[108:111]
    ds_read_b64_tr_b16 v[44:45], v6 offset:37888
    ds_read_b64_tr_b16 v[46:47], v6 offset:38400
    v_mfma_f32_16x16x32_bf16 v[124:127], v[28:31], v[212:215], v[124:127]
    s_lshl_b32 s94, s9, 14
    s_add_u32 s94, s94, s11
    s_add_u32 s92, s94, s22
    s_waitcnt lgkmcnt(4)
    v_mfma_f32_16x16x32_bf16 v[80:83], v[32:35], v[216:219], v[80:83]
    s_waitcnt vmcnt(7)
    s_barrier
    ds_read_b64_tr_b16 v[28:29], v5 offset:38912
    ds_read_b64_tr_b16 v[30:31], v5 offset:39424
    v_mfma_f32_16x16x32_bf16 v[88:91], v[32:35], v[220:223], v[88:91]
    buffer_load_dwordx4 v[24:27], v48, s[24:27], s89 offen sc1
    v_mfma_f32_16x16x32_bf16 v[84:87], v[36:39], v[216:219], v[84:87]
    s_add_u32 m0, s79, -98304
    ds_read_b64_tr_b16 v[32:33], v6 offset:38912
    ds_read_b64_tr_b16 v[34:35], v6 offset:39424
    v_mfma_f32_16x16x32_bf16 v[92:95], v[36:39], v[220:223], v[92:95]
    buffer_load_dwordx4 v8, s[56:59], s1 offen lds
    ds_read_b128 v[224:227], v1 offset:0
    s_waitcnt lgkmcnt(5)
    v_mfma_f32_16x16x32_bf16 v[96:99], v[40:43], v[216:219], v[96:99]
    ds_read_b64_tr_b16 v[36:37], v3 offset:0
    ds_read_b64_tr_b16 v[38:39], v3 offset:512
    v_mfma_f32_16x16x32_bf16 v[112:115], v[40:43], v[220:223], v[112:115]
    ds_read_b128 v[228:231], v1 offset:4096
    buffer_load_dwordx2 v[10:11], v49, s[24:27], s90 offen sc1
    s_add_u32 s93, s92, 16384
    v_mfma_f32_16x16x32_bf16 v[100:103], v[44:47], v[216:219], v[100:103]
    ds_read_b64_tr_b16 v[40:41], v4 offset:0
    ds_read_b64_tr_b16 v[42:43], v4 offset:512
    v_mfma_f32_16x16x32_bf16 v[116:119], v[44:47], v[220:223], v[116:119]
    buffer_load_dwordx4 v8, s[60:63], s1 offen offset:1024 lds
    ds_read_b128 v[232:235], v2 offset:0
    s_waitcnt lgkmcnt(7)
    v_mfma_f32_16x16x32_bf16 v[104:107], v[28:31], v[216:219], v[104:107]
    ds_read_b64_tr_b16 v[44:45], v3 offset:1024
    ds_read_b64_tr_b16 v[46:47], v3 offset:1536
    v_mfma_f32_16x16x32_bf16 v[120:123], v[28:31], v[220:223], v[120:123]
    ds_read_b128 v[236:239], v2 offset:4096
    s_add_u32 s94, s94, s43
    s_add_u32 s95, s94, 16384
    v_mfma_f32_16x16x32_bf16 v[108:111], v[32:35], v[216:219], v[108:111]
    ds_read_b64_tr_b16 v[28:29], v4 offset:1024
    ds_read_b64_tr_b16 v[30:31], v4 offset:1536
    v_mfma_f32_16x16x32_bf16 v[124:127], v[32:35], v[220:223], v[124:127]
    buffer_load_dwordx2 v[12:13], v49, s[24:27], s90 offen offset:512 sc1
    s_lshr_b32 s11, s8, 1
    s_lshl_b32 s11, s11, 17
    s_waitcnt lgkmcnt(6)
    v_mfma_f32_16x16x32_bf16 v[80:83], v[36:39], v[224:227], v[80:83]
    ds_read_b64_tr_b16 v[32:33], v3 offset:2048
    ds_read_b64_tr_b16 v[34:35], v3 offset:2560
    v_mfma_f32_16x16x32_bf16 v[88:91], v[36:39], v[228:231], v[88:91]
    s_and_b32 s42, s8, 1
    s_lshl_b32 s42, s42, 10
    s_add_u32 s11, s11, s42
    v_mfma_f32_16x16x32_bf16 v[84:87], v[40:43], v[224:227], v[84:87]
    ds_read_b64_tr_b16 v[36:37], v4 offset:2048
    ds_read_b64_tr_b16 v[38:39], v4 offset:2560
    v_mfma_f32_16x16x32_bf16 v[92:95], v[40:43], v[228:231], v[92:95]
    buffer_load_dwordx2 v[14:15], v49, s[24:27], s90 offen offset:1024 sc1
    s_lshl_b32 s96, s9, 11
    s_add_u32 s96, s96, s11
    s_waitcnt lgkmcnt(4)
    v_mfma_f32_16x16x32_bf16 v[96:99], v[44:47], v[224:227], v[96:99]
    ds_read_b64_tr_b16 v[40:41], v3 offset:12288
    ds_read_b64_tr_b16 v[42:43], v3 offset:12800
    v_mfma_f32_16x16x32_bf16 v[112:115], v[44:47], v[228:231], v[112:115]
    s_add_u32 s100, s96, 5242880
    s_add_u32 s96, s96, 3145728
    s_lshl_b32 s97, s19, 11
    v_mfma_f32_16x16x32_bf16 v[100:103], v[28:31], v[224:227], v[100:103]
    ds_read_b64_tr_b16 v[44:45], v4 offset:12288
    ds_read_b64_tr_b16 v[46:47], v4 offset:12800
    v_mfma_f32_16x16x32_bf16 v[116:119], v[28:31], v[228:231], v[116:119]
    buffer_load_dwordx2 v[16:17], v49, s[24:27], s90 offen offset:1536 sc1
    s_add_u32 s97, s97, s11
    s_add_u32 s97, s97, 1048576
    s_waitcnt lgkmcnt(4)
    v_mfma_f32_16x16x32_bf16 v[104:107], v[32:35], v[224:227], v[104:107]
    ds_read_b64_tr_b16 v[28:29], v3 offset:13312
    ds_read_b64_tr_b16 v[30:31], v3 offset:13824
    v_mfma_f32_16x16x32_bf16 v[120:123], v[32:35], v[228:231], v[120:123]
    s_mov_b32 s42, 2097152
    s_mov_b32 s43, 0x20000
    v_mfma_f32_16x16x32_bf16 v[108:111], v[36:39], v[224:227], v[108:111]
    ds_read_b64_tr_b16 v[32:33], v4 offset:13312
    ds_read_b64_tr_b16 v[34:35], v4 offset:13824
    v_mfma_f32_16x16x32_bf16 v[124:127], v[36:39], v[228:231], v[124:127]
    buffer_load_dwordx2 v[18:19], v49, s[24:27], s90 offen offset:2048 sc1
    s_waitcnt lgkmcnt(4)
    v_mfma_f32_16x16x32_bf16 v[80:83], v[40:43], v[232:235], v[80:83]
    s_waitcnt vmcnt(8)
    s_barrier
    ds_read_b64_tr_b16 v[36:37], v3 offset:14336
    ds_read_b64_tr_b16 v[38:39], v3 offset:14848
    v_mfma_f32_16x16x32_bf16 v[88:91], v[40:43], v[236:239], v[88:91]
    v_mfma_f32_16x16x32_bf16 v[84:87], v[44:47], v[232:235], v[84:87]
    s_add_u32 m0, s79, -81920
    ds_read_b64_tr_b16 v[40:41], v4 offset:14336
    ds_read_b64_tr_b16 v[42:43], v4 offset:14848
    v_mfma_f32_16x16x32_bf16 v[92:95], v[44:47], v[236:239], v[92:95]
    buffer_load_dwordx4 v8, s[56:59], s71 offen lds
    ds_read_b128 v[240:243], v1 offset:16384
    s_waitcnt lgkmcnt(5)
    v_mfma_f32_16x16x32_bf16 v[96:99], v[28:31], v[232:235], v[96:99]
    ds_read_b64_tr_b16 v[44:45], v3 offset:24576
    ds_read_b64_tr_b16 v[46:47], v3 offset:25088
    v_mfma_f32_16x16x32_bf16 v[112:115], v[28:31], v[236:239], v[112:115]
    ds_read_b128 v[244:247], v1 offset:20480
    v_mfma_f32_16x16x32_bf16 v[100:103], v[32:35], v[232:235], v[100:103]
    ds_read_b64_tr_b16 v[28:29], v4 offset:24576
    ds_read_b64_tr_b16 v[30:31], v4 offset:25088
    v_mfma_f32_16x16x32_bf16 v[116:119], v[32:35], v[236:239], v[116:119]
    buffer_load_dwordx4 v8, s[60:63], s71 offen offset:1024 lds
    ds_read_b128 v[248:251], v2 offset:16384
    s_waitcnt lgkmcnt(7)
    v_mfma_f32_16x16x32_bf16 v[104:107], v[36:39], v[232:235], v[104:107]
    ds_read_b64_tr_b16 v[32:33], v3 offset:25600
    ds_read_b64_tr_b16 v[34:35], v3 offset:26112
    v_mfma_f32_16x16x32_bf16 v[120:123], v[36:39], v[236:239], v[120:123]
    ds_read_b128 v[252:255], v2 offset:20480
    v_mfma_f32_16x16x32_bf16 v[108:111], v[40:43], v[232:235], v[108:111]
    s_add_u32 m0, s79, -65536
    ds_read_b64_tr_b16 v[36:37], v4 offset:25600
    ds_read_b64_tr_b16 v[38:39], v4 offset:26112
    v_mfma_f32_16x16x32_bf16 v[124:127], v[40:43], v[236:239], v[124:127]
    buffer_load_dwordx4 v8, s[56:59], s72 offen lds
    s_waitcnt lgkmcnt(6)
    v_mfma_f32_16x16x32_bf16 v[80:83], v[44:47], v[240:243], v[80:83]
    ds_read_b64_tr_b16 v[40:41], v3 offset:26624
    ds_read_b64_tr_b16 v[42:43], v3 offset:27136
    v_mfma_f32_16x16x32_bf16 v[88:91], v[44:47], v[244:247], v[88:91]
    v_mfma_f32_16x16x32_bf16 v[84:87], v[28:31], v[240:243], v[84:87]
    ds_read_b64_tr_b16 v[44:45], v4 offset:26624
    ds_read_b64_tr_b16 v[46:47], v4 offset:27136
    v_mfma_f32_16x16x32_bf16 v[92:95], v[28:31], v[244:247], v[92:95]
    buffer_load_dwordx4 v8, s[60:63], s72 offen offset:1024 lds
    s_waitcnt lgkmcnt(4)
    v_mfma_f32_16x16x32_bf16 v[96:99], v[32:35], v[240:243], v[96:99]
    ds_read_b64_tr_b16 v[28:29], v3 offset:36864
    ds_read_b64_tr_b16 v[30:31], v3 offset:37376
    v_mfma_f32_16x16x32_bf16 v[112:115], v[32:35], v[244:247], v[112:115]
    v_mfma_f32_16x16x32_bf16 v[100:103], v[36:39], v[240:243], v[100:103]
    s_add_u32 m0, s79, 32768
    ds_read_b64_tr_b16 v[32:33], v4 offset:36864
    ds_read_b64_tr_b16 v[34:35], v4 offset:37376
    v_mfma_f32_16x16x32_bf16 v[116:119], v[36:39], v[244:247], v[116:119]
    buffer_load_dwordx4 v8, s[56:59], s74 offen lds
    s_waitcnt lgkmcnt(4)
    v_mfma_f32_16x16x32_bf16 v[104:107], v[40:43], v[240:243], v[104:107]
    ds_read_b64_tr_b16 v[36:37], v3 offset:37888
    ds_read_b64_tr_b16 v[38:39], v3 offset:38400
    v_mfma_f32_16x16x32_bf16 v[120:123], v[40:43], v[244:247], v[120:123]
    v_mfma_f32_16x16x32_bf16 v[108:111], v[44:47], v[240:243], v[108:111]
    ds_read_b64_tr_b16 v[40:41], v4 offset:37888
    ds_read_b64_tr_b16 v[42:43], v4 offset:38400
    v_mfma_f32_16x16x32_bf16 v[124:127], v[44:47], v[244:247], v[124:127]
    buffer_load_dwordx4 v8, s[60:63], s74 offen offset:1024 lds
    s_waitcnt lgkmcnt(4)
    v_mfma_f32_16x16x32_bf16 v[80:83], v[28:31], v[248:251], v[80:83]
    s_waitcnt vmcnt(10)
    s_barrier
    ds_read_b64_tr_b16 v[44:45], v3 offset:38912
    ds_read_b64_tr_b16 v[46:47], v3 offset:39424
    v_mfma_f32_16x16x32_bf16 v[88:91], v[28:31], v[252:255], v[88:91]
    v_sub_u32 v5, v5, v51
    v_sub_u32 v6, v6, v51
    v_mfma_f32_16x16x32_bf16 v[84:87], v[32:35], v[248:251], v[84:87]
    s_add_u32 m0, s79, -49152
    ds_read_b64_tr_b16 v[28:29], v4 offset:38912
    ds_read_b64_tr_b16 v[30:31], v4 offset:39424
    v_mfma_f32_16x16x32_bf16 v[92:95], v[32:35], v[252:255], v[92:95]
    buffer_load_dwordx4 v8, s[56:59], s73 offen lds
    s_waitcnt lgkmcnt(4)
    v_mfma_f32_16x16x32_bf16 v[96:99], v[36:39], v[248:251], v[96:99]
    ds_read_b64_tr_b16 v[32:33], v5 offset:0
    ds_read_b64_tr_b16 v[34:35], v5 offset:512
    v_mfma_f32_16x16x32_bf16 v[112:115], v[36:39], v[252:255], v[112:115]
    v_mfma_f32_16x16x32_bf16 v[100:103], v[40:43], v[248:251], v[100:103]
    ds_read_b64_tr_b16 v[36:37], v6 offset:0
    ds_read_b64_tr_b16 v[38:39], v6 offset:512
    v_mfma_f32_16x16x32_bf16 v[116:119], v[40:43], v[252:255], v[116:119]
    buffer_load_dwordx4 v8, s[60:63], s73 offen offset:1024 lds
    s_waitcnt lgkmcnt(4)
    v_mfma_f32_16x16x32_bf16 v[104:107], v[44:47], v[248:251], v[104:107]
    ds_read_b64_tr_b16 v[40:41], v5 offset:1024
    ds_read_b64_tr_b16 v[42:43], v5 offset:1536
    v_mfma_f32_16x16x32_bf16 v[120:123], v[44:47], v[252:255], v[120:123]
    v_mfma_f32_16x16x32_bf16 v[108:111], v[28:31], v[248:251], v[108:111]
    ds_read_b64_tr_b16 v[44:45], v6 offset:1024
    ds_read_b64_tr_b16 v[46:47], v6 offset:1536
    v_mfma_f32_16x16x32_bf16 v[124:127], v[28:31], v[252:255], v[124:127]
    s_waitcnt vmcnt(8)
    v_min3_u32 v50, v11, v13, v15
    v_max3_u32 v51, v11, v13, v15
    v_min3_u32 v50, v50, v17, v19
    v_max3_u32 v51, v51, v17, v19
    v_min3_u32 v50, v50, v25, v27
    v_max3_u32 v51, v51, v25, v27
    v_xor_b32 v50, s5, v50
    v_xor_b32 v51, s5, v51
    v_or_b32 v50, v50, v51
    v_cmp_ne_u32 vcc, 0, v50
    s_nop 0
    s_cbranch_vccz Lok_gran_1
    s_mov_b32 s18, 0
Lsp_gran_2:
    buffer_load_dwordx4 v[24:27], v48, s[24:27], s89 offen sc1
    buffer_load_dwordx2 v[10:11], v49, s[24:27], s90 offen sc1
    buffer_load_dwordx2 v[12:13], v49, s[24:27], s90 offen offset:512 sc1
    buffer_load_dwordx2 v[14:15], v49, s[24:27], s90 offen offset:1024 sc1
    buffer_load_dwordx2 v[16:17], v49, s[24:27], s90 offen offset:1536 sc1
    buffer_load_dwordx2 v[18:19], v49, s[24:27], s90 offen offset:2048 sc1
    s_waitcnt vmcnt(0)
    v_min3_u32 v50, v11, v13, v15
    v_max3_u32 v51, v11, v13, v15
    v_min3_u32 v50, v50, v17, v19
    v_max3_u32 v51, v51, v17, v19
    v_min3_u32 v50, v50, v25, v27
    v_max3_u32 v51, v51, v25, v27
    v_xor_b32 v50, s5, v50
    v_xor_b32 v51, s5, v51
    v_or_b32 v50, v50, v51
    v_cmp_ne_u32 vcc, 0, v50
    s_nop 0
    s_cbranch_vccz Lok_gran_1
    s_add_u32 s18, s18, 1
    s_cmp_lt_u32 s18, 20000
    s_cbranch_scc1 Lsp_gran_2
Lok_gran_1:
    v_mov_b32 v20, v10
    v_permlane32_swap_b32 v12, v14
    v_permlane32_swap_b32 v16, v18
    v_permlane32_swap_b32 v10, v20
    v_mov_b32 v22, v26
    v_mov_b32 v23, v26
    v_add_f32 v12, v12, v14
    v_add_f32 v16, v16, v18
    v_add_f32 v10, v10, v20
    v_permlane32_swap_b32 v22, v23
    v_mfma_f32_16x16x1_4b_f32 v[48:63], v16, v24, 0 blgp:4
    v_mfma_f32_16x16x1_4b_f32 v[64:79], v16, v24, 0 blgp:6
    v_mfma_f32_16x16x1_4b_f32 v[80:95], v10, v24, v[80:95]
    v_mfma_f32_16x16x1_4b_f32 v[96:111], v12, v24, v[96:111] blgp:4
    v_mfma_f32_16x16x1_4b_f32 v[112:127], v12, v24, v[112:127] blgp:6
    s_waitcnt lgkmcnt(4)
    s_nop 4
    v_mfma_f32_16x16x32_bf16 v[48:51], v[32:35], v[128:131], v[48:51]
    s_add_u32 m0, s79, 49152
    ds_read_b64_tr_b16 v[28:29], v5 offset:8192
    ds_read_b64_tr_b16 v[30:31], v5 offset:8704
    v_mfma_f32_16x16x32_bf16 v[64:67], v[32:35], v[132:135], v[64:67]
    buffer_load_dwordx4 v8, s[56:59], s75 offen lds
    v_mfma_f32_16x16x32_bf16 v[52:55], v[36:39], v[128:131], v[52:55]
    ds_read_b64_tr_b16 v[32:33], v6 offset:8192
    ds_read_b64_tr_b16 v[34:35], v6 offset:8704
    v_mfma_f32_16x16x32_bf16 v[68:71], v[36:39], v[132:135], v[68:71]
    buffer_load_dwordx4 v8, s[60:63], s75 offen offset:1024 lds
    v_mul_f32 v24, s101, v22
    v_mul_f32 v25, s101, v23
    v_mul_f32 v80, v80, v24
    v_mul_f32 v81, v81, v24
    v_mul_f32 v82, v82, v24
    v_mul_f32 v83, v83, v24
    v_mul_f32 v88, v88, v25
    s_waitcnt lgkmcnt(4)
    v_mfma_f32_16x16x32_bf16 v[56:59], v[40:43], v[128:131], v[56:59]
    ds_read_b64_tr_b16 v[36:37], v5 offset:9216
    ds_read_b64_tr_b16 v[38:39], v5 offset:9728
    v_mfma_f32_16x16x32_bf16 v[72:75], v[40:43], v[132:135], v[72:75]
    v_mul_f32 v89, v89, v25
    v_mul_f32 v90, v90, v25
    v_mul_f32 v91, v91, v25
    v_cvt_pk_bf16_f32 v80, v80, v81
    v_cvt_pk_bf16_f32 v81, v82, v83
    v_cvt_pk_bf16_f32 v82, v88, v89
    v_cvt_pk_bf16_f32 v83, v90, v91
    v_mfma_f32_16x16x32_bf16 v[60:63], v[44:47], v[128:131], v[60:63]
    s_waitcnt vmcnt(8)
    s_barrier
    ds_read_b64_tr_b16 v[40:41], v6 offset:9216
    ds_read_b64_tr_b16 v[42:43], v6 offset:9728
    v_mfma_f32_16x16x32_bf16 v[76:79], v[44:47], v[132:135], v[76:79]
    v_permlane16_swap_b32 v80, v82
    v_permlane16_swap_b32 v81, v83
    buffer_store_dwordx4 v[80:83], v9, s[24:27], s82 offen sc1
    v_mul_f32 v84, v84, v24
    v_mul_f32 v85, v85, v24
    s_waitcnt lgkmcnt(4)
    v_mfma_f32_16x16x32_bf16 v[48:51], v[28:31], v[136:139], v[48:51]
    ds_read_b64_tr_b16 v[44:45], v5 offset:16384
    ds_read_b64_tr_b16 v[46:47], v5 offset:16896
    v_mfma_f32_16x16x32_bf16 v[64:67], v[28:31], v[140:143], v[64:67]
    v_mul_f32 v86, v86, v24
    v_mul_f32 v87, v87, v24
    v_mul_f32 v92, v92, v25
    v_mul_f32 v93, v93, v25
    v_mul_f32 v94, v94, v25
    v_mul_f32 v95, v95, v25
    v_cvt_pk_bf16_f32 v84, v84, v85
    v_cvt_pk_bf16_f32 v85, v86, v87
    v_mfma_f32_16x16x32_bf16 v[52:55], v[32:35], v[136:139], v[52:55]
    ds_read_b64_tr_b16 v[28:29], v6 offset:16384
    ds_read_b64_tr_b16 v[30:31], v6 offset:16896
    v_mfma_f32_16x16x32_bf16 v[68:71], v[32:35], v[140:143], v[68:71]
    v_cvt_pk_bf16_f32 v86, v92, v93
    v_cvt_pk_bf16_f32 v87, v94, v95
    s_waitcnt lgkmcnt(4)
    v_mfma_f32_16x16x32_bf16 v[56:59], v[36:39], v[136:139], v[56:59]
    ds_read_b64_tr_b16 v[32:33], v5 offset:17408
    ds_read_b64_tr_b16 v[34:35], v5 offset:17920
    v_mfma_f32_16x16x32_bf16 v[72:75], v[36:39], v[140:143], v[72:75]
    v_permlane16_swap_b32 v84, v86
    v_permlane16_swap_b32 v85, v87
    buffer_store_dwordx4 v[84:87], v9, s[24:27], s82 offen offset:1024 sc1
    v_mfma_f32_16x16x32_bf16 v[60:63], v[40:43], v[136:139], v[60:63]
    ds_read_b64_tr_b16 v[36:37], v6 offset:17408
    ds_read_b64_tr_b16 v[38:39], v6 offset:17920
    v_mfma_f32_16x16x32_bf16 v[76:79], v[40:43], v[140:143], v[76:79]
    v_mul_f32 v96, v96, v104
    v_mul_f32 v97, v97, v105
    v_mul_f32 v98, v98, v106
    v_mul_f32 v99, v99, v107
    s_waitcnt lgkmcnt(4)
    v_mfma_f32_16x16x32_bf16 v[48:51], v[44:47], v[144:147], v[48:51]
    ds_read_b64_tr_b16 v[40:41], v5 offset:24576
    ds_read_b64_tr_b16 v[42:43], v5 offset:25088
    v_mfma_f32_16x16x32_bf16 v[64:67], v[44:47], v[148:151], v[64:67]
    v_mul_f32 v100, v100, v108
    v_mul_f32 v101, v101, v109
    v_mul_f32 v102, v102, v110
    v_mul_f32 v103, v103, v111
    v_mfma_f32_16x16x32_bf16 v[52:55], v[28:31], v[144:147], v[52:55]
    ds_read_b64_tr_b16 v[44:45], v6 offset:24576
    ds_read_b64_tr_b16 v[46:47], v6 offset:25088
    v_mfma_f32_16x16x32_bf16 v[68:71], v[28:31], v[148:151], v[68:71]
    v_cvt_pk_bf16_f32 v96, v96, v97
    v_cvt_pk_bf16_f32 v97, v98, v99
    v_cvt_pk_bf16_f32 v98, v100, v101
    v_cvt_pk_bf16_f32 v99, v102, v103
    s_waitcnt lgkmcnt(4)
    v_mfma_f32_16x16x32_bf16 v[56:59], v[32:35], v[144:147], v[56:59]
    ds_read_b64_tr_b16 v[28:29], v5 offset:25600
    ds_read_b64_tr_b16 v[30:31], v5 offset:26112
    v_mfma_f32_16x16x32_bf16 v[72:75], v[32:35], v[148:151], v[72:75]
    v_mul_f32 v112, v112, v120
    v_mul_f32 v113, v113, v121
    v_mul_f32 v114, v114, v122
    v_mul_f32 v115, v115, v123
    v_mfma_f32_16x16x32_bf16 v[60:63], v[36:39], v[144:147], v[60:63]
    s_waitcnt vmcnt(8)
    s_barrier
    ds_read_b64_tr_b16 v[32:33], v6 offset:25600
    ds_read_b64_tr_b16 v[34:35], v6 offset:26112
    v_mfma_f32_16x16x32_bf16 v[76:79], v[36:39], v[148:151], v[76:79]
    v_mul_f32 v116, v116, v124
    v_mul_f32 v117, v117, v125
    s_waitcnt lgkmcnt(4)
    v_mfma_f32_16x16x32_bf16 v[48:51], v[40:43], v[152:155], v[48:51]
    s_add_u32 m0, s79, -98304
    ds_read_b64_tr_b16 v[36:37], v5 offset:32768
    ds_read_b64_tr_b16 v[38:39], v5 offset:33280
    v_mfma_f32_16x16x32_bf16 v[64:67], v[40:43], v[156:159], v[64:67]
    buffer_load_dwordx4 v8, s[56:59], s76 offen lds
    v_mul_f32 v118, v118, v126
    v_mul_f32 v119, v119, v127
    v_mfma_f32_16x16x32_bf16 v[52:55], v[44:47], v[152:155], v[52:55]
    ds_read_b64_tr_b16 v[40:41], v6 offset:32768
    ds_read_b64_tr_b16 v[42:43], v6 offset:33280
    v_mfma_f32_16x16x32_bf16 v[68:71], v[44:47], v[156:159], v[68:71]
    buffer_load_dwordx4 v8, s[60:63], s76 offen offset:1024 lds
    v_cvt_pk_bf16_f32 v112, v112, v113
    v_cvt_pk_bf16_f32 v113, v114, v115
    v_cvt_pk_bf16_f32 v114, v116, v117
    s_waitcnt lgkmcnt(4)
    v_mfma_f32_16x16x32_bf16 v[56:59], v[28:31], v[152:155], v[56:59]
    ds_read_b64_tr_b16 v[44:45], v5 offset:33792
    ds_read_b64_tr_b16 v[46:47], v5 offset:34304
    v_mfma_f32_16x16x32_bf16 v[72:75], v[28:31], v[156:159], v[72:75]
    s_waitcnt vmcnt(2)
    v_lshlrev_b32 v94, 2, v0
    v_mov_b32 v95, s5
    s_mov_b32 exec_hi, 0
    buffer_store_dword v95, v94, s[24:27], s86 offen sc1
    s_mov_b32 exec_hi, -1
    s_add_u32 s86, s86, 4096
    v_mfma_f32_16x16x32_bf16 v[60:63], v[32:35], v[152:155], v[60:63]
    ds_read_b64_tr_b16 v[28:29], v6 offset:33792
    ds_read_b64_tr_b16 v[30:31], v6 offset:34304
    v_mfma_f32_16x16x32_bf16 v[76:79], v[32:35], v[156:159], v[76:79]
    v_cvt_pk_bf16_f32 v115, v118, v119
    v_lshrrev_b32 v2, 3, v0
    v_and_b32 v3, 6, v2
    s_waitcnt lgkmcnt(4)
    v_mfma_f32_16x16x32_bf16 v[48:51], v[36:39], v[160:163], v[48:51]
    ds_read_b64_tr_b16 v[32:33], v5 offset:40960
    ds_read_b64_tr_b16 v[34:35], v5 offset:41472
    v_mfma_f32_16x16x32_bf16 v[64:67], v[36:39], v[164:167], v[64:67]
    v_and_b32 v4, 7, v0
    v_xor_b32 v3, v3, v4
    v_lshlrev_b32 v3, 4, v3
    v_mfma_f32_16x16x32_bf16 v[52:55], v[40:43], v[160:163], v[52:55]
    ds_read_b64_tr_b16 v[36:37], v6 offset:40960
    ds_read_b64_tr_b16 v[38:39], v6 offset:41472
    v_mfma_f32_16x16x32_bf16 v[68:71], v[40:43], v[164:167], v[68:71]
    v_lshl_add_u32 v1, v2, 10, v3
    v_add_u32 v2, 7168, v1
    v_add_u32 v3, 14336, v1
    s_waitcnt lgkmcnt(4)
    v_mfma_f32_16x16x32_bf16 v[56:59], v[44:47], v[160:163], v[56:59]
    ds_read_b64_tr_b16 v[40:41], v5 offset:41984
    ds_read_b64_tr_b16 v[42:43], v5 offset:42496
    v_mfma_f32_16x16x32_bf16 v[72:75], v[44:47], v[164:167], v[72:75]
    v_add_u32 v4, 21504, v1
    s_mov_b32 s22, 0
    v_mfma_f32_16x16x32_bf16 v[60:63], v[28:31], v[160:163], v[60:63]
    s_barrier
    ds_read_b64_tr_b16 v[44:45], v6 offset:41984
    ds_read_b64_tr_b16 v[46:47], v6 offset:42496
    v_mfma_f32_16x16x32_bf16 v[76:79], v[28:31], v[164:167], v[76:79]
    s_waitcnt lgkmcnt(4)
    v_mfma_f32_16x16x32_bf16 v[48:51], v[32:35], v[168:171], v[48:51]
    s_add_u32 m0, s79, -81920
    ds_read_b64_tr_b16 v[28:29], v5 offset:49152
    ds_read_b64_tr_b16 v[30:31], v5 offset:49664
    v_mfma_f32_16x16x32_bf16 v[64:67], v[32:35], v[172:175], v[64:67]
    buffer_load_dwordx4 v8, s[56:59], s77 offen lds
    v_lshlrev_b32 v92, 16, v0
    s_bfe_u32 s10, s14, 0x2000f
    s_bfe_u32 s9, s13, 0x30007
    s_lshl3_add_u32 s10, s10, s9
    s_lshl_b32 s10, s10, 10
    s_lshl_b32 s9, s9, 7
    s_sub_u32 s10, s10, s9
    v_mfma_f32_16x16x32_bf16 v[52:55], v[36:39], v[168:171], v[52:55]
    ds_read_b64_tr_b16 v[32:33], v6 offset:49152
    ds_read_b64_tr_b16 v[34:35], v6 offset:49664
    v_mfma_f32_16x16x32_bf16 v[68:71], v[36:39], v[172:175], v[68:71]
    buffer_load_dwordx4 v8, s[60:63], s77 offen offset:1024 lds
    s_add_u32 s9, s32, s10
    s_sub_u32 s9, 384, s9
    s_and_b32 s9, s9, 0x380
    s_add_u32 s9, s9, s10
    s_mov_b64 exec, 15
    v_add_u32 v87, s9, v92
    buffer_load_dword v87, v87, s[32:35], 0 offen
    s_mov_b64 exec, -1
    s_waitcnt lgkmcnt(4)
    v_mfma_f32_16x16x32_bf16 v[56:59], v[40:43], v[168:171], v[56:59]
    ds_read_b64_tr_b16 v[36:37], v5 offset:50176
    ds_read_b64_tr_b16 v[38:39], v5 offset:50688
    v_mfma_f32_16x16x32_bf16 v[72:75], v[40:43], v[172:175], v[72:75]
    v_mfma_f32_16x16x32_bf16 v[60:63], v[44:47], v[168:171], v[60:63]
    s_add_u32 m0, s6, 98304
    ds_read_b64_tr_b16 v[40:41], v6 offset:50176
    ds_read_b64_tr_b16 v[42:43], v6 offset:50688
    v_mfma_f32_16x16x32_bf16 v[76:79], v[44:47], v[172:175], v[76:79]
    buffer_load_dwordx4 v1, s[32:35], s22 offen lds
    s_waitcnt lgkmcnt(4)
    v_mfma_f32_16x16x32_bf16 v[48:51], v[28:31], v[176:179], v[48:51]
    ds_read_b64_tr_b16 v[44:45], v5 offset:57344
    ds_read_b64_tr_b16 v[46:47], v5 offset:57856
    v_mfma_f32_16x16x32_bf16 v[64:67], v[28:31], v[180:183], v[64:67]
    buffer_store_dwordx4 v[96:99], v9, s[24:27], s83 offen sc1
    v_mfma_f32_16x16x32_bf16 v[52:55], v[32:35], v[176:179], v[52:55]
    ds_read_b64_tr_b16 v[28:29], v6 offset:57344
    ds_read_b64_tr_b16 v[30:31], v6 offset:57856
    v_mfma_f32_16x16x32_bf16 v[68:71], v[32:35], v[180:183], v[68:71]
    buffer_load_dwordx4 v2, s[32:35], s22 offen offset:1024 lds
    s_waitcnt lgkmcnt(4)
    v_mfma_f32_16x16x32_bf16 v[56:59], v[36:39], v[176:179], v[56:59]
    ds_read_b64_tr_b16 v[32:33], v5 offset:58368
    ds_read_b64_tr_b16 v[34:35], v5 offset:58880
    v_add_u32 v5, 131072, v5
    v_mfma_f32_16x16x32_bf16 v[72:75], v[36:39], v[180:183], v[72:75]
    buffer_store_dwordx4 v[112:115], v9, s[24:27], s83 offen offset:1024 sc1
    v_mfma_f32_16x16x32_bf16 v[60:63], v[40:43], v[176:179], v[60:63]
    s_barrier
    ds_read_b64_tr_b16 v[36:37], v6 offset:58368
    ds_read_b64_tr_b16 v[38:39], v6 offset:58880
    v_add_u32 v6, 131072, v6
    v_mfma_f32_16x16x32_bf16 v[76:79], v[40:43], v[180:183], v[76:79]
    buffer_load_dwordx4 v3, s[32:35], s22 offen offset:2048 lds
    v_lshrrev_b32 v27, 5, v0
    s_waitcnt lgkmcnt(4)
    v_mfma_f32_16x16x32_bf16 v[48:51], v[44:47], v[184:187], v[48:51]
    ds_read_b64_tr_b16 v[40:41], v5 offset:0
    ds_read_b64_tr_b16 v[42:43], v5 offset:512
    v_mfma_f32_16x16x32_bf16 v[64:67], v[44:47], v[188:191], v[64:67]
    v_and_b32 v26, 31, v0
    v_lshlrev_b32 v27, 2, v27
    v_sub_u32 v27, v26, v27
    v_cmp_le_i32 s[44:45], 0, v27
    v_mfma_f32_16x16x32_bf16 v[52:55], v[28:31], v[184:187], v[52:55]
    ds_read_b64_tr_b16 v[44:45], v6 offset:0
    ds_read_b64_tr_b16 v[46:47], v6 offset:512
    v_mfma_f32_16x16x32_bf16 v[68:71], v[28:31], v[188:191], v[68:71]
    buffer_load_dwordx4 v4, s[32:35], s22 offen offset:3072 lds
    v_cmp_le_i32 s[46:47], 1, v27
    v_cmp_le_i32 s[48:49], 2, v27
    v_cmp_le_i32 s[50:51], 3, v27
    s_waitcnt lgkmcnt(4)
    v_mfma_f32_16x16x32_bf16 v[56:59], v[32:35], v[184:187], v[56:59]
    ds_read_b64_tr_b16 v[28:29], v5 offset:1024
    ds_read_b64_tr_b16 v[30:31], v5 offset:1536
    v_mfma_f32_16x16x32_bf16 v[72:75], v[32:35], v[188:191], v[72:75]
    v_cmp_le_i32 s[52:53], 8, v27
    v_cmp_le_i32 s[54:55], 9, v27
    v_cmp_le_i32 s[56:57], 10, v27
    v_cmp_le_i32 s[58:59], 11, v27
    v_mfma_f32_16x16x32_bf16 v[60:63], v[36:39], v[184:187], v[60:63]
    s_mov_b32 s22, 65536
    s_add_u32 m0, s6, 65536
    ds_read_b64_tr_b16 v[32:33], v6 offset:1024
    ds_read_b64_tr_b16 v[34:35], v6 offset:1536
    v_mfma_f32_16x16x32_bf16 v[76:79], v[36:39], v[188:191], v[76:79]
    buffer_load_dwordx4 v1, s[32:35], s22 offen lds
    s_waitcnt lgkmcnt(4)
    v_mfma_f32_16x16x32_bf16 v[48:51], v[40:43], v[192:195], v[48:51]
    ds_read_b64_tr_b16 v[36:37], v5 offset:8192
    ds_read_b64_tr_b16 v[38:39], v5 offset:8704
    v_mfma_f32_16x16x32_bf16 v[64:67], v[40:43], v[196:199], v[64:67]
    v_cmp_le_i32 s[60:61], 16, v27
    v_cmp_le_i32 s[62:63], 17, v27
    v_cmp_le_i32 s[64:65], 18, v27
    v_cmp_le_i32 s[66:67], 19, v27
    v_mfma_f32_16x16x32_bf16 v[52:55], v[44:47], v[192:195], v[52:55]
    ds_read_b64_tr_b16 v[40:41], v6 offset:8192
    ds_read_b64_tr_b16 v[42:43], v6 offset:8704
    v_mfma_f32_16x16x32_bf16 v[68:71], v[44:47], v[196:199], v[68:71]
    buffer_load_dwordx4 v2, s[32:35], s22 offen offset:1024 lds
    v_cmp_le_i32 s[68:69], 24, v27
    v_cmp_le_i32 s[70:71], 25, v27
    v_cmp_le_i32 s[72:73], 26, v27
    s_waitcnt lgkmcnt(4)
    v_mfma_f32_16x16x32_bf16 v[56:59], v[28:31], v[192:195], v[56:59]
    ds_read_b64_tr_b16 v[44:45], v5 offset:9216
    ds_read_b64_tr_b16 v[46:47], v5 offset:9728
    v_mfma_f32_16x16x32_bf16 v[72:75], v[28:31], v[196:199], v[72:75]
    v_mov_b32 v101, s91
    v_writelane_b32 v101, s92, 1
    v_writelane_b32 v101, s93, 2
    v_writelane_b32 v101, s94, 3
    v_mfma_f32_16x16x32_bf16 v[60:63], v[32:35], v[192:195], v[60:63]
    s_barrier
    ds_read_b64_tr_b16 v[28:29], v6 offset:9216
    ds_read_b64_tr_b16 v[30:31], v6 offset:9728
    v_mfma_f32_16x16x32_bf16 v[76:79], v[32:35], v[196:199], v[76:79]
    buffer_load_dwordx4 v3, s[32:35], s22 offen offset:2048 lds
    v_writelane_b32 v101, s95, 4
    s_waitcnt lgkmcnt(4)
    v_mfma_f32_16x16x32_bf16 v[48:51], v[36:39], v[200:203], v[48:51]
    ds_read_b64_tr_b16 v[32:33], v5 offset:16384
    ds_read_b64_tr_b16 v[34:35], v5 offset:16896
    v_mfma_f32_16x16x32_bf16 v[64:67], v[36:39], v[204:207], v[64:67]
    v_cmp_le_i32 s[74:75], 27, v27
    s_lshl_b32 s8, s4, 10
    s_add_u32 s9, s8, 131072
    v_add_u32 v102, s9, v9
    v_mfma_f32_16x16x32_bf16 v[52:55], v[40:43], v[200:203], v[52:55]
    ds_read_b64_tr_b16 v[36:37], v6 offset:16384
    ds_read_b64_tr_b16 v[38:39], v6 offset:16896
    v_mfma_f32_16x16x32_bf16 v[68:71], v[40:43], v[204:207], v[68:71]
    buffer_load_dwordx4 v4, s[32:35], s22 offen offset:3072 lds
    v_and_b32 v103, 0xf0, v9
    v_lshrrev_b32 v27, 5, v0
    v_lshl_add_u32 v103, v27, 8, v103
    s_waitcnt lgkmcnt(4)
    v_mfma_f32_16x16x32_bf16 v[56:59], v[44:47], v[200:203], v[56:59]
    ds_read_b64_tr_b16 v[40:41], v5 offset:17408
    ds_read_b64_tr_b16 v[42:43], v5 offset:17920
    v_mfma_f32_16x16x32_bf16 v[72:75], v[44:47], v[204:207], v[72:75]
    buffer_load_dword v100, v101, s[24:27], 0 offen sc1
    v_and_b32 v8, 16, v0
    v_lshl_add_u32 v8, v8, 6, v103
    v_mfma_f32_16x16x32_bf16 v[60:63], v[28:31], v[200:203], v[60:63]
    ds_read_b64_tr_b16 v[44:45], v6 offset:17408
    ds_read_b64_tr_b16 v[46:47], v6 offset:17920
    v_mfma_f32_16x16x32_bf16 v[76:79], v[28:31], v[204:207], v[76:79]
    s_add_u32 s9, s8, 147456
    v_add_u32 v103, s9, v103
    v_mov_b32 v27, 0xffff
    v_mov_b32 v26, 0xff7fffff
    s_waitcnt lgkmcnt(4)
    v_mfma_f32_16x16x32_bf16 v[48:51], v[32:35], v[208:211], v[48:51]
    s_mov_b32 s22, 131072
    s_add_u32 m0, s6, 32768
    ds_read_b64_tr_b16 v[28:29], v5 offset:24576
    ds_read_b64_tr_b16 v[30:31], v5 offset:25088
    v_mfma_f32_16x16x32_bf16 v[64:67], v[32:35], v[212:215], v[64:67]
    buffer_load_dwordx4 v1, s[32:35], s22 offen lds
    s_waitcnt vmcnt(8)
    v_lshlrev_b32 v94, 2, v0
    v_mov_b32 v95, s5
    s_mov_b32 exec_hi, 0
    buffer_store_dword v95, v94, s[24:27], s86 offen sc1
    s_mov_b32 exec_hi, -1
    s_add_u32 s86, s86, 4096
    v_mfma_f32_16x16x32_bf16 v[52:55], v[36:39], v[208:211], v[52:55]
    ds_read_b64_tr_b16 v[32:33], v6 offset:24576
    ds_read_b64_tr_b16 v[34:35], v6 offset:25088
    v_mfma_f32_16x16x32_bf16 v[68:71], v[36:39], v[212:215], v[68:71]
    v_cndmask_b32 v120, 0, v27, s[44:45]
    v_cndmask_b32 v121, 0, v27, s[48:49]
    v_cndmask_b32 v122, 0, v27, s[52:53]
    v_cndmask_b32 v123, 0, v27, s[56:57]
    s_waitcnt lgkmcnt(4)
    v_mfma_f32_16x16x32_bf16 v[56:59], v[40:43], v[208:211], v[56:59]
    ds_read_b64_tr_b16 v[36:37], v5 offset:25600
    ds_read_b64_tr_b16 v[38:39], v5 offset:26112
    v_subrev_u32 v5, 131072, v5
    v_mfma_f32_16x16x32_bf16 v[72:75], v[40:43], v[212:215], v[72:75]
    buffer_load_dwordx4 v2, s[32:35], s22 offen offset:1024 lds
    v_cndmask_b32 v124, 0, v27, s[60:61]
    v_cndmask_b32 v125, 0, v27, s[64:65]
    v_cndmask_b32 v126, 0, v27, s[68:69]
    v_mfma_f32_16x16x32_bf16 v[60:63], v[44:47], v[208:211], v[60:63]
    s_barrier
    ds_read_b64_tr_b16 v[40:41], v6 offset:25600
    ds_read_b64_tr_b16 v[42:43], v6 offset:26112
    v_subrev_u32 v6, 131072, v6
    v_mfma_f32_16x16x32_bf16 v[76:79], v[44:47], v[212:215], v[76:79]
    v_cndmask_b32 v127, 0, v27, s[72:73]
    v_cndmask_b32 v120, v120, -1, s[46:47]
    s_waitcnt lgkmcnt(4)
    v_mfma_f32_16x16x32_bf16 v[48:51], v[28:31], v[216:219], v[48:51]
    ds_read_b64_tr_b16 v[44:45], v5 offset:0
    ds_read_b64_tr_b16 v[46:47], v5 offset:512
    v_mfma_f32_16x16x32_bf16 v[64:67], v[28:31], v[220:223], v[64:67]
    v_cndmask_b32 v121, v121, -1, s[50:51]
    v_cndmask_b32 v122, v122, -1, s[54:55]
    v_cndmask_b32 v123, v123, -1, s[58:59]
    v_cndmask_b32 v124, v124, -1, s[62:63]
    v_mfma_f32_16x16x32_bf16 v[52:55], v[32:35], v[216:219], v[52:55]
    s_add_u32 m0, s79, 32768
    ds_read_b64_tr_b16 v[28:29], v6 offset:0
    ds_read_b64_tr_b16 v[30:31], v6 offset:512
    v_mfma_f32_16x16x32_bf16 v[68:71], v[32:35], v[220:223], v[68:71]
    s_waitcnt vmcnt(3)
    v_cmp_ne_u32 vcc, s5, v100
    s_nop 0
    s_cbranch_vccz Lok_A_3
    s_mov_b32 s18, 0
Lsp_A_4:
    buffer_load_dword v100, v101, s[24:27], 0 offen sc1
    s_waitcnt vmcnt(0)
    v_cmp_ne_u32 vcc, s5, v100
    s_nop 0
    s_cbranch_vccz Lok_A_3
    s_add_u32 s18, s18, 1
    s_cmp_lt_u32 s18, 20000
    s_cbranch_scc1 Lsp_A_4
Lok_A_3:
    buffer_load_dwordx4 v9, s[24:27], s96 offen sc1 lds
    s_waitcnt lgkmcnt(4)
    v_mfma_f32_16x16x32_bf16 v[56:59], v[36:39], v[216:219], v[56:59]
    ds_read_b64_tr_b16 v[32:33], v5 offset:1024
    ds_read_b64_tr_b16 v[34:35], v5 offset:1536
    v_mfma_f32_16x16x32_bf16 v[72:75], v[36:39], v[220:223], v[72:75]
    v_cndmask_b32 v125, v125, -1, s[66:67]
    v_cndmask_b32 v126, v126, -1, s[70:71]
    v_cndmask_b32 v127, v127, -1, s[74:75]
    v_mov_b32 v104, 0x3f803f80
    v_mfma_f32_16x16x32_bf16 v[60:63], v[40:43], v[216:219], v[60:63]
    s_add_u32 m0, s79, 31744
    ds_read_b64_tr_b16 v[36:37], v6 offset:1024
    ds_read_b64_tr_b16 v[38:39], v6 offset:1536
    v_mfma_f32_16x16x32_bf16 v[76:79], v[40:43], v[220:223], v[76:79]
    buffer_load_dwordx4 v9, s[24:27], s96 offen offset:2048 sc1 lds
    v_mov_b32 v105, 0x3f803f80
    v_mov_b32 v106, 0x3f803f80
    s_waitcnt lgkmcnt(4)
    v_mfma_f32_16x16x32_bf16 v[48:51], v[44:47], v[224:227], v[48:51]
    ds_read_b64_tr_b16 v[40:41], v5 offset:8192
    ds_read_b64_tr_b16 v[42:43], v5 offset:8704
    v_mfma_f32_16x16x32_bf16 v[64:67], v[44:47], v[228:231], v[64:67]
    v_mov_b32 v107, 0x3f803f80
    v_mov_b32 v108, 0x3f803f80
    v_mov_b32 v109, 0x3f803f80
    v_mov_b32 v110, 0x3f803f80
    v_mfma_f32_16x16x32_bf16 v[52:55], v[28:31], v[224:227], v[52:55]
    ds_read_b64_tr_b16 v[44:45], v6 offset:8192
    ds_read_b64_tr_b16 v[46:47], v6 offset:8704
    v_mfma_f32_16x16x32_bf16 v[68:71], v[28:31], v[228:231], v[68:71]
    buffer_load_dwordx4 v[96:99], v9, s[24:27], s97 offen sc1
    v_mov_b32 v111, 0x3f803f80
    v_mov_b32 v112, 0x3f803f80
    v_mov_b32 v113, 0x3f803f80
    s_waitcnt lgkmcnt(4)
    v_mfma_f32_16x16x32_bf16 v[56:59], v[32:35], v[224:227], v[56:59]
    ds_read_b64_tr_b16 v[28:29], v5 offset:9216
    ds_read_b64_tr_b16 v[30:31], v5 offset:9728
    v_mfma_f32_16x16x32_bf16 v[72:75], v[32:35], v[228:231], v[72:75]
    v_mov_b32 v114, 0x3f803f80
    v_mov_b32 v115, 0x3f803f80
    v_mov_b32 v116, 0x3f803f80
    v_mov_b32 v117, 0x3f803f80
    v_mfma_f32_16x16x32_bf16 v[60:63], v[36:39], v[224:227], v[60:63]
    s_barrier
    s_add_u32 m0, s6, 32768
    ds_read_b64_tr_b16 v[32:33], v6 offset:9216
    ds_read_b64_tr_b16 v[34:35], v6 offset:9728
    v_mfma_f32_16x16x32_bf16 v[76:79], v[36:39], v[228:231], v[76:79]
    buffer_load_dwordx4 v3, s[32:35], s22 offen offset:2048 lds
    v_mov_b32 v118, 0x3f803f80
    s_waitcnt lgkmcnt(4)
    v_mfma_f32_16x16x32_bf16 v[48:51], v[40:43], v[232:235], v[48:51]
    ds_read_b64_tr_b16 v[36:37], v5 offset:16384
    ds_read_b64_tr_b16 v[38:39], v5 offset:16896
    v_mfma_f32_16x16x32_bf16 v[64:67], v[40:43], v[236:239], v[64:67]
    v_mov_b32 v119, 0x3f803f80
    v_mfma_f32_16x16x32_bf16 v[52:55], v[44:47], v[232:235], v[52:55]
    ds_read_b64_tr_b16 v[40:41], v6 offset:16384
    ds_read_b64_tr_b16 v[42:43], v6 offset:16896
    v_mfma_f32_16x16x32_bf16 v[68:71], v[44:47], v[236:239], v[68:71]
    buffer_load_dwordx4 v4, s[32:35], s22 offen offset:3072 lds
    s_waitcnt lgkmcnt(4)
    v_mfma_f32_16x16x32_bf16 v[56:59], v[28:31], v[232:235], v[56:59]
    s_add_u32 m0, s79, 49152
    ds_read_b64_tr_b16 v[44:45], v5 offset:17408
    ds_read_b64_tr_b16 v[46:47], v5 offset:17920
    v_mfma_f32_16x16x32_bf16 v[72:75], v[28:31], v[236:239], v[72:75]
    buffer_load_dwordx4 v9, s[24:27], s100 offen sc1 lds
    v_mfma_f32_16x16x32_bf16 v[60:63], v[32:35], v[232:235], v[60:63]
    ds_read_b64_tr_b16 v[28:29], v6 offset:17408
    ds_read_b64_tr_b16 v[30:31], v6 offset:17920
    v_mfma_f32_16x16x32_bf16 v[76:79], v[32:35], v[236:239], v[76:79]
    s_waitcnt lgkmcnt(4)
    v_mfma_f32_16x16x32_bf16 v[48:51], v[36:39], v[240:243], v[48:51]
    ds_read_b64_tr_b16 v[32:33], v5 offset:24576
    ds_read_b64_tr_b16 v[34:35], v5 offset:25088
    v_mfma_f32_16x16x32_bf16 v[64:67], v[36:39], v[244:247], v[64:67]
    v_mfma_f32_16x16x32_bf16 v[52:55], v[40:43], v[240:243], v[52:55]
    s_add_u32 m0, s79, 48128
    ds_read_b64_tr_b16 v[36:37], v6 offset:24576
    ds_read_b64_tr_b16 v[38:39], v6 offset:25088
    v_mfma_f32_16x16x32_bf16 v[68:71], v[40:43], v[244:247], v[68:71]
    buffer_load_dwordx4 v9, s[24:27], s100 offen offset:2048 sc1 lds
    s_waitcnt lgkmcnt(4)
    v_mfma_f32_16x16x32_bf16 v[56:59], v[44:47], v[240:243], v[56:59]
    ds_read_b64_tr_b16 v[40:41], v5 offset:25600
    ds_read_b64_tr_b16 v[42:43], v5 offset:26112
    v_mfma_f32_16x16x32_bf16 v[72:75], v[44:47], v[244:247], v[72:75]
    v_mfma_f32_16x16x32_bf16 v[60:63], v[28:31], v[240:243], v[60:63]
    s_barrier
    ds_read_b64_tr_b16 v[44:45], v6 offset:25600
    ds_read_b64_tr_b16 v[46:47], v6 offset:26112
    v_mfma_f32_16x16x32_bf16 v[76:79], v[28:31], v[244:247], v[76:79]
    s_waitcnt lgkmcnt(4)
    v_mfma_f32_16x16x32_bf16 v[48:51], v[32:35], v[248:251], v[48:51]
    v_mfma_f32_16x16x32_bf16 v[64:67], v[32:35], v[252:255], v[64:67]
    s_and_b32 s7, s4, 3
    s_mul_i32 s7, s7, 768
    v_min_u32 v101, 5, v0
    v_lshl_add_u32 v101, v101, 7, s7
    buffer_load_dword v100, v101, s[24:27], s14 offen sc1
    v_mfma_f32_16x16x32_bf16 v[52:55], v[36:39], v[248:251], v[52:55]
    v_mfma_f32_16x16x32_bf16 v[68:71], v[36:39], v[252:255], v[68:71]
    s_waitcnt lgkmcnt(0)
    v_mfma_f32_16x16x32_bf16 v[56:59], v[40:43], v[248:251], v[56:59]
    v_mfma_f32_16x16x32_bf16 v[72:75], v[40:43], v[252:255], v[72:75]
    v_mfma_f32_16x16x32_bf16 v[60:63], v[44:47], v[248:251], v[60:63]
    v_mfma_f32_16x16x32_bf16 v[76:79], v[44:47], v[252:255], v[76:79]
    s_nop 4
    v_pk_mul_f32 v[48:49], v[48:49], v[56:57]
    v_pk_mul_f32 v[50:51], v[50:51], v[58:59]
    v_pk_mul_f32 v[52:53], v[52:53], v[60:61]
    v_pk_mul_f32 v[54:55], v[54:55], v[62:63]
    v_cvt_pk_bf16_f32 v48, v48, v49
    v_cvt_pk_bf16_f32 v49, v50, v51
    v_cvt_pk_bf16_f32 v50, v52, v53
    v_cvt_pk_bf16_f32 v51, v54, v55
    buffer_store_dwordx4 v[48:51], v9, s[24:27], s85 offen sc1
    v_pk_mul_f32 v[64:65], v[64:65], v[72:73]
    v_pk_mul_f32 v[66:67], v[66:67], v[74:75]
    v_pk_mul_f32 v[68:69], v[68:69], v[76:77]
    v_pk_mul_f32 v[70:71], v[70:71], v[78:79]
    v_cvt_pk_bf16_f32 v64, v64, v65
    v_cvt_pk_bf16_f32 v65, v66, v67
    v_cvt_pk_bf16_f32 v66, v68, v69
    v_cvt_pk_bf16_f32 v67, v70, v71
    buffer_store_dwordx4 v[64:67], v9, s[24:27], s85 offen offset:1024 sc1
    s_branch L_att
L_V_PV:
    s_waitcnt vmcnt(7)
    s_barrier
    ds_read_b128 v[128:131], v1 offset:0
    ds_read_b64_tr_b16 v[28:29], v5 offset:0
    ds_read_b64_tr_b16 v[30:31], v5 offset:512
    ds_read_b128 v[132:135], v1 offset:4096
    ds_read_b64_tr_b16 v[32:33], v6 offset:0
    ds_read_b64_tr_b16 v[34:35], v6 offset:512
    ds_read_b128 v[136:139], v2 offset:0
    ds_read_b64_tr_b16 v[36:37], v5 offset:1024
    ds_read_b64_tr_b16 v[38:39], v5 offset:1536
    ds_read_b128 v[140:143], v2 offset:4096
    ds_read_b64_tr_b16 v[40:41], v6 offset:1024
    ds_read_b64_tr_b16 v[42:43], v6 offset:1536
    s_waitcnt lgkmcnt(6)
    v_mfma_f32_16x16x32_bf16 v[80:83], v[128:131], v[28:31], 0
    s_add_u32 m0, s78, 49152
    ds_read_b64_tr_b16 v[44:45], v5 offset:2048
    ds_read_b64_tr_b16 v[46:47], v5 offset:2560
    v_mfma_f32_16x16x32_bf16 v[88:91], v[132:135], v[28:31], 0
    buffer_load_dwordx4 v11, s[44:47], s65 offen lds
    s_add_u32 s66, s0, 589824
    s_cmp_ge_u32 s93, 5
    s_cselect_b32 s82, 1, 0
    s_mul_i32 s86, s82, 5
    s_sub_u32 s83, s93, s86
    v_mfma_f32_16x16x32_bf16 v[84:87], v[128:131], v[32:35], 0
    ds_read_b64_tr_b16 v[28:29], v6 offset:2048
    ds_read_b64_tr_b16 v[30:31], v6 offset:2560
    v_mfma_f32_16x16x32_bf16 v[92:95], v[132:135], v[32:35], 0
    buffer_load_dwordx4 v8, s[48:51], s72 offen offset:1024 lds
    s_add_u32 s73, s1, 688128
    s_sub_u32 s67, 786432, s0
    s_cmp_lt_u32 s94, 4
    s_cselect_b32 s86, 3, 1
    s_cmp_lt_u32 s83, s86
    s_cselect_b32 s9, 6, 7
    s_lshl_b32 s9, s9, 9
    s_waitcnt lgkmcnt(4)
    v_mfma_f32_16x16x32_bf16 v[96:99], v[36:39], v[128:131], 0
    ds_read_b64_tr_b16 v[32:33], v5 offset:12288
    ds_read_b64_tr_b16 v[34:35], v5 offset:12800
    v_mfma_f32_16x16x32_bf16 v[112:115], v[36:39], v[132:135], 0
    buffer_load_dwordx4 v8, s[52:55], s72 offen offset:2048 lds
    s_sub_u32 s74, 917504, s1
    s_add_u32 s68, s67, 196608
    s_lshl_b32 s86, s4, 5
    v_lshrrev_b32 v27, 3, v0
    v_add_u32 v25, s86, v27
    v_and_b32 v26, 7, v0
    v_mul_u32_u24 v25, s9, v25
    v_mfma_f32_16x16x32_bf16 v[100:103], v[40:43], v[128:131], 0
    s_add_u32 m0, s79, 32512
    ds_read_b64_tr_b16 v[36:37], v6 offset:12288
    ds_read_b64_tr_b16 v[38:39], v6 offset:12800
    v_mfma_f32_16x16x32_bf16 v[116:119], v[40:43], v[132:135], 0
    buffer_load_dwordx4 v10, s[28:31], s80 offen offset:256 lds
    s_add_u32 s75, s74, 229376
    v_lshl_add_u32 v25, v26, 4, v25
    s_cmp_ge_u32 s93, 10
    s_cselect_b32 s84, 2146435072, 0
    v_or_b32 v25, s84, v25
    s_mov_b64 s[20:21], s[44:45]
    s_waitcnt lgkmcnt(4)
    v_mfma_f32_16x16x32_bf16 v[104:107], v[44:47], v[128:131], 0
    ds_read_b64_tr_b16 v[40:41], v5 offset:13312
    ds_read_b64_tr_b16 v[42:43], v5 offset:13824
    v_mfma_f32_16x16x32_bf16 v[120:123], v[44:47], v[132:135], 0
    buffer_load_dwordx4 v10, s[28:31], s81 offen offset:1280 lds
    s_add_u32 s69, s67, 393216
    s_add_u32 s76, s74, 458752
    s_mov_b32 s22, 1837056
    s_mov_b32 s23, 0x20000
    s_cmp_eq_u32 s83, 1
    s_cselect_b64 s[20:21], s[48:49], s[20:21]
    v_mfma_f32_16x16x32_bf16 v[108:111], v[28:31], v[128:131], 0
    ds_read_b64_tr_b16 v[44:45], v6 offset:13312
    ds_read_b64_tr_b16 v[46:47], v6 offset:13824
    v_mfma_f32_16x16x32_bf16 v[124:127], v[28:31], v[132:135], 0
    s_add_u32 s70, s67, 589824
    s_add_u32 s77, s74, 688128
    s_add_u32 s71, s1, 229376
    s_cmp_eq_u32 s83, 2
    s_cselect_b64 s[20:21], s[52:53], s[20:21]
    s_cmp_eq_u32 s83, 3
    s_cselect_b64 s[20:21], s[56:57], s[20:21]
    s_waitcnt lgkmcnt(4)
    v_mfma_f32_16x16x32_bf16 v[80:83], v[136:139], v[32:35], v[80:83]
    s_waitcnt vmcnt(6)
    s_barrier
    ds_read_b64_tr_b16 v[28:29], v5 offset:14336
    ds_read_b64_tr_b16 v[30:31], v5 offset:14848
    v_mfma_f32_16x16x32_bf16 v[88:91], v[140:143], v[32:35], v[88:91]
    s_cmp_eq_u32 s83, 4
    s_cselect_b64 s[20:21], s[60:61], s[20:21]
    s_cmp_ge_u32 s83, 3
    s_cselect_b32 s11, 3, 0
    s_sub_u32 s11, s83, s11
    s_lshl_b32 s11, s11, 10
    v_mfma_f32_16x16x32_bf16 v[84:87], v[136:139], v[36:39], v[84:87]
    ds_read_b64_tr_b16 v[32:33], v6 offset:14336
    ds_read_b64_tr_b16 v[34:35], v6 offset:14848
    v_mfma_f32_16x16x32_bf16 v[92:95], v[140:143], v[36:39], v[92:95]
    ds_read_b128 v[144:147], v1 offset:16384
    s_mul_i32 s86, s9, s82
    s_lshl_b32 s86, s86, 8
    s_add_u32 s11, s11, s86
    s_lshl_b32 s9, s9, 3
    s_mul_i32 s88, s94, 5
    s_add_u32 s88, s88, s83
    s_lshl_b32 s88, s88, 9
    s_waitcnt lgkmcnt(5)
    v_mfma_f32_16x16x32_bf16 v[96:99], v[40:43], v[136:139], v[96:99]
    ds_read_b64_tr_b16 v[36:37], v5 offset:24576
    ds_read_b64_tr_b16 v[38:39], v5 offset:25088
    v_mfma_f32_16x16x32_bf16 v[112:115], v[40:43], v[140:143], v[112:115]
    ds_read_b128 v[148:151], v1 offset:20480
    buffer_load_dwordx4 v[64:67], v25, s[20:23], s11 offen
    s_add_u32 s11, s11, s9
    s_mul_i32 s86, s82, 40960
    s_add_u32 s88, s88, s86
    s_add_u32 s88, s88, 131072
    v_and_b32 v23, 1, v27
    v_lshl_add_u32 v22, v26, 1, v23
    v_mfma_f32_16x16x32_bf16 v[100:103], v[44:47], v[136:139], v[100:103]
    ds_read_b64_tr_b16 v[40:41], v6 offset:24576
    ds_read_b64_tr_b16 v[42:43], v6 offset:25088
    v_mfma_f32_16x16x32_bf16 v[116:119], v[44:47], v[140:143], v[116:119]
    ds_read_b128 v[152:155], v2 offset:16384
    buffer_load_dwordx4 v[68:71], v25, s[20:23], s11 offen
    s_add_u32 s11, s11, s9
    v_mov_b32 v56, 0x3f803f80
    v_mov_b32 v57, 0x3f803f80
    v_bfe_u32 v23, v0, 4, 1
    v_lshl_add_u32 v22, v22, 1, v23
    v_lshrrev_b32 v23, 5, v0
    s_waitcnt lgkmcnt(7)
    v_mfma_f32_16x16x32_bf16 v[104:107], v[28:31], v[136:139], v[104:107]
    ds_read_b64_tr_b16 v[44:45], v5 offset:25600
    ds_read_b64_tr_b16 v[46:47], v5 offset:26112
    v_mfma_f32_16x16x32_bf16 v[120:123], v[28:31], v[140:143], v[120:123]
    ds_read_b128 v[156:159], v2 offset:20480
    buffer_load_dwordx4 v[72:75], v25, s[20:23], s11 offen
    s_add_u32 s11, s11, s9
    s_waitcnt vmcnt(8)
    v_readfirstlane_b32 s5, v60
    v_lshl_add_u32 v22, v22, 1, v23
    s_lshl_b32 s86, s4, 8
    s_add_u32 s86, s86, 147456
    v_lshl_add_u32 v22, v22, 2, s86
    v_mfma_f32_16x16x32_bf16 v[108:111], v[32:35], v[136:139], v[108:111]
    ds_read_b64_tr_b16 v[28:29], v6 offset:25600
    ds_read_b64_tr_b16 v[30:31], v6 offset:26112
    v_mfma_f32_16x16x32_bf16 v[124:127], v[32:35], v[140:143], v[124:127]
    buffer_load_dwordx4 v[76:79], v25, s[20:23], s11 offen
    s_mov_b32 s20, 0x0000ffff
    s_mov_b32 s21, 0x0000ffff
    v_mfma_f32_4x4x4_16b_bf16 v[52:55], v[56:57], v[48:49], 0
    s_mul_i32 s5, s5, 0x9E3779B1
    s_lshl_b32 s86, s4, 3
    v_add_u32 v26, s86, v26
    v_lshlrev_b32 v24, 3, v26
    v_lshl_add_u32 v24, v27, 28, v24
    s_waitcnt lgkmcnt(6)
    v_mfma_f32_16x16x32_bf16 v[80:83], v[144:147], v[36:39], v[80:83]
    ds_read_b64_tr_b16 v[32:33], v5 offset:26624
    ds_read_b64_tr_b16 v[34:35], v5 offset:27136
    v_mfma_f32_16x16x32_bf16 v[88:91], v[148:151], v[36:39], v[88:91]
    v_and_b32 v20, 0x30, v9
    s_mov_b64 vcc, 0x3f80
    v_lshlrev_b64 v[20:21], v20, vcc
    v_or_b32 v24, s84, v24
    v_lshlrev_b32 v27, 8, v27
    v_lshl_add_u32 v23, v26, 2, v27
    v_add_u32 v23, 147456, v23
    s_lshl_b32 s8, s91, 2
    s_lshr_b32 s3, s92, 3
    s_add_u32 s8, s8, s3
    v_mfma_f32_16x16x32_bf16 v[84:87], v[144:147], v[40:43], v[84:87]
    s_add_u32 m0, s78, 73728
    ds_read_b64_tr_b16 v[36:37], v6 offset:26624
    ds_read_b64_tr_b16 v[38:39], v6 offset:27136
    v_mfma_f32_16x16x32_bf16 v[92:95], v[148:151], v[40:43], v[92:95]
    buffer_load_dwordx4 v11, s[44:47], s66 offen lds
    v_mfma_f32_4x4x4_16b_bf16 v[52:55], v[56:57], v[50:51], v[52:55]
    s_add_u32 s5, s5, 0x7F4A7C15
    s_lshl_b32 s8, s8, 1
    s_lshr_b32 s19, s4, 2
    s_add_u32 s8, s8, s19
    s_and_b32 s9, s92, 7
    s_lshl_b32 s9, s9, 7
    s_lshl_b32 s11, s19, 15
    s_waitcnt lgkmcnt(4)
    v_mfma_f32_16x16x32_bf16 v[96:99], v[44:47], v[144:147], v[96:99]
    ds_read_b64_tr_b16 v[40:41], v5 offset:36864
    ds_read_b64_tr_b16 v[42:43], v5 offset:37376
    v_mfma_f32_16x16x32_bf16 v[112:115], v[44:47], v[148:151], v[112:115]
    v_add_f32_dpp v52, v52, v52 row_ror:1 row_mask:0xf bank_mask:0xf
    s_nop 1
    v_add_f32_dpp v52, v52, v52 row_ror:2 row_mask:0xf bank_mask:0xf
    s_add_u32 s11, s11, s9
    s_and_b32 s16, s4, 3
    s_lshl_b32 s22, s16, 17
    s_add_u32 s22, s22, s11
    s_add_u32 s36, s36, s22
    s_addc_u32 s37, s37, 0
    s_sub_u32 s38, 524288, s22
    s_mov_b32 s39, 0x20000
    v_mfma_f32_16x16x32_bf16 v[100:103], v[28:31], v[144:147], v[100:103]
    ds_read_b64_tr_b16 v[44:45], v6 offset:36864
    ds_read_b64_tr_b16 v[46:47], v6 offset:37376
    v_mfma_f32_16x16x32_bf16 v[116:119], v[28:31], v[148:151], v[116:119]
    buffer_load_dwordx4 v8, s[48:51], s73 offen offset:1024 lds
    v_add_f32_dpp v52, v52, v52 row_ror:4 row_mask:0xf bank_mask:0xf
    s_nop 1
    v_add_f32_dpp v52, v52, v52 row_ror:8 row_mask:0xf bank_mask:0xf
    s_mul_i32 s22, s16, 458752
    s_add_u32 s22, s22, s11
    s_add_u32 s32, s32, s22
    s_addc_u32 s33, s33, 0
    s_sub_u32 s34, 1835008, s22
    s_mov_b32 s35, 0x20000
    s_lshl_b32 s6, s16, 13
    s_waitcnt lgkmcnt(4)
    v_mfma_f32_16x16x32_bf16 v[104:107], v[32:35], v[144:147], v[104:107]
    ds_read_b64_tr_b16 v[28:29], v5 offset:37888
    ds_read_b64_tr_b16 v[30:31], v5 offset:38400
    v_mfma_f32_16x16x32_bf16 v[120:123], v[32:35], v[148:151], v[120:123]
    v_mov_b32 v56, v52
    s_nop 1
    v_permlane16_swap_b32 v52, v56
    v_add_f32 v52, v52, v56
    s_lshl_b32 s3, s19, 12
    s_add_u32 s6, s6, s3
    s_mul_i32 s17, s8, 147456
    s_mul_i32 s3, s16, 28672
    s_add_u32 s17, s17, s3
    s_add_u32 s17, s17, 7340032
    s_lshl_b32 s14, s8, 14
    v_mfma_f32_16x16x32_bf16 v[108:111], v[36:39], v[144:147], v[108:111]
    ds_read_b64_tr_b16 v[32:33], v6 offset:37888
    ds_read_b64_tr_b16 v[34:35], v6 offset:38400
    v_mfma_f32_16x16x32_bf16 v[124:127], v[36:39], v[148:151], v[124:127]
    buffer_load_dwordx4 v8, s[52:55], s73 offen offset:2048 lds
    v_mov_b32 v56, v52
    s_nop 1
    v_permlane32_swap_b32 v52, v56
    v_add_f32 v52, v52, v56
    v_mul_f32 v60, 0xbb000000, v52
    s_add_u32 s14, s14, 16782336
    s_lshl_b32 s15, s8, 2
    s_add_u32 s15, s15, s16
    s_lshl_b32 s15, s15, 10
    s_add_u32 s15, s15, 17825792
    s_waitcnt lgkmcnt(4)
    v_mfma_f32_16x16x32_bf16 v[80:83], v[152:155], v[40:43], v[80:83]
    s_waitcnt vmcnt(7)
    s_barrier
    ds_read_b64_tr_b16 v[36:37], v5 offset:38912
    ds_read_b64_tr_b16 v[38:39], v5 offset:39424
    v_mfma_f32_16x16x32_bf16 v[88:91], v[156:159], v[40:43], v[88:91]
    v_mul_f32 v61, 0xbb000000, v52
    v_mov_b64 v[62:63], v[60:61]
    s_lshr_b32 s3, s8, 1
    s_lshl_b32 s3, s3, 3
    s_add_u32 s3, s3, s4
    s_lshl_b32 s13, s3, 13
    s_add_u32 s13, s13, s9
    s_lshl_b32 s23, s3, 7
    v_mfma_f32_16x16x32_bf16 v[84:87], v[152:155], v[44:47], v[84:87]
    s_add_u32 m0, s79, -384
    ds_read_b64_tr_b16 v[40:41], v6 offset:38912
    ds_read_b64_tr_b16 v[42:43], v6 offset:39424
    v_mfma_f32_16x16x32_bf16 v[92:95], v[156:159], v[44:47], v[92:95]
    buffer_load_dwordx4 v10, s[28:31], s80 offen offset:384 lds
    ds_read_b128 v[160:163], v1 offset:32768
    v_mfma_f32_4x4x4_16b_bf16 v[52:55], v[20:21], v[48:49], v[60:63]
    v_mfma_f32_4x4x4_16b_bf16 v[56:59], v[20:21], v[50:51], v[60:63]
    s_waitcnt vmcnt(4)
    v_mfma_f32_4x4x4_16b_bf16 v[12:15], v[20:21], v[64:65], 0
    v_mfma_f32_4x4x4_16b_bf16 v[16:19], v[20:21], v[66:67], 0
    s_add_u32 s23, s23, 65544
    s_lshl_b32 s8, s93, 2
    s_add_u32 s8, s8, s16
    s_waitcnt lgkmcnt(5)
    v_mfma_f32_16x16x32_bf16 v[96:99], v[28:31], v[152:155], v[96:99]
    ds_read_b64_tr_b16 v[44:45], v3 offset:0
    ds_read_b64_tr_b16 v[46:47], v3 offset:512
    v_mfma_f32_16x16x32_bf16 v[112:115], v[28:31], v[156:159], v[112:115]
    ds_read_b128 v[164:167], v1 offset:36864
    v_mul_f32 v50, v52, v52
    v_mul_f32 v51, v53, v53
    v_fmac_f32 v50, v54, v54
    v_fmac_f32 v51, v55, v55
    v_mfma_f32_4x4x4_16b_bf16 v[12:15], v[20:21], v[68:69], v[12:15]
    v_mfma_f32_4x4x4_16b_bf16 v[16:19], v[20:21], v[70:71], v[16:19]
    s_lshl_b32 s89, s8, 9
    s_add_u32 s89, s89, 65536
    s_mul_i32 s90, s94, 2560
    v_mfma_f32_16x16x32_bf16 v[100:103], v[32:35], v[152:155], v[100:103]
    ds_read_b64_tr_b16 v[28:29], v4 offset:0
    ds_read_b64_tr_b16 v[30:31], v4 offset:512
    v_mfma_f32_16x16x32_bf16 v[116:119], v[32:35], v[156:159], v[116:119]
    buffer_load_dwordx4 v10, s[28:31], s81 offen offset:1408 lds
    ds_read_b128 v[168:171], v2 offset:32768
    v_fmac_f32 v50, v56, v56
    v_fmac_f32 v51, v57, v57
    v_fmac_f32 v50, v58, v58
    v_mfma_f32_4x4x4_16b_bf16 v[12:15], v[20:21], v[72:73], v[12:15]
    v_mfma_f32_4x4x4_16b_bf16 v[16:19], v[20:21], v[74:75], v[16:19]
    s_lshl_b32 s9, s19, 8
    s_add_u32 s90, s90, s9
    s_add_u32 s90, s90, 131072
    s_waitcnt lgkmcnt(7)
    v_mfma_f32_16x16x32_bf16 v[104:107], v[36:39], v[152:155], v[104:107]
    ds_read_b64_tr_b16 v[32:33], v3 offset:1024
    ds_read_b64_tr_b16 v[34:35], v3 offset:1536
    v_mfma_f32_16x16x32_bf16 v[120:123], v[36:39], v[156:159], v[120:123]
    ds_read_b128 v[172:175], v2 offset:36864
    v_fmac_f32 v51, v59, v59
    v_add_f32 v50, v50, v51
    v_mfma_f32_4x4x4_16b_bf16 v[12:15], v[20:21], v[76:77], v[12:15]
    v_mfma_f32_4x4x4_16b_bf16 v[16:19], v[20:21], v[78:79], v[16:19]
    s_bfe_u32 s9, s95, 0x30007
    s_lshl_b32 s9, s9, 1
    s_add_u32 s9, s9, s19
    s_lshl_b32 s9, s9, 17
    s_lshl_b32 s11, s8, 11
    v_mfma_f32_16x16x32_bf16 v[108:111], v[40:43], v[152:155], v[108:111]
    s_mov_b32 m0, s78
    ds_read_b64_tr_b16 v[36:37], v4 offset:1024
    ds_read_b64_tr_b16 v[38:39], v4 offset:1536
    v_mfma_f32_16x16x32_bf16 v[124:127], v[40:43], v[156:159], v[124:127]
    buffer_load_dwordx4 v11, s[44:47], s67 offen lds
    v_add_f32_dpp v50, v50, v50 row_ror:1 row_mask:0xf bank_mask:0xf
    s_nop 1
    v_add_f32_dpp v50, v50, v50 row_ror:2 row_mask:0xf bank_mask:0xf
    v_and_b32 v64, 8, v0
    s_add_u32 s9, s9, s11
    s_lshr_b32 s11, s95, 10
    s_lshl_b32 s11, s11, 21
    s_add_u32 s82, s9, s11
    s_add_u32 s82, s82, 1048576
    s_waitcnt lgkmcnt(6)
    v_mfma_f32_16x16x32_bf16 v[80:83], v[160:163], v[44:47], v[80:83]
    ds_read_b64_tr_b16 v[40:41], v3 offset:2048
    ds_read_b64_tr_b16 v[42:43], v3 offset:2560
    v_mfma_f32_16x16x32_bf16 v[88:91], v[164:167], v[44:47], v[88:91]
    v_add_f32_dpp v50, v50, v50 row_ror:4 row_mask:0xf bank_mask:0xf
    s_nop 1
    v_add_f32_dpp v50, v50, v50 row_ror:8 row_mask:0xf bank_mask:0xf
    v_permlane32_swap_b32 v12, v13
    v_permlane32_swap_b32 v14, v15
    v_permlane32_swap_b32 v16, v17
    v_permlane32_swap_b32 v18, v19
    v_add_f32 v12, v12, v13
    v_add_f32 v14, v14, v15
    s_add_u32 s84, s9, 786432
    s_and_b32 s84, s84, 1048575
    v_mfma_f32_16x16x32_bf16 v[84:87], v[160:163], v[28:31], v[84:87]
    ds_read_b64_tr_b16 v[44:45], v4 offset:2048
    ds_read_b64_tr_b16 v[46:47], v4 offset:2560
    v_mfma_f32_16x16x32_bf16 v[92:95], v[164:167], v[28:31], v[92:95]
    buffer_load_dwordx4 v8, s[48:51], s74 offen offset:1024 lds
    v_mov_b32 v49, v50
    s_nop 1
    v_permlane16_swap_b32 v50, v49
    v_add_f32 v50, v50, v49
    v_add_f32 v16, v16, v17
    v_add_f32 v18, v18, v19
    v_cmp_eq_u32 vcc, 0, v64
    s_add_u32 s84, s84, 3145728
    s_xor_b32 s9, s9, 524288
    s_add_u32 s9, s9, 1048576
    s_waitcnt lgkmcnt(4)
    v_mfma_f32_16x16x32_bf16 v[96:99], v[32:35], v[160:163], v[96:99]
    ds_read_b64_tr_b16 v[28:29], v3 offset:12288
    ds_read_b64_tr_b16 v[30:31], v3 offset:12800
    v_mfma_f32_16x16x32_bf16 v[112:115], v[32:35], v[164:167], v[112:115]
    v_mov_b32 v49, v50
    s_nop 1
    v_permlane32_swap_b32 v50, v49
    v_add_f32 v50, v50, v49
    v_mov_b32 v49, 0x3727c5ac
    v_fmac_f32 v49, 0x3b000000, v50
    v_permlane16_swap_b32 v12, v14
    v_permlane16_swap_b32 v16, v18
    v_add_f32 v12, v12, v14
    s_mul_i32 s11, s8, 147456
    s_lshl_b32 s22, s19, 11
    v_mfma_f32_16x16x32_bf16 v[100:103], v[36:39], v[160:163], v[100:103]
    ds_read_b64_tr_b16 v[32:33], v4 offset:12288
    ds_read_b64_tr_b16 v[34:35], v4 offset:12800
    v_mfma_f32_16x16x32_bf16 v[116:119], v[36:39], v[164:167], v[116:119]
    buffer_load_dwordx4 v8, s[52:55], s74 offen offset:2048 lds
    v_rsq_f32 v54, v49
    v_mov_b32 v52, v60
    v_mov_b32 v53, s5
    v_mov_b32 v55, s5
    v_add_f32 v16, v16, v18
    s_add_u32 s11, s11, s22
    s_add_u32 s11, s11, 7340032
    s_lshl_b32 s85, s85, 12
    s_add_u32 s85, s85, s11
    s_waitcnt lgkmcnt(4)
    v_mfma_f32_16x16x32_bf16 v[104:107], v[40:43], v[160:163], v[104:107]
    ds_read_b64_tr_b16 v[36:37], v3 offset:13312
    ds_read_b64_tr_b16 v[38:39], v3 offset:13824
    v_mfma_f32_16x16x32_bf16 v[120:123], v[40:43], v[164:167], v[120:123]
    s_cmp_eq_u32 s2, 4
    s_cselect_b32 s7, 1024, 0
    v_subrev_u32 v10, s7, v10
    v_add_f32_dpp v12, v12, v12 row_ror:8 row_mask:0xf bank_mask:0xf
    v_add_f32_dpp v16, v16, v16 row_ror:8 row_mask:0xf bank_mask:0xf
    v_cndmask_b32 v12, v16, v12, vcc
    ds_write_b32 v22, v12
    s_lshl_b32 s100, s100, 12
    s_add_u32 s11, s11, s100
    v_mfma_f32_16x16x32_bf16 v[108:111], v[44:47], v[160:163], v[108:111]
    s_add_u32 m0, s79, 15872
    ds_read_b64_tr_b16 v[40:41], v4 offset:13312
    ds_read_b64_tr_b16 v[42:43], v4 offset:13824
    v_mfma_f32_16x16x32_bf16 v[124:127], v[44:47], v[164:167], v[124:127]
    buffer_load_dwordx4 v10, s[28:31], s80 offen offset:512 lds
    s_mov_b64 exec, 1
    buffer_store_dwordx4 v[52:55], off, s[24:27], s87 sc1
    s_mov_b64 exec, -1
    s_cmp_lt_u32 s94, 4
    s_cselect_b32 s83, s9, s11
    s_lshl_b32 s86, s8, 7
    s_lshl_b32 s9, s94, 1
    s_add_u32 s9, s9, s19
    s_waitcnt lgkmcnt(5)
    v_mfma_f32_16x16x32_bf16 v[80:83], v[168:171], v[28:31], v[80:83]
    s_waitcnt vmcnt(5) lgkmcnt(2)
    s_barrier
    ds_read_b64_tr_b16 v[44:45], v3 offset:14336
    ds_read_b64_tr_b16 v[46:47], v3 offset:14848
    v_mfma_f32_16x16x32_bf16 v[88:91], v[172:175], v[28:31], v[88:91]
    ds_read_b32 v12, v23
    s_add_u32 s86, s86, s9
    s_lshl_b32 s86, s86, 7
    s_add_u32 s86, s86, 16777216
    v_mfma_f32_16x16x32_bf16 v[84:87], v[168:171], v[32:35], v[84:87]
    ds_read_b64_tr_b16 v[28:29], v4 offset:14336
    ds_read_b64_tr_b16 v[30:31], v4 offset:14848
    v_mfma_f32_16x16x32_bf16 v[92:95], v[172:175], v[32:35], v[92:95]
    buffer_load_dwordx4 v10, s[28:31], s81 offen offset:1536 lds
    ds_read_b128 v[176:179], v1 offset:0
    s_and_b32 s8, s92, 3
    s_waitcnt lgkmcnt(6)
    v_mfma_f32_16x16x32_bf16 v[96:99], v[36:39], v[168:171], v[96:99]
    ds_read_b64_tr_b16 v[32:33], v3 offset:24576
    ds_read_b64_tr_b16 v[34:35], v3 offset:25088
    v_mfma_f32_16x16x32_bf16 v[112:115], v[36:39], v[172:175], v[112:115]
    ds_read_b128 v[180:183], v1 offset:4096
    s_lshl_b32 s22, s91, 2
    s_add_u32 s8, s8, s22
    v_mfma_f32_16x16x32_bf16 v[100:103], v[40:43], v[168:171], v[100:103]
    s_add_u32 m0, s78, 24576
    ds_read_b64_tr_b16 v[36:37], v4 offset:24576
    ds_read_b64_tr_b16 v[38:39], v4 offset:25088
    v_mfma_f32_16x16x32_bf16 v[116:119], v[40:43], v[172:175], v[116:119]
    buffer_load_dwordx4 v11, s[44:47], s68 offen lds
    ds_read_b128 v[184:187], v2 offset:0
    s_waitcnt lgkmcnt(9)
    v_mov_b32 v13, v12
    s_waitcnt lgkmcnt(7)
    v_mfma_f32_16x16x32_bf16 v[104:107], v[44:47], v[168:171], v[104:107]
    ds_read_b64_tr_b16 v[40:41], v3 offset:25600
    ds_read_b64_tr_b16 v[42:43], v3 offset:26112
    v_mfma_f32_16x16x32_bf16 v[120:123], v[44:47], v[172:175], v[120:123]
    ds_read_b128 v[188:191], v2 offset:4096
    v_permlane32_swap_b32 v12, v13
    v_add_f32 v12, v12, v13
    v_mov_b32 v13, v12
    v_mfma_f32_16x16x32_bf16 v[108:111], v[28:31], v[168:171], v[108:111]
    ds_read_b64_tr_b16 v[44:45], v4 offset:25600
    ds_read_b64_tr_b16 v[46:47], v4 offset:26112
    v_mfma_f32_16x16x32_bf16 v[124:127], v[28:31], v[172:175], v[124:127]
    buffer_load_dwordx4 v8, s[48:51], s75 offen offset:1024 lds
    v_permlane16_swap_b32 v12, v13
    v_add_f32 v12, v12, v13
    v_mov_b32 v15, s5
    s_waitcnt lgkmcnt(6)
    v_mfma_f32_16x16x32_bf16 v[80:83], v[176:179], v[32:35], v[80:83]
    ds_read_b64_tr_b16 v[28:29], v3 offset:26624
    ds_read_b64_tr_b16 v[30:31], v3 offset:27136
    v_mfma_f32_16x16x32_bf16 v[88:91], v[180:183], v[32:35], v[88:91]
    v_add_f32_dpp v14, v12, v12 row_ror:8 row_mask:0xf bank_mask:0xf
    buffer_store_dwordx2 v[14:15], v24, s[24:27], s88 offen sc1
    v_mfma_f32_16x16x32_bf16 v[84:87], v[176:179], v[36:39], v[84:87]
    ds_read_b64_tr_b16 v[32:33], v4 offset:26624
    ds_read_b64_tr_b16 v[34:35], v4 offset:27136
    v_mfma_f32_16x16x32_bf16 v[92:95], v[180:183], v[36:39], v[92:95]
    buffer_load_dwordx4 v8, s[52:55], s75 offen offset:2048 lds
    v_and_b32 v49, 31, v0
    v_lshlrev_b32 v49, 3, v49
    s_waitcnt lgkmcnt(4)
    v_mfma_f32_16x16x32_bf16 v[96:99], v[40:43], v[176:179], v[96:99]
    ds_read_b64_tr_b16 v[36:37], v3 offset:36864
    ds_read_b64_tr_b16 v[38:39], v3 offset:37376
    v_mfma_f32_16x16x32_bf16 v[112:115], v[40:43], v[180:183], v[112:115]
    v_and_b32 v48, 0xf0, v9
    v_lshrrev_b32 v50, 5, v0
    v_lshl_add_u32 v48, v50, 8, v48
    v_mfma_f32_16x16x32_bf16 v[100:103], v[44:47], v[176:179], v[100:103]
    s_add_u32 m0, s79, 32128
    ds_read_b64_tr_b16 v[40:41], v4 offset:36864
    ds_read_b64_tr_b16 v[42:43], v4 offset:37376
    v_mfma_f32_16x16x32_bf16 v[116:119], v[44:47], v[180:183], v[116:119]
    buffer_load_dwordx4 v10, s[28:31], s80 offen offset:640 lds
    v_mul_u32_u24 v50, 40960, v50
    s_waitcnt lgkmcnt(4)
    v_mfma_f32_16x16x32_bf16 v[104:107], v[28:31], v[176:179], v[104:107]
    ds_read_b64_tr_b16 v[44:45], v3 offset:37888
    ds_read_b64_tr_b16 v[46:47], v3 offset:38400
    v_mfma_f32_16x16x32_bf16 v[120:123], v[28:31], v[180:183], v[120:123]
    v_add_u32 v49, v49, v50
    v_lshrrev_b32 v51, 4, v0
    v_lshlrev_b32 v51, 10, v51
    v_mfma_f32_16x16x32_bf16 v[108:111], v[32:35], v[176:179], v[108:111]
    ds_read_b64_tr_b16 v[28:29], v4 offset:37888
    ds_read_b64_tr_b16 v[30:31], v4 offset:38400
    v_mfma_f32_16x16x32_bf16 v[124:127], v[32:35], v[180:183], v[124:127]
    buffer_load_dwordx4 v10, s[28:31], s81 offen offset:1664 lds
    s_lshr_b32 s19, s92, 2
    s_lshl_b32 s19, s19, 3
    s_waitcnt lgkmcnt(4)
    v_mfma_f32_16x16x32_bf16 v[80:83], v[184:187], v[36:39], v[80:83]
    s_waitcnt vmcnt(6)
    s_barrier
    ds_read_b64_tr_b16 v[32:33], v3 offset:38912
    ds_read_b64_tr_b16 v[34:35], v3 offset:39424
    v_mfma_f32_16x16x32_bf16 v[88:91], v[188:191], v[36:39], v[88:91]
    s_lshl_b32 s9, s4, 1
    v_mfma_f32_16x16x32_bf16 v[84:87], v[184:187], v[40:43], v[84:87]
    s_add_u32 m0, s78, 49152
    ds_read_b64_tr_b16 v[36:37], v4 offset:38912
    ds_read_b64_tr_b16 v[38:39], v4 offset:39424
    v_mfma_f32_16x16x32_bf16 v[92:95], v[188:191], v[40:43], v[92:95]
    buffer_load_dwordx4 v11, s[44:47], s69 offen lds
    ds_read_b128 v[192:195], v1 offset:16384
    s_waitcnt lgkmcnt(5)
    v_mfma_f32_16x16x32_bf16 v[96:99], v[44:47], v[184:187], v[96:99]
    ds_read_b64_tr_b16 v[40:41], v5 offset:0
    ds_read_b64_tr_b16 v[42:43], v5 offset:512
    v_mfma_f32_16x16x32_bf16 v[112:115], v[44:47], v[188:191], v[112:115]
    ds_read_b128 v[196:199], v1 offset:20480
    s_add_u32 s9, s9, s19
    s_add_u32 s19, s19, s4
    v_mfma_f32_16x16x32_bf16 v[100:103], v[28:31], v[184:187], v[100:103]
    ds_read_b64_tr_b16 v[44:45], v6 offset:0
    ds_read_b64_tr_b16 v[46:47], v6 offset:512
    v_mfma_f32_16x16x32_bf16 v[116:119], v[28:31], v[188:191], v[116:119]
    buffer_load_dwordx4 v8, s[48:51], s76 offen offset:1024 lds
    ds_read_b128 v[200:203], v2 offset:16384
    s_waitcnt lgkmcnt(7)
    v_mfma_f32_16x16x32_bf16 v[104:107], v[32:35], v[184:187], v[104:107]
    ds_read_b64_tr_b16 v[28:29], v5 offset:1024
    ds_read_b64_tr_b16 v[30:31], v5 offset:1536
    v_mfma_f32_16x16x32_bf16 v[120:123], v[32:35], v[188:191], v[120:123]
    ds_read_b128 v[204:207], v2 offset:20480
    s_cmp_lt_u32 s9, 8
    s_cselect_b32 s22, 0, 8
    v_mfma_f32_16x16x32_bf16 v[108:111], v[36:39], v[184:187], v[108:111]
    ds_read_b64_tr_b16 v[32:33], v6 offset:1024
    ds_read_b64_tr_b16 v[34:35], v6 offset:1536
    v_mfma_f32_16x16x32_bf16 v[124:127], v[36:39], v[188:191], v[124:127]
    buffer_load_dwordx4 v8, s[52:55], s76 offen offset:2048 lds
    s_sub_u32 s9, s9, s22
    s_mul_i32 s3, s19, 144
    s_waitcnt lgkmcnt(6)
    v_mfma_f32_16x16x32_bf16 v[80:83], v[192:195], v[40:43], v[80:83]
    ds_read_b64_tr_b16 v[36:37], v5 offset:2048
    ds_read_b64_tr_b16 v[38:39], v5 offset:2560
    v_mfma_f32_16x16x32_bf16 v[88:91], v[196:199], v[40:43], v[88:91]
    s_add_u32 s3, s3, s8
    s_lshl_b32 s3, s3, 10
    s_add_u32 s3, s3, 7454720
    v_mfma_f32_16x16x32_bf16 v[84:87], v[192:195], v[44:47], v[84:87]
    s_add_u32 m0, s79, -768
    ds_read_b64_tr_b16 v[40:41], v6 offset:2048
    ds_read_b64_tr_b16 v[42:43], v6 offset:2560
    v_mfma_f32_16x16x32_bf16 v[92:95], v[196:199], v[44:47], v[92:95]
    buffer_load_dwordx4 v10, s[28:31], s80 offen offset:768 lds
    s_and_b32 s22, s8, 1
    s_waitcnt lgkmcnt(4)
    v_mfma_f32_16x16x32_bf16 v[96:99], v[28:31], v[192:195], v[96:99]
    ds_read_b64_tr_b16 v[44:45], v5 offset:12288
    ds_read_b64_tr_b16 v[46:47], v5 offset:12800
    v_mfma_f32_16x16x32_bf16 v[112:115], v[28:31], v[196:199], v[112:115]
    s_lshl_b32 s22, s22, 9
    s_sub_u32 s3, s3, s22
    s_lshl_b32 s16, s19, 5
    v_mfma_f32_16x16x32_bf16 v[100:103], v[32:35], v[192:195], v[100:103]
    ds_read_b64_tr_b16 v[28:29], v6 offset:12288
    ds_read_b64_tr_b16 v[30:31], v6 offset:12800
    v_mfma_f32_16x16x32_bf16 v[116:119], v[32:35], v[196:199], v[116:119]
    buffer_load_dwordx4 v10, s[28:31], s81 offen offset:1792 lds
    s_add_u32 s16, s16, s8
    s_lshl_b32 s16, s16, 7
    s_waitcnt lgkmcnt(4)
    v_mfma_f32_16x16x32_bf16 v[104:107], v[36:39], v[192:195], v[104:107]
    ds_read_b64_tr_b16 v[32:33], v5 offset:13312
    ds_read_b64_tr_b16 v[34:35], v5 offset:13824
    v_mfma_f32_16x16x32_bf16 v[120:123], v[36:39], v[196:199], v[120:123]
    v_lshlrev_b32 v59, 16, v0
    s_bfe_u32 s10, s14, 0x5000f
    s_lshl_b32 s10, s10, 10
    v_mfma_f32_16x16x32_bf16 v[108:111], v[40:43], v[192:195], v[108:111]
    ds_read_b64_tr_b16 v[36:37], v6 offset:13312
    ds_read_b64_tr_b16 v[38:39], v6 offset:13824
    v_mfma_f32_16x16x32_bf16 v[124:127], v[40:43], v[196:199], v[124:127]
    s_mov_b64 exec, 0x7f
    buffer_load_dword v58, v59, s[32:35], s10 offen
    s_mov_b64 exec, 3
    buffer_load_dword v58, v59, s[36:39], s10 offen
    s_mov_b64 exec, -1
    s_waitcnt lgkmcnt(4)
    v_mfma_f32_16x16x32_bf16 v[80:83], v[200:203], v[44:47], v[80:83]
    s_waitcnt vmcnt(7)
    s_barrier
    ds_read_b64_tr_b16 v[40:41], v5 offset:14336
    ds_read_b64_tr_b16 v[42:43], v5 offset:14848
    v_mfma_f32_16x16x32_bf16 v[88:91], v[204:207], v[44:47], v[88:91]
    s_add_u32 s16, s16, 17825792
    v_mfma_f32_16x16x32_bf16 v[84:87], v[200:203], v[28:31], v[84:87]
    s_add_u32 m0, s78, 73728
    ds_read_b64_tr_b16 v[44:45], v6 offset:14336
    ds_read_b64_tr_b16 v[46:47], v6 offset:14848
    v_mfma_f32_16x16x32_bf16 v[92:95], v[204:207], v[28:31], v[92:95]
    buffer_load_dwordx4 v11, s[44:47], s70 offen lds
    ds_read_b128 v[208:211], v1 offset:32768
    s_waitcnt lgkmcnt(5)
    v_mfma_f32_16x16x32_bf16 v[96:99], v[32:35], v[200:203], v[96:99]
    ds_read_b64_tr_b16 v[28:29], v5 offset:24576
    ds_read_b64_tr_b16 v[30:31], v5 offset:25088
    v_mfma_f32_16x16x32_bf16 v[112:115], v[32:35], v[204:207], v[112:115]
    ds_read_b128 v[212:215], v1 offset:36864
    s_cmp_lt_u32 s95, 1024
    s_cselect_b32 s101, 0x3eb8aa3b, 1.0
    v_mfma_f32_16x16x32_bf16 v[100:103], v[36:39], v[200:203], v[100:103]
    ds_read_b64_tr_b16 v[32:33], v6 offset:24576
    ds_read_b64_tr_b16 v[34:35], v6 offset:25088
    v_mfma_f32_16x16x32_bf16 v[116:119], v[36:39], v[204:207], v[116:119]
    buffer_load_dwordx4 v8, s[48:51], s77 offen offset:1024 lds
    ds_read_b128 v[216:219], v2 offset:32768
    s_add_u32 s22, s91, 3
    s_waitcnt lgkmcnt(7)
    v_mfma_f32_16x16x32_bf16 v[104:107], v[40:43], v[200:203], v[104:107]
    ds_read_b64_tr_b16 v[36:37], v5 offset:25600
    ds_read_b64_tr_b16 v[38:39], v5 offset:26112
    v_mfma_f32_16x16x32_bf16 v[120:123], v[40:43], v[204:207], v[120:123]
    ds_read_b128 v[220:223], v2 offset:36864
    s_and_b32 s22, s22, 3
    s_add_u32 s42, s91, 4
    v_mfma_f32_16x16x32_bf16 v[108:111], v[44:47], v[200:203], v[108:111]
    ds_read_b64_tr_b16 v[40:41], v6 offset:25600
    ds_read_b64_tr_b16 v[42:43], v6 offset:26112
    v_mfma_f32_16x16x32_bf16 v[124:127], v[44:47], v[204:207], v[124:127]
    buffer_load_dwordx4 v8, s[52:55], s77 offen offset:2048 lds
    s_xor_b32 s43, s91, 2
    s_add_u32 s97, s91, 8
    s_waitcnt lgkmcnt(6)
    v_mfma_f32_16x16x32_bf16 v[80:83], v[208:211], v[28:31], v[80:83]
    ds_read_b64_tr_b16 v[44:45], v5 offset:26624
    ds_read_b64_tr_b16 v[46:47], v5 offset:27136
    v_mfma_f32_16x16x32_bf16 v[88:91], v[212:215], v[28:31], v[88:91]
    s_cmp_lt_u32 s91, 4
    s_cselect_b32 s22, s22, s42
    s_cselect_b32 s43, s43, s97
    v_mfma_f32_16x16x32_bf16 v[84:87], v[208:211], v[32:35], v[84:87]
    s_add_u32 m0, s79, 15488
    ds_read_b64_tr_b16 v[28:29], v6 offset:26624
    ds_read_b64_tr_b16 v[30:31], v6 offset:27136
    v_mfma_f32_16x16x32_bf16 v[92:95], v[212:215], v[32:35], v[92:95]
    buffer_load_dwordx4 v10, s[28:31], s80 offen offset:896 lds
    s_lshl_b32 s22, s22, 8
    s_waitcnt lgkmcnt(4)
    v_mfma_f32_16x16x32_bf16 v[96:99], v[36:39], v[208:211], v[96:99]
    ds_read_b64_tr_b16 v[32:33], v5 offset:36864
    ds_read_b64_tr_b16 v[34:35], v5 offset:37376
    v_mfma_f32_16x16x32_bf16 v[112:115], v[36:39], v[212:215], v[112:115]
    s_lshl_b32 s43, s43, 8
    s_lshl_b32 s42, s91, 8
    s_bfe_u32 s11, s8, 0x10001
    v_mfma_f32_16x16x32_bf16 v[100:103], v[40:43], v[208:211], v[100:103]
    ds_read_b64_tr_b16 v[36:37], v6 offset:36864
    ds_read_b64_tr_b16 v[38:39], v6 offset:37376
    v_mfma_f32_16x16x32_bf16 v[116:119], v[40:43], v[212:215], v[116:119]
    buffer_load_dwordx4 v10, s[28:31], s81 offen offset:1920 lds
    s_lshl_b32 s11, s11, 7
    s_add_u32 s11, s11, 16777216
    s_waitcnt lgkmcnt(4)
    v_mfma_f32_16x16x32_bf16 v[104:107], v[44:47], v[208:211], v[104:107]
    ds_read_b64_tr_b16 v[40:41], v5 offset:37888
    ds_read_b64_tr_b16 v[42:43], v5 offset:38400
    v_mfma_f32_16x16x32_bf16 v[120:123], v[44:47], v[212:215], v[120:123]
    s_lshl_b32 s91, s19, 14
    s_add_u32 s91, s91, s11
    s_add_u32 s91, s91, s42
    v_mfma_f32_16x16x32_bf16 v[108:111], v[28:31], v[208:211], v[108:111]
    ds_read_b64_tr_b16 v[44:45], v6 offset:37888
    ds_read_b64_tr_b16 v[46:47], v6 offset:38400
    v_mfma_f32_16x16x32_bf16 v[124:127], v[28:31], v[212:215], v[124:127]
    s_lshl_b32 s94, s9, 14
    s_add_u32 s94, s94, s11
    s_add_u32 s92, s94, s22
    s_waitcnt lgkmcnt(4)
    v_mfma_f32_16x16x32_bf16 v[80:83], v[216:219], v[32:35], v[80:83]
    s_waitcnt vmcnt(7)
    s_barrier
    ds_read_b64_tr_b16 v[28:29], v5 offset:38912
    ds_read_b64_tr_b16 v[30:31], v5 offset:39424
    v_mfma_f32_16x16x32_bf16 v[88:91], v[220:223], v[32:35], v[88:91]
    buffer_load_dwordx4 v[24:27], v48, s[24:27], s89 offen sc1
    v_mfma_f32_16x16x32_bf16 v[84:87], v[216:219], v[36:39], v[84:87]
    s_add_u32 m0, s79, -98304
    ds_read_b64_tr_b16 v[32:33], v6 offset:38912
    ds_read_b64_tr_b16 v[34:35], v6 offset:39424
    v_mfma_f32_16x16x32_bf16 v[92:95], v[220:223], v[36:39], v[92:95]
    buffer_load_dwordx4 v8, s[56:59], s1 offen lds
    ds_read_b128 v[224:227], v1 offset:0
    s_waitcnt lgkmcnt(5)
    v_mfma_f32_16x16x32_bf16 v[96:99], v[40:43], v[216:219], v[96:99]
    ds_read_b64_tr_b16 v[36:37], v3 offset:0
    ds_read_b64_tr_b16 v[38:39], v3 offset:512
    v_mfma_f32_16x16x32_bf16 v[112:115], v[40:43], v[220:223], v[112:115]
    ds_read_b128 v[228:231], v1 offset:4096
    buffer_load_dwordx2 v[10:11], v49, s[24:27], s90 offen sc1
    s_add_u32 s93, s92, 16384
    v_mfma_f32_16x16x32_bf16 v[100:103], v[44:47], v[216:219], v[100:103]
    ds_read_b64_tr_b16 v[40:41], v4 offset:0
    ds_read_b64_tr_b16 v[42:43], v4 offset:512
    v_mfma_f32_16x16x32_bf16 v[116:119], v[44:47], v[220:223], v[116:119]
    buffer_load_dwordx4 v8, s[60:63], s1 offen offset:1024 lds
    ds_read_b128 v[232:235], v2 offset:0
    s_waitcnt lgkmcnt(7)
    v_mfma_f32_16x16x32_bf16 v[104:107], v[28:31], v[216:219], v[104:107]
    ds_read_b64_tr_b16 v[44:45], v3 offset:1024
    ds_read_b64_tr_b16 v[46:47], v3 offset:1536
    v_mfma_f32_16x16x32_bf16 v[120:123], v[28:31], v[220:223], v[120:123]
    ds_read_b128 v[236:239], v2 offset:4096
    s_add_u32 s94, s94, s43
    s_add_u32 s95, s94, 16384
    v_mfma_f32_16x16x32_bf16 v[108:111], v[32:35], v[216:219], v[108:111]
    ds_read_b64_tr_b16 v[28:29], v4 offset:1024
    ds_read_b64_tr_b16 v[30:31], v4 offset:1536
    v_mfma_f32_16x16x32_bf16 v[124:127], v[32:35], v[220:223], v[124:127]
    buffer_load_dwordx2 v[12:13], v49, s[24:27], s90 offen offset:512 sc1
    s_lshr_b32 s11, s8, 1
    s_lshl_b32 s11, s11, 17
    s_waitcnt lgkmcnt(6)
    v_mfma_f32_16x16x32_bf16 v[80:83], v[224:227], v[36:39], v[80:83]
    ds_read_b64_tr_b16 v[32:33], v3 offset:2048
    ds_read_b64_tr_b16 v[34:35], v3 offset:2560
    v_mfma_f32_16x16x32_bf16 v[88:91], v[228:231], v[36:39], v[88:91]
    s_and_b32 s42, s8, 1
    s_lshl_b32 s42, s42, 10
    s_add_u32 s11, s11, s42
    v_mfma_f32_16x16x32_bf16 v[84:87], v[224:227], v[40:43], v[84:87]
    ds_read_b64_tr_b16 v[36:37], v4 offset:2048
    ds_read_b64_tr_b16 v[38:39], v4 offset:2560
    v_mfma_f32_16x16x32_bf16 v[92:95], v[228:231], v[40:43], v[92:95]
    buffer_load_dwordx2 v[14:15], v49, s[24:27], s90 offen offset:1024 sc1
    s_lshl_b32 s96, s9, 11
    s_add_u32 s96, s96, s11
    s_waitcnt lgkmcnt(4)
    v_mfma_f32_16x16x32_bf16 v[96:99], v[44:47], v[224:227], v[96:99]
    ds_read_b64_tr_b16 v[40:41], v3 offset:12288
    ds_read_b64_tr_b16 v[42:43], v3 offset:12800
    v_mfma_f32_16x16x32_bf16 v[112:115], v[44:47], v[228:231], v[112:115]
    s_add_u32 s100, s96, 5242880
    s_add_u32 s96, s96, 3145728
    s_lshl_b32 s97, s19, 11
    v_mfma_f32_16x16x32_bf16 v[100:103], v[28:31], v[224:227], v[100:103]
    ds_read_b64_tr_b16 v[44:45], v4 offset:12288
    ds_read_b64_tr_b16 v[46:47], v4 offset:12800
    v_mfma_f32_16x16x32_bf16 v[116:119], v[28:31], v[228:231], v[116:119]
    buffer_load_dwordx2 v[16:17], v49, s[24:27], s90 offen offset:1536 sc1
    s_add_u32 s97, s97, s11
    s_add_u32 s97, s97, 1048576
    s_waitcnt lgkmcnt(4)
    v_mfma_f32_16x16x32_bf16 v[104:107], v[32:35], v[224:227], v[104:107]
    ds_read_b64_tr_b16 v[28:29], v3 offset:13312
    ds_read_b64_tr_b16 v[30:31], v3 offset:13824
    v_mfma_f32_16x16x32_bf16 v[120:123], v[32:35], v[228:231], v[120:123]
    s_mov_b32 s42, 2097152
    s_mov_b32 s43, 0x20000
    v_mfma_f32_16x16x32_bf16 v[108:111], v[36:39], v[224:227], v[108:111]
    ds_read_b64_tr_b16 v[32:33], v4 offset:13312
    ds_read_b64_tr_b16 v[34:35], v4 offset:13824
    v_mfma_f32_16x16x32_bf16 v[124:127], v[36:39], v[228:231], v[124:127]
    buffer_load_dwordx2 v[18:19], v49, s[24:27], s90 offen offset:2048 sc1
    s_waitcnt lgkmcnt(4)
    v_mfma_f32_16x16x32_bf16 v[80:83], v[232:235], v[40:43], v[80:83]
    s_waitcnt vmcnt(8)
    s_barrier
    ds_read_b64_tr_b16 v[36:37], v3 offset:14336
    ds_read_b64_tr_b16 v[38:39], v3 offset:14848
    v_mfma_f32_16x16x32_bf16 v[88:91], v[236:239], v[40:43], v[88:91]
    v_mfma_f32_16x16x32_bf16 v[84:87], v[232:235], v[44:47], v[84:87]
    s_add_u32 m0, s79, -81920
    ds_read_b64_tr_b16 v[40:41], v4 offset:14336
    ds_read_b64_tr_b16 v[42:43], v4 offset:14848
    v_mfma_f32_16x16x32_bf16 v[92:95], v[236:239], v[44:47], v[92:95]
    buffer_load_dwordx4 v8, s[56:59], s71 offen lds
    ds_read_b128 v[240:243], v1 offset:16384
    s_waitcnt lgkmcnt(5)
    v_mfma_f32_16x16x32_bf16 v[96:99], v[28:31], v[232:235], v[96:99]
    ds_read_b64_tr_b16 v[44:45], v3 offset:24576
    ds_read_b64_tr_b16 v[46:47], v3 offset:25088
    v_mfma_f32_16x16x32_bf16 v[112:115], v[28:31], v[236:239], v[112:115]
    ds_read_b128 v[244:247], v1 offset:20480
    v_mfma_f32_16x16x32_bf16 v[100:103], v[32:35], v[232:235], v[100:103]
    ds_read_b64_tr_b16 v[28:29], v4 offset:24576
    ds_read_b64_tr_b16 v[30:31], v4 offset:25088
    v_mfma_f32_16x16x32_bf16 v[116:119], v[32:35], v[236:239], v[116:119]
    buffer_load_dwordx4 v8, s[60:63], s71 offen offset:1024 lds
    ds_read_b128 v[248:251], v2 offset:16384
    s_waitcnt lgkmcnt(7)
    v_mfma_f32_16x16x32_bf16 v[104:107], v[36:39], v[232:235], v[104:107]
    ds_read_b64_tr_b16 v[32:33], v3 offset:25600
    ds_read_b64_tr_b16 v[34:35], v3 offset:26112
    v_mfma_f32_16x16x32_bf16 v[120:123], v[36:39], v[236:239], v[120:123]
    ds_read_b128 v[252:255], v2 offset:20480
    v_mfma_f32_16x16x32_bf16 v[108:111], v[40:43], v[232:235], v[108:111]
    s_add_u32 m0, s79, -65536
    ds_read_b64_tr_b16 v[36:37], v4 offset:25600
    ds_read_b64_tr_b16 v[38:39], v4 offset:26112
    v_mfma_f32_16x16x32_bf16 v[124:127], v[40:43], v[236:239], v[124:127]
    buffer_load_dwordx4 v8, s[56:59], s72 offen lds
    s_waitcnt lgkmcnt(6)
    v_mfma_f32_16x16x32_bf16 v[80:83], v[240:243], v[44:47], v[80:83]
    ds_read_b64_tr_b16 v[40:41], v3 offset:26624
    ds_read_b64_tr_b16 v[42:43], v3 offset:27136
    v_mfma_f32_16x16x32_bf16 v[88:91], v[244:247], v[44:47], v[88:91]
    v_mfma_f32_16x16x32_bf16 v[84:87], v[240:243], v[28:31], v[84:87]
    ds_read_b64_tr_b16 v[44:45], v4 offset:26624
    ds_read_b64_tr_b16 v[46:47], v4 offset:27136
    v_mfma_f32_16x16x32_bf16 v[92:95], v[244:247], v[28:31], v[92:95]
    buffer_load_dwordx4 v8, s[60:63], s72 offen offset:1024 lds
    s_waitcnt lgkmcnt(4)
    v_mfma_f32_16x16x32_bf16 v[96:99], v[32:35], v[240:243], v[96:99]
    ds_read_b64_tr_b16 v[28:29], v3 offset:36864
    ds_read_b64_tr_b16 v[30:31], v3 offset:37376
    v_mfma_f32_16x16x32_bf16 v[112:115], v[32:35], v[244:247], v[112:115]
    v_mfma_f32_16x16x32_bf16 v[100:103], v[36:39], v[240:243], v[100:103]
    s_add_u32 m0, s79, 32768
    ds_read_b64_tr_b16 v[32:33], v4 offset:36864
    ds_read_b64_tr_b16 v[34:35], v4 offset:37376
    v_mfma_f32_16x16x32_bf16 v[116:119], v[36:39], v[244:247], v[116:119]
    buffer_load_dwordx4 v8, s[56:59], s74 offen lds
    s_waitcnt lgkmcnt(4)
    v_mfma_f32_16x16x32_bf16 v[104:107], v[40:43], v[240:243], v[104:107]
    ds_read_b64_tr_b16 v[36:37], v3 offset:37888
    ds_read_b64_tr_b16 v[38:39], v3 offset:38400
    v_mfma_f32_16x16x32_bf16 v[120:123], v[40:43], v[244:247], v[120:123]
    v_mfma_f32_16x16x32_bf16 v[108:111], v[44:47], v[240:243], v[108:111]
    ds_read_b64_tr_b16 v[40:41], v4 offset:37888
    ds_read_b64_tr_b16 v[42:43], v4 offset:38400
    v_mfma_f32_16x16x32_bf16 v[124:127], v[44:47], v[244:247], v[124:127]
    buffer_load_dwordx4 v8, s[60:63], s74 offen offset:1024 lds
    s_waitcnt lgkmcnt(4)
    v_mfma_f32_16x16x32_bf16 v[80:83], v[248:251], v[28:31], v[80:83]
    s_waitcnt vmcnt(10)
    s_barrier
    ds_read_b64_tr_b16 v[44:45], v3 offset:38912
    ds_read_b64_tr_b16 v[46:47], v3 offset:39424
    v_mfma_f32_16x16x32_bf16 v[88:91], v[252:255], v[28:31], v[88:91]
    v_sub_u32 v5, v5, v51
    v_sub_u32 v6, v6, v51
    v_mfma_f32_16x16x32_bf16 v[84:87], v[248:251], v[32:35], v[84:87]
    s_add_u32 m0, s79, -49152
    ds_read_b64_tr_b16 v[28:29], v4 offset:38912
    ds_read_b64_tr_b16 v[30:31], v4 offset:39424
    v_mfma_f32_16x16x32_bf16 v[92:95], v[252:255], v[32:35], v[92:95]
    buffer_load_dwordx4 v8, s[56:59], s73 offen lds
    s_waitcnt lgkmcnt(4)
    v_mfma_f32_16x16x32_bf16 v[96:99], v[36:39], v[248:251], v[96:99]
    ds_read_b64_tr_b16 v[32:33], v5 offset:0
    ds_read_b64_tr_b16 v[34:35], v5 offset:512
    v_mfma_f32_16x16x32_bf16 v[112:115], v[36:39], v[252:255], v[112:115]
    v_mfma_f32_16x16x32_bf16 v[100:103], v[40:43], v[248:251], v[100:103]
    ds_read_b64_tr_b16 v[36:37], v6 offset:0
    ds_read_b64_tr_b16 v[38:39], v6 offset:512
    v_mfma_f32_16x16x32_bf16 v[116:119], v[40:43], v[252:255], v[116:119]
    buffer_load_dwordx4 v8, s[60:63], s73 offen offset:1024 lds
    s_waitcnt lgkmcnt(4)
    v_mfma_f32_16x16x32_bf16 v[104:107], v[44:47], v[248:251], v[104:107]
    ds_read_b64_tr_b16 v[40:41], v5 offset:1024
    ds_read_b64_tr_b16 v[42:43], v5 offset:1536
    v_mfma_f32_16x16x32_bf16 v[120:123], v[44:47], v[252:255], v[120:123]
    v_mfma_f32_16x16x32_bf16 v[108:111], v[28:31], v[248:251], v[108:111]
    ds_read_b64_tr_b16 v[44:45], v6 offset:1024
    ds_read_b64_tr_b16 v[46:47], v6 offset:1536
    v_mfma_f32_16x16x32_bf16 v[124:127], v[28:31], v[252:255], v[124:127]
    s_waitcnt vmcnt(8)
    v_min3_u32 v50, v11, v13, v15
    v_max3_u32 v51, v11, v13, v15
    v_min3_u32 v50, v50, v17, v19
    v_max3_u32 v51, v51, v17, v19
    v_min3_u32 v50, v50, v25, v27
    v_max3_u32 v51, v51, v25, v27
    v_xor_b32 v50, s5, v50
    v_xor_b32 v51, s5, v51
    v_or_b32 v50, v50, v51
    v_cmp_ne_u32 vcc, 0, v50
    s_nop 0
    s_cbranch_vccz Lok_gran_5
    s_mov_b32 s18, 0
Lsp_gran_6:
    buffer_load_dwordx4 v[24:27], v48, s[24:27], s89 offen sc1
    buffer_load_dwordx2 v[10:11], v49, s[24:27], s90 offen sc1
    buffer_load_dwordx2 v[12:13], v49, s[24:27], s90 offen offset:512 sc1
    buffer_load_dwordx2 v[14:15], v49, s[24:27], s90 offen offset:1024 sc1
    buffer_load_dwordx2 v[16:17], v49, s[24:27], s90 offen offset:1536 sc1
    buffer_load_dwordx2 v[18:19], v49, s[24:27], s90 offen offset:2048 sc1
    s_waitcnt vmcnt(0)
    v_min3_u32 v50, v11, v13, v15
    v_max3_u32 v51, v11, v13, v15
    v_min3_u32 v50, v50, v17, v19
    v_max3_u32 v51, v51, v17, v19
    v_min3_u32 v50, v50, v25, v27
    v_max3_u32 v51, v51, v25, v27
    v_xor_b32 v50, s5, v50
    v_xor_b32 v51, s5, v51
    v_or_b32 v50, v50, v51
    v_cmp_ne_u32 vcc, 0, v50
    s_nop 0
    s_cbranch_vccz Lok_gran_5
    s_add_u32 s18, s18, 1
    s_cmp_lt_u32 s18, 20000
    s_cbranch_scc1 Lsp_gran_6
Lok_gran_5:
    v_mov_b32 v20, v10
    v_permlane32_swap_b32 v12, v14
    v_permlane32_swap_b32 v16, v18
    v_permlane32_swap_b32 v10, v20
    v_mov_b32 v22, v26
    v_mov_b32 v23, v26
    v_add_f32 v12, v12, v14
    v_add_f32 v16, v16, v18
    v_add_f32 v10, v10, v20
    v_permlane32_swap_b32 v22, v23
    v_mfma_f32_16x16x1_4b_f32 v[48:63], v16, v24, 0 blgp:4
    v_mfma_f32_16x16x1_4b_f32 v[64:79], v16, v24, 0 blgp:6
    v_mfma_f32_16x16x1_4b_f32 v[80:95], v24, v10, v[80:95]
    s_lshl_b32 s7, s4, 7
    s_add_u32 s7, s7, 65536
    v_mfma_f32_16x16x1_4b_f32 v[96:111], v12, v24, v[96:111] blgp:4
    v_mfma_f32_16x16x1_4b_f32 v[112:127], v12, v24, v[112:127] blgp:6
    s_waitcnt lgkmcnt(4)
    s_nop 2
    v_mfma_f32_16x16x32_bf16 v[48:51], v[32:35], v[128:131], v[48:51]
    s_add_u32 m0, s79, 49152
    ds_read_b64_tr_b16 v[28:29], v5 offset:8192
    ds_read_b64_tr_b16 v[30:31], v5 offset:8704
    v_mfma_f32_16x16x32_bf16 v[64:67], v[32:35], v[132:135], v[64:67]
    buffer_load_dwordx4 v8, s[56:59], s75 offen lds
    v_and_b32 v18, 0xf0, v9
    v_lshrrev_b32 v20, 5, v0
    v_lshl_add_u32 v19, v20, 8, v18
    v_lshrrev_b32 v19, 2, v19
    v_add_u32 v19, s7, v19
    ds_write_b32 v19, v26
    v_mfma_f32_16x16x32_bf16 v[52:55], v[36:39], v[128:131], v[52:55]
    ds_read_b64_tr_b16 v[32:33], v6 offset:8192
    ds_read_b64_tr_b16 v[34:35], v6 offset:8704
    v_mfma_f32_16x16x32_bf16 v[68:71], v[36:39], v[132:135], v[68:71]
    buffer_load_dwordx4 v8, s[60:63], s75 offen offset:1024 lds
    v_and_b32 v19, 0x30, v0
    v_add_u32 v19, s7, v19
    ds_read_b128 v[10:13], v19 offset:0
    ds_read_b128 v[14:17], v19 offset:64
    v_lshl_add_u32 v18, v20, 10, v18
    v_and_b32 v21, 0x100, v9
    v_add_u32 v18, v21, v18
    s_waitcnt lgkmcnt(7)
    v_mfma_f32_16x16x32_bf16 v[56:59], v[40:43], v[128:131], v[56:59]
    ds_read_b64_tr_b16 v[36:37], v5 offset:9216
    ds_read_b64_tr_b16 v[38:39], v5 offset:9728
    v_mfma_f32_16x16x32_bf16 v[72:75], v[40:43], v[132:135], v[72:75]
    s_waitcnt lgkmcnt(3)
    v_mul_f32 v80, v80, v10
    v_mul_f32 v81, v81, v11
    v_mul_f32 v82, v82, v12
    v_mul_f32 v83, v83, v13
    v_mul_f32 v84, v84, v10
    v_mul_f32 v85, v85, v11
    v_mul_f32 v86, v86, v12
    v_mul_f32 v87, v87, v13
    v_mfma_f32_16x16x32_bf16 v[60:63], v[44:47], v[128:131], v[60:63]
    s_waitcnt vmcnt(8)
    s_barrier
    ds_read_b64_tr_b16 v[40:41], v6 offset:9216
    ds_read_b64_tr_b16 v[42:43], v6 offset:9728
    v_mfma_f32_16x16x32_bf16 v[76:79], v[44:47], v[132:135], v[76:79]
    v_cvt_pk_bf16_f32 v80, v80, v81
    v_cvt_pk_bf16_f32 v81, v82, v83
    v_cvt_pk_bf16_f32 v82, v84, v85
    v_cvt_pk_bf16_f32 v83, v86, v87
    v_mfma_f32_16x16x32_bf16 v[48:51], v[28:31], v[136:139], v[48:51]
    ds_read_b64_tr_b16 v[44:45], v5 offset:16384
    ds_read_b64_tr_b16 v[46:47], v5 offset:16896
    v_mfma_f32_16x16x32_bf16 v[64:67], v[28:31], v[140:143], v[64:67]
    v_permlane32_swap_b32 v80, v82
    v_permlane32_swap_b32 v81, v83
    buffer_store_dwordx4 v[80:83], v18, s[24:27], s82 offen sc1
    s_waitcnt lgkmcnt(6)
    v_mul_f32 v88, v88, v14
    v_mul_f32 v89, v89, v15
    v_mul_f32 v90, v90, v16
    v_mul_f32 v91, v91, v17
    v_mfma_f32_16x16x32_bf16 v[52:55], v[32:35], v[136:139], v[52:55]
    ds_read_b64_tr_b16 v[28:29], v6 offset:16384
    ds_read_b64_tr_b16 v[30:31], v6 offset:16896
    v_mfma_f32_16x16x32_bf16 v[68:71], v[32:35], v[140:143], v[68:71]
    v_mul_f32 v92, v92, v14
    v_mul_f32 v93, v93, v15
    v_mul_f32 v94, v94, v16
    v_mul_f32 v95, v95, v17
    v_cvt_pk_bf16_f32 v88, v88, v89
    v_cvt_pk_bf16_f32 v89, v90, v91
    v_cvt_pk_bf16_f32 v90, v92, v93
    v_cvt_pk_bf16_f32 v91, v94, v95
    s_waitcnt lgkmcnt(4)
    v_mfma_f32_16x16x32_bf16 v[56:59], v[36:39], v[136:139], v[56:59]
    ds_read_b64_tr_b16 v[32:33], v5 offset:17408
    ds_read_b64_tr_b16 v[34:35], v5 offset:17920
    v_mfma_f32_16x16x32_bf16 v[72:75], v[36:39], v[140:143], v[72:75]
    v_permlane32_swap_b32 v88, v90
    v_permlane32_swap_b32 v89, v91
    buffer_store_dwordx4 v[88:91], v18, s[24:27], s82 offen offset:512 sc1
    v_mfma_f32_16x16x32_bf16 v[60:63], v[40:43], v[136:139], v[60:63]
    ds_read_b64_tr_b16 v[36:37], v6 offset:17408
    ds_read_b64_tr_b16 v[38:39], v6 offset:17920
    v_mfma_f32_16x16x32_bf16 v[76:79], v[40:43], v[140:143], v[76:79]
    v_mul_f32 v96, v96, v104
    v_mul_f32 v97, v97, v105
    v_mul_f32 v98, v98, v106
    v_mul_f32 v99, v99, v107
    s_waitcnt lgkmcnt(4)
    v_mfma_f32_16x16x32_bf16 v[48:51], v[44:47], v[144:147], v[48:51]
    ds_read_b64_tr_b16 v[40:41], v5 offset:24576
    ds_read_b64_tr_b16 v[42:43], v5 offset:25088
    v_mfma_f32_16x16x32_bf16 v[64:67], v[44:47], v[148:151], v[64:67]
    v_mul_f32 v100, v100, v108
    v_mul_f32 v101, v101, v109
    v_mul_f32 v102, v102, v110
    v_mul_f32 v103, v103, v111
    v_mfma_f32_16x16x32_bf16 v[52:55], v[28:31], v[144:147], v[52:55]
    ds_read_b64_tr_b16 v[44:45], v6 offset:24576
    ds_read_b64_tr_b16 v[46:47], v6 offset:25088
    v_mfma_f32_16x16x32_bf16 v[68:71], v[28:31], v[148:151], v[68:71]
    v_cvt_pk_bf16_f32 v96, v96, v97
    v_cvt_pk_bf16_f32 v97, v98, v99
    v_cvt_pk_bf16_f32 v98, v100, v101
    v_cvt_pk_bf16_f32 v99, v102, v103
    s_waitcnt lgkmcnt(4)
    v_mfma_f32_16x16x32_bf16 v[56:59], v[32:35], v[144:147], v[56:59]
    ds_read_b64_tr_b16 v[28:29], v5 offset:25600
    ds_read_b64_tr_b16 v[30:31], v5 offset:26112
    v_mfma_f32_16x16x32_bf16 v[72:75], v[32:35], v[148:151], v[72:75]
    v_mul_f32 v112, v112, v120
    v_mul_f32 v113, v113, v121
    v_mul_f32 v114, v114, v122
    v_mul_f32 v115, v115, v123
    v_mfma_f32_16x16x32_bf16 v[60:63], v[36:39], v[144:147], v[60:63]
    s_waitcnt vmcnt(8)
    s_barrier
    ds_read_b64_tr_b16 v[32:33], v6 offset:25600
    ds_read_b64_tr_b16 v[34:35], v6 offset:26112
    v_mfma_f32_16x16x32_bf16 v[76:79], v[36:39], v[148:151], v[76:79]
    v_mul_f32 v116, v116, v124
    v_mul_f32 v117, v117, v125
    s_waitcnt lgkmcnt(4)
    v_mfma_f32_16x16x32_bf16 v[48:51], v[40:43], v[152:155], v[48:51]
    s_add_u32 m0, s79, -98304
    ds_read_b64_tr_b16 v[36:37], v5 offset:32768
    ds_read_b64_tr_b16 v[38:39], v5 offset:33280
    v_mfma_f32_16x16x32_bf16 v[64:67], v[40:43], v[156:159], v[64:67]
    buffer_load_dwordx4 v8, s[56:59], s76 offen lds
    v_mul_f32 v118, v118, v126
    v_mul_f32 v119, v119, v127
    v_mfma_f32_16x16x32_bf16 v[52:55], v[44:47], v[152:155], v[52:55]
    ds_read_b64_tr_b16 v[40:41], v6 offset:32768
    ds_read_b64_tr_b16 v[42:43], v6 offset:33280
    v_mfma_f32_16x16x32_bf16 v[68:71], v[44:47], v[156:159], v[68:71]
    buffer_load_dwordx4 v8, s[60:63], s76 offen offset:1024 lds
    v_cvt_pk_bf16_f32 v112, v112, v113
    v_cvt_pk_bf16_f32 v113, v114, v115
    v_cvt_pk_bf16_f32 v114, v116, v117
    s_waitcnt lgkmcnt(4)
    v_mfma_f32_16x16x32_bf16 v[56:59], v[28:31], v[152:155], v[56:59]
    ds_read_b64_tr_b16 v[44:45], v5 offset:33792
    ds_read_b64_tr_b16 v[46:47], v5 offset:34304
    v_mfma_f32_16x16x32_bf16 v[72:75], v[28:31], v[156:159], v[72:75]
    s_waitcnt vmcnt(2)
    v_lshlrev_b32 v94, 2, v0
    v_mov_b32 v95, s5
    s_mov_b32 exec_hi, 0
    buffer_store_dword v95, v94, s[24:27], s86 offen sc1
    s_mov_b32 exec_hi, -1
    s_add_u32 s86, s86, 4096
    v_mfma_f32_16x16x32_bf16 v[60:63], v[32:35], v[152:155], v[60:63]
    ds_read_b64_tr_b16 v[28:29], v6 offset:33792
    ds_read_b64_tr_b16 v[30:31], v6 offset:34304
    v_mfma_f32_16x16x32_bf16 v[76:79], v[32:35], v[156:159], v[76:79]
    v_cvt_pk_bf16_f32 v115, v118, v119
    v_lshrrev_b32 v2, 3, v0
    v_and_b32 v3, 6, v2
    s_waitcnt lgkmcnt(4)
    v_mfma_f32_16x16x32_bf16 v[48:51], v[36:39], v[160:163], v[48:51]
    ds_read_b64_tr_b16 v[32:33], v5 offset:40960
    ds_read_b64_tr_b16 v[34:35], v5 offset:41472
    v_mfma_f32_16x16x32_bf16 v[64:67], v[36:39], v[164:167], v[64:67]
    v_and_b32 v4, 7, v0
    v_xor_b32 v3, v3, v4
    v_lshlrev_b32 v3, 4, v3
    v_mfma_f32_16x16x32_bf16 v[52:55], v[40:43], v[160:163], v[52:55]
    ds_read_b64_tr_b16 v[36:37], v6 offset:40960
    ds_read_b64_tr_b16 v[38:39], v6 offset:41472
    v_mfma_f32_16x16x32_bf16 v[68:71], v[40:43], v[164:167], v[68:71]
    v_lshl_add_u32 v1, v2, 10, v3
    v_add_u32 v2, 7168, v1
    v_add_u32 v3, 14336, v1
    s_waitcnt lgkmcnt(4)
    v_mfma_f32_16x16x32_bf16 v[56:59], v[44:47], v[160:163], v[56:59]
    ds_read_b64_tr_b16 v[40:41], v5 offset:41984
    ds_read_b64_tr_b16 v[42:43], v5 offset:42496
    v_mfma_f32_16x16x32_bf16 v[72:75], v[44:47], v[164:167], v[72:75]
    v_add_u32 v4, 21504, v1
    s_mov_b32 s22, 0
    v_mfma_f32_16x16x32_bf16 v[60:63], v[28:31], v[160:163], v[60:63]
    s_barrier
    ds_read_b64_tr_b16 v[44:45], v6 offset:41984
    ds_read_b64_tr_b16 v[46:47], v6 offset:42496
    v_mfma_f32_16x16x32_bf16 v[76:79], v[28:31], v[164:167], v[76:79]
    s_waitcnt lgkmcnt(4)
    v_mfma_f32_16x16x32_bf16 v[48:51], v[32:35], v[168:171], v[48:51]
    s_add_u32 m0, s79, -81920
    ds_read_b64_tr_b16 v[28:29], v5 offset:49152
    ds_read_b64_tr_b16 v[30:31], v5 offset:49664
    v_mfma_f32_16x16x32_bf16 v[64:67], v[32:35], v[172:175], v[64:67]
    buffer_load_dwordx4 v8, s[56:59], s77 offen lds
    v_lshlrev_b32 v92, 16, v0
    s_bfe_u32 s10, s14, 0x2000f
    s_bfe_u32 s9, s13, 0x30007
    s_lshl3_add_u32 s10, s10, s9
    s_lshl_b32 s10, s10, 10
    s_lshl_b32 s9, s9, 7
    s_sub_u32 s10, s10, s9
    v_mfma_f32_16x16x32_bf16 v[52:55], v[36:39], v[168:171], v[52:55]
    ds_read_b64_tr_b16 v[32:33], v6 offset:49152
    ds_read_b64_tr_b16 v[34:35], v6 offset:49664
    v_mfma_f32_16x16x32_bf16 v[68:71], v[36:39], v[172:175], v[68:71]
    buffer_load_dwordx4 v8, s[60:63], s77 offen offset:1024 lds
    s_add_u32 s9, s32, s10
    s_sub_u32 s9, 384, s9
    s_and_b32 s9, s9, 0x380
    s_add_u32 s9, s9, s10
    s_mov_b64 exec, 15
    v_add_u32 v87, s9, v92
    buffer_load_dword v87, v87, s[32:35], 0 offen
    s_mov_b64 exec, -1
    s_waitcnt lgkmcnt(4)
    v_mfma_f32_16x16x32_bf16 v[56:59], v[40:43], v[168:171], v[56:59]
    ds_read_b64_tr_b16 v[36:37], v5 offset:50176
    ds_read_b64_tr_b16 v[38:39], v5 offset:50688
    v_mfma_f32_16x16x32_bf16 v[72:75], v[40:43], v[172:175], v[72:75]
    v_mfma_f32_16x16x32_bf16 v[60:63], v[44:47], v[168:171], v[60:63]
    s_add_u32 m0, s6, 98304
    ds_read_b64_tr_b16 v[40:41], v6 offset:50176
    ds_read_b64_tr_b16 v[42:43], v6 offset:50688
    v_mfma_f32_16x16x32_bf16 v[76:79], v[44:47], v[172:175], v[76:79]
    buffer_load_dwordx4 v1, s[32:35], s22 offen lds
    s_waitcnt lgkmcnt(4)
    v_mfma_f32_16x16x32_bf16 v[48:51], v[28:31], v[176:179], v[48:51]
    ds_read_b64_tr_b16 v[44:45], v5 offset:57344
    ds_read_b64_tr_b16 v[46:47], v5 offset:57856
    v_mfma_f32_16x16x32_bf16 v[64:67], v[28:31], v[180:183], v[64:67]
    buffer_store_dwordx4 v[96:99], v9, s[24:27], s83 offen sc1
    v_mfma_f32_16x16x32_bf16 v[52:55], v[32:35], v[176:179], v[52:55]
    ds_read_b64_tr_b16 v[28:29], v6 offset:57344
    ds_read_b64_tr_b16 v[30:31], v6 offset:57856
    v_mfma_f32_16x16x32_bf16 v[68:71], v[32:35], v[180:183], v[68:71]
    buffer_load_dwordx4 v2, s[32:35], s22 offen offset:1024 lds
    s_waitcnt lgkmcnt(4)
    v_mfma_f32_16x16x32_bf16 v[56:59], v[36:39], v[176:179], v[56:59]
    ds_read_b64_tr_b16 v[32:33], v5 offset:58368
    ds_read_b64_tr_b16 v[34:35], v5 offset:58880
    v_add_u32 v5, 131072, v5
    v_mfma_f32_16x16x32_bf16 v[72:75], v[36:39], v[180:183], v[72:75]
    buffer_store_dwordx4 v[112:115], v9, s[24:27], s83 offen offset:1024 sc1
    v_mfma_f32_16x16x32_bf16 v[60:63], v[40:43], v[176:179], v[60:63]
    s_barrier
    ds_read_b64_tr_b16 v[36:37], v6 offset:58368
    ds_read_b64_tr_b16 v[38:39], v6 offset:58880
    v_add_u32 v6, 131072, v6
    v_mfma_f32_16x16x32_bf16 v[76:79], v[40:43], v[180:183], v[76:79]
    buffer_load_dwordx4 v3, s[32:35], s22 offen offset:2048 lds
    v_lshrrev_b32 v27, 5, v0
    s_waitcnt lgkmcnt(4)
    v_mfma_f32_16x16x32_bf16 v[48:51], v[44:47], v[184:187], v[48:51]
    ds_read_b64_tr_b16 v[40:41], v5 offset:0
    ds_read_b64_tr_b16 v[42:43], v5 offset:512
    v_mfma_f32_16x16x32_bf16 v[64:67], v[44:47], v[188:191], v[64:67]
    v_and_b32 v26, 31, v0
    v_lshlrev_b32 v27, 2, v27
    v_sub_u32 v27, v26, v27
    v_cmp_le_i32 s[44:45], 0, v27
    v_mfma_f32_16x16x32_bf16 v[52:55], v[28:31], v[184:187], v[52:55]
    ds_read_b64_tr_b16 v[44:45], v6 offset:0
    ds_read_b64_tr_b16 v[46:47], v6 offset:512
    v_mfma_f32_16x16x32_bf16 v[68:71], v[28:31], v[188:191], v[68:71]
    buffer_load_dwordx4 v4, s[32:35], s22 offen offset:3072 lds
    v_cmp_le_i32 s[46:47], 1, v27
    v_cmp_le_i32 s[48:49], 2, v27
    v_cmp_le_i32 s[50:51], 3, v27
    s_waitcnt lgkmcnt(4)
    v_mfma_f32_16x16x32_bf16 v[56:59], v[32:35], v[184:187], v[56:59]
    ds_read_b64_tr_b16 v[28:29], v5 offset:1024
    ds_read_b64_tr_b16 v[30:31], v5 offset:1536
    v_mfma_f32_16x16x32_bf16 v[72:75], v[32:35], v[188:191], v[72:75]
    v_cmp_le_i32 s[52:53], 8, v27
    v_cmp_le_i32 s[54:55], 9, v27
    v_cmp_le_i32 s[56:57], 10, v27
    v_cmp_le_i32 s[58:59], 11, v27
    v_mfma_f32_16x16x32_bf16 v[60:63], v[36:39], v[184:187], v[60:63]
    s_mov_b32 s22, 65536
    s_add_u32 m0, s6, 65536
    ds_read_b64_tr_b16 v[32:33], v6 offset:1024
    ds_read_b64_tr_b16 v[34:35], v6 offset:1536
    v_mfma_f32_16x16x32_bf16 v[76:79], v[36:39], v[188:191], v[76:79]
    buffer_load_dwordx4 v1, s[32:35], s22 offen lds
    s_waitcnt lgkmcnt(4)
    v_mfma_f32_16x16x32_bf16 v[48:51], v[40:43], v[192:195], v[48:51]
    ds_read_b64_tr_b16 v[36:37], v5 offset:8192
    ds_read_b64_tr_b16 v[38:39], v5 offset:8704
    v_mfma_f32_16x16x32_bf16 v[64:67], v[40:43], v[196:199], v[64:67]
    v_cmp_le_i32 s[60:61], 16, v27
    v_cmp_le_i32 s[62:63], 17, v27
    v_cmp_le_i32 s[64:65], 18, v27
    v_cmp_le_i32 s[66:67], 19, v27
    v_mfma_f32_16x16x32_bf16 v[52:55], v[44:47], v[192:195], v[52:55]
    ds_read_b64_tr_b16 v[40:41], v6 offset:8192
    ds_read_b64_tr_b16 v[42:43], v6 offset:8704
    v_mfma_f32_16x16x32_bf16 v[68:71], v[44:47], v[196:199], v[68:71]
    buffer_load_dwordx4 v2, s[32:35], s22 offen offset:1024 lds
    v_cmp_le_i32 s[68:69], 24, v27
    v_cmp_le_i32 s[70:71], 25, v27
    v_cmp_le_i32 s[72:73], 26, v27
    s_waitcnt lgkmcnt(4)
    v_mfma_f32_16x16x32_bf16 v[56:59], v[28:31], v[192:195], v[56:59]
    ds_read_b64_tr_b16 v[44:45], v5 offset:9216
    ds_read_b64_tr_b16 v[46:47], v5 offset:9728
    v_mfma_f32_16x16x32_bf16 v[72:75], v[28:31], v[196:199], v[72:75]
    v_mov_b32 v101, s91
    v_writelane_b32 v101, s92, 1
    v_writelane_b32 v101, s93, 2
    v_writelane_b32 v101, s94, 3
    v_mfma_f32_16x16x32_bf16 v[60:63], v[32:35], v[192:195], v[60:63]
    s_barrier
    ds_read_b64_tr_b16 v[28:29], v6 offset:9216
    ds_read_b64_tr_b16 v[30:31], v6 offset:9728
    v_mfma_f32_16x16x32_bf16 v[76:79], v[32:35], v[196:199], v[76:79]
    buffer_load_dwordx4 v3, s[32:35], s22 offen offset:2048 lds
    v_writelane_b32 v101, s95, 4
    s_waitcnt lgkmcnt(4)
    v_mfma_f32_16x16x32_bf16 v[48:51], v[36:39], v[200:203], v[48:51]
    ds_read_b64_tr_b16 v[32:33], v5 offset:16384
    ds_read_b64_tr_b16 v[34:35], v5 offset:16896
    v_mfma_f32_16x16x32_bf16 v[64:67], v[36:39], v[204:207], v[64:67]
    v_cmp_le_i32 s[74:75], 27, v27
    s_lshl_b32 s8, s4, 10
    s_add_u32 s9, s8, 131072
    v_add_u32 v102, s9, v9
    v_mfma_f32_16x16x32_bf16 v[52:55], v[40:43], v[200:203], v[52:55]
    ds_read_b64_tr_b16 v[36:37], v6 offset:16384
    ds_read_b64_tr_b16 v[38:39], v6 offset:16896
    v_mfma_f32_16x16x32_bf16 v[68:71], v[40:43], v[204:207], v[68:71]
    buffer_load_dwordx4 v4, s[32:35], s22 offen offset:3072 lds
    v_and_b32 v103, 0xf0, v9
    v_lshrrev_b32 v27, 5, v0
    v_lshl_add_u32 v103, v27, 8, v103
    s_waitcnt lgkmcnt(4)
    v_mfma_f32_16x16x32_bf16 v[56:59], v[44:47], v[200:203], v[56:59]
    ds_read_b64_tr_b16 v[40:41], v5 offset:17408
    ds_read_b64_tr_b16 v[42:43], v5 offset:17920
    v_mfma_f32_16x16x32_bf16 v[72:75], v[44:47], v[204:207], v[72:75]
    buffer_load_dword v100, v101, s[24:27], 0 offen sc1
    v_and_b32 v8, 16, v0
    v_lshl_add_u32 v8, v8, 6, v103
    v_mfma_f32_16x16x32_bf16 v[60:63], v[28:31], v[200:203], v[60:63]
    ds_read_b64_tr_b16 v[44:45], v6 offset:17408
    ds_read_b64_tr_b16 v[46:47], v6 offset:17920
    v_mfma_f32_16x16x32_bf16 v[76:79], v[28:31], v[204:207], v[76:79]
    s_add_u32 s9, s8, 147456
    v_add_u32 v103, s9, v103
    v_mov_b32 v27, 0xffff
    v_mov_b32 v26, 0xff7fffff
    s_waitcnt lgkmcnt(4)
    v_mfma_f32_16x16x32_bf16 v[48:51], v[32:35], v[208:211], v[48:51]
    s_mov_b32 s22, 131072
    s_add_u32 m0, s6, 32768
    ds_read_b64_tr_b16 v[28:29], v5 offset:24576
    ds_read_b64_tr_b16 v[30:31], v5 offset:25088
    v_mfma_f32_16x16x32_bf16 v[64:67], v[32:35], v[212:215], v[64:67]
    buffer_load_dwordx4 v1, s[32:35], s22 offen lds
    s_waitcnt vmcnt(8)
    v_lshlrev_b32 v94, 2, v0
    v_mov_b32 v95, s5
    s_mov_b32 exec_hi, 0
    buffer_store_dword v95, v94, s[24:27], s86 offen sc1
    s_mov_b32 exec_hi, -1
    s_add_u32 s86, s86, 4096
    v_mfma_f32_16x16x32_bf16 v[52:55], v[36:39], v[208:211], v[52:55]
    ds_read_b64_tr_b16 v[32:33], v6 offset:24576
    ds_read_b64_tr_b16 v[34:35], v6 offset:25088
    v_mfma_f32_16x16x32_bf16 v[68:71], v[36:39], v[212:215], v[68:71]
    v_cndmask_b32 v120, 0, v27, s[44:45]
    v_cndmask_b32 v121, 0, v27, s[48:49]
    v_cndmask_b32 v122, 0, v27, s[52:53]
    v_cndmask_b32 v123, 0, v27, s[56:57]
    s_waitcnt lgkmcnt(4)
    v_mfma_f32_16x16x32_bf16 v[56:59], v[40:43], v[208:211], v[56:59]
    ds_read_b64_tr_b16 v[36:37], v5 offset:25600
    ds_read_b64_tr_b16 v[38:39], v5 offset:26112
    v_subrev_u32 v5, 131072, v5
    v_mfma_f32_16x16x32_bf16 v[72:75], v[40:43], v[212:215], v[72:75]
    buffer_load_dwordx4 v2, s[32:35], s22 offen offset:1024 lds
    v_cndmask_b32 v124, 0, v27, s[60:61]
    v_cndmask_b32 v125, 0, v27, s[64:65]
    v_cndmask_b32 v126, 0, v27, s[68:69]
    v_mfma_f32_16x16x32_bf16 v[60:63], v[44:47], v[208:211], v[60:63]
    s_barrier
    ds_read_b64_tr_b16 v[40:41], v6 offset:25600
    ds_read_b64_tr_b16 v[42:43], v6 offset:26112
    v_subrev_u32 v6, 131072, v6
    v_mfma_f32_16x16x32_bf16 v[76:79], v[44:47], v[212:215], v[76:79]
    v_cndmask_b32 v127, 0, v27, s[72:73]
    v_cndmask_b32 v120, v120, -1, s[46:47]
    s_waitcnt lgkmcnt(4)
    v_mfma_f32_16x16x32_bf16 v[48:51], v[28:31], v[216:219], v[48:51]
    ds_read_b64_tr_b16 v[44:45], v5 offset:0
    ds_read_b64_tr_b16 v[46:47], v5 offset:512
    v_mfma_f32_16x16x32_bf16 v[64:67], v[28:31], v[220:223], v[64:67]
    v_cndmask_b32 v121, v121, -1, s[50:51]
    v_cndmask_b32 v122, v122, -1, s[54:55]
    v_cndmask_b32 v123, v123, -1, s[58:59]
    v_cndmask_b32 v124, v124, -1, s[62:63]
    v_mfma_f32_16x16x32_bf16 v[52:55], v[32:35], v[216:219], v[52:55]
    s_add_u32 m0, s79, 32768
    ds_read_b64_tr_b16 v[28:29], v6 offset:0
    ds_read_b64_tr_b16 v[30:31], v6 offset:512
    v_mfma_f32_16x16x32_bf16 v[68:71], v[32:35], v[220:223], v[68:71]
    s_waitcnt vmcnt(3)
    v_cmp_ne_u32 vcc, s5, v100
    s_nop 0
    s_cbranch_vccz Lok_A_7
    s_mov_b32 s18, 0
Lsp_A_8:
    buffer_load_dword v100, v101, s[24:27], 0 offen sc1
    s_waitcnt vmcnt(0)
    v_cmp_ne_u32 vcc, s5, v100
    s_nop 0
    s_cbranch_vccz Lok_A_7
    s_add_u32 s18, s18, 1
    s_cmp_lt_u32 s18, 20000
    s_cbranch_scc1 Lsp_A_8
Lok_A_7:
    buffer_load_dwordx4 v9, s[24:27], s96 offen sc1 lds
    s_waitcnt lgkmcnt(4)
    v_mfma_f32_16x16x32_bf16 v[56:59], v[36:39], v[216:219], v[56:59]
    ds_read_b64_tr_b16 v[32:33], v5 offset:1024
    ds_read_b64_tr_b16 v[34:35], v5 offset:1536
    v_mfma_f32_16x16x32_bf16 v[72:75], v[36:39], v[220:223], v[72:75]
    v_cndmask_b32 v125, v125, -1, s[66:67]
    v_cndmask_b32 v126, v126, -1, s[70:71]
    v_cndmask_b32 v127, v127, -1, s[74:75]
    v_mov_b32 v104, 0x3f803f80
    v_mfma_f32_16x16x32_bf16 v[60:63], v[40:43], v[216:219], v[60:63]
    s_add_u32 m0, s79, 31744
    ds_read_b64_tr_b16 v[36:37], v6 offset:1024
    ds_read_b64_tr_b16 v[38:39], v6 offset:1536
    v_mfma_f32_16x16x32_bf16 v[76:79], v[40:43], v[220:223], v[76:79]
    buffer_load_dwordx4 v9, s[24:27], s96 offen offset:2048 sc1 lds
    v_mov_b32 v105, 0x3f803f80
    v_mov_b32 v106, 0x3f803f80
    s_waitcnt lgkmcnt(4)
    v_mfma_f32_16x16x32_bf16 v[48:51], v[44:47], v[224:227], v[48:51]
    ds_read_b64_tr_b16 v[40:41], v5 offset:8192
    ds_read_b64_tr_b16 v[42:43], v5 offset:8704
    v_mfma_f32_16x16x32_bf16 v[64:67], v[44:47], v[228:231], v[64:67]
    v_mov_b32 v107, 0x3f803f80
    v_mov_b32 v108, 0x3f803f80
    v_mov_b32 v109, 0x3f803f80
    v_mov_b32 v110, 0x3f803f80
    v_mfma_f32_16x16x32_bf16 v[52:55], v[28:31], v[224:227], v[52:55]
    ds_read_b64_tr_b16 v[44:45], v6 offset:8192
    ds_read_b64_tr_b16 v[46:47], v6 offset:8704
    v_mfma_f32_16x16x32_bf16 v[68:71], v[28:31], v[228:231], v[68:71]
    buffer_load_dwordx4 v[96:99], v9, s[24:27], s97 offen sc1
    v_mov_b32 v111, 0x3f803f80
    v_mov_b32 v112, 0x3f803f80
    v_mov_b32 v113, 0x3f803f80
    s_waitcnt lgkmcnt(4)
    v_mfma_f32_16x16x32_bf16 v[56:59], v[32:35], v[224:227], v[56:59]
    ds_read_b64_tr_b16 v[28:29], v5 offset:9216
    ds_read_b64_tr_b16 v[30:31], v5 offset:9728
    v_mfma_f32_16x16x32_bf16 v[72:75], v[32:35], v[228:231], v[72:75]
    v_mov_b32 v114, 0x3f803f80
    v_mov_b32 v115, 0x3f803f80
    v_mov_b32 v116, 0x3f803f80
    v_mov_b32 v117, 0x3f803f80
    v_mfma_f32_16x16x32_bf16 v[60:63], v[36:39], v[224:227], v[60:63]
    s_barrier
    s_add_u32 m0, s6, 32768
    ds_read_b64_tr_b16 v[32:33], v6 offset:9216
    ds_read_b64_tr_b16 v[34:35], v6 offset:9728
    v_mfma_f32_16x16x32_bf16 v[76:79], v[36:39], v[228:231], v[76:79]
    buffer_load_dwordx4 v3, s[32:35], s22 offen offset:2048 lds
    v_mov_b32 v118, 0x3f803f80
    s_waitcnt lgkmcnt(4)
    v_mfma_f32_16x16x32_bf16 v[48:51], v[40:43], v[232:235], v[48:51]
    ds_read_b64_tr_b16 v[36:37], v5 offset:16384
    ds_read_b64_tr_b16 v[38:39], v5 offset:16896
    v_mfma_f32_16x16x32_bf16 v[64:67], v[40:43], v[236:239], v[64:67]
    v_mov_b32 v119, 0x3f803f80
    v_mfma_f32_16x16x32_bf16 v[52:55], v[44:47], v[232:235], v[52:55]
    ds_read_b64_tr_b16 v[40:41], v6 offset:16384
    ds_read_b64_tr_b16 v[42:43], v6 offset:16896
    v_mfma_f32_16x16x32_bf16 v[68:71], v[44:47], v[236:239], v[68:71]
    buffer_load_dwordx4 v4, s[32:35], s22 offen offset:3072 lds
    s_waitcnt lgkmcnt(4)
    v_mfma_f32_16x16x32_bf16 v[56:59], v[28:31], v[232:235], v[56:59]
    s_add_u32 m0, s79, 49152
    ds_read_b64_tr_b16 v[44:45], v5 offset:17408
    ds_read_b64_tr_b16 v[46:47], v5 offset:17920
    v_mfma_f32_16x16x32_bf16 v[72:75], v[28:31], v[236:239], v[72:75]
    buffer_load_dwordx4 v9, s[24:27], s100 offen sc1 lds
    v_mfma_f32_16x16x32_bf16 v[60:63], v[32:35], v[232:235], v[60:63]
    ds_read_b64_tr_b16 v[28:29], v6 offset:17408
    ds_read_b64_tr_b16 v[30:31], v6 offset:17920
    v_mfma_f32_16x16x32_bf16 v[76:79], v[32:35], v[236:239], v[76:79]
    s_waitcnt lgkmcnt(4)
    v_mfma_f32_16x16x32_bf16 v[48:51], v[36:39], v[240:243], v[48:51]
    ds_read_b64_tr_b16 v[32:33], v5 offset:24576
    ds_read_b64_tr_b16 v[34:35], v5 offset:25088
    v_mfma_f32_16x16x32_bf16 v[64:67], v[36:39], v[244:247], v[64:67]
    v_mfma_f32_16x16x32_bf16 v[52:55], v[40:43], v[240:243], v[52:55]
    s_add_u32 m0, s79, 48128
    ds_read_b64_tr_b16 v[36:37], v6 offset:24576
    ds_read_b64_tr_b16 v[38:39], v6 offset:25088
    v_mfma_f32_16x16x32_bf16 v[68:71], v[40:43], v[244:247], v[68:71]
    buffer_load_dwordx4 v9, s[24:27], s100 offen offset:2048 sc1 lds
    s_waitcnt lgkmcnt(4)
    v_mfma_f32_16x16x32_bf16 v[56:59], v[44:47], v[240:243], v[56:59]
    ds_read_b64_tr_b16 v[40:41], v5 offset:25600
    ds_read_b64_tr_b16 v[42:43], v5 offset:26112
    v_mfma_f32_16x16x32_bf16 v[72:75], v[44:47], v[244:247], v[72:75]
    v_mfma_f32_16x16x32_bf16 v[60:63], v[28:31], v[240:243], v[60:63]
    s_barrier
    ds_read_b64_tr_b16 v[44:45], v6 offset:25600
    ds_read_b64_tr_b16 v[46:47], v6 offset:26112
    v_mfma_f32_16x16x32_bf16 v[76:79], v[28:31], v[244:247], v[76:79]
    s_waitcnt lgkmcnt(4)
    v_mfma_f32_16x16x32_bf16 v[48:51], v[32:35], v[248:251], v[48:51]
    v_mfma_f32_16x16x32_bf16 v[64:67], v[32:35], v[252:255], v[64:67]
    s_and_b32 s7, s4, 3
    s_mul_i32 s7, s7, 768
    v_min_u32 v101, 5, v0
    v_lshl_add_u32 v101, v101, 7, s7
    buffer_load_dword v100, v101, s[24:27], s14 offen sc1
    v_mfma_f32_16x16x32_bf16 v[52:55], v[36:39], v[248:251], v[52:55]
    v_mfma_f32_16x16x32_bf16 v[68:71], v[36:39], v[252:255], v[68:71]
    s_waitcnt lgkmcnt(0)
    v_mfma_f32_16x16x32_bf16 v[56:59], v[40:43], v[248:251], v[56:59]
    v_mfma_f32_16x16x32_bf16 v[72:75], v[40:43], v[252:255], v[72:75]
    v_mfma_f32_16x16x32_bf16 v[60:63], v[44:47], v[248:251], v[60:63]
    v_mfma_f32_16x16x32_bf16 v[76:79], v[44:47], v[252:255], v[76:79]
    s_nop 4
    v_pk_mul_f32 v[48:49], v[48:49], v[56:57]
    v_pk_mul_f32 v[50:51], v[50:51], v[58:59]
    v_pk_mul_f32 v[52:53], v[52:53], v[60:61]
    v_pk_mul_f32 v[54:55], v[54:55], v[62:63]
    v_cvt_pk_bf16_f32 v48, v48, v49
    v_cvt_pk_bf16_f32 v49, v50, v51
    v_cvt_pk_bf16_f32 v50, v52, v53
    v_cvt_pk_bf16_f32 v51, v54, v55
    buffer_store_dwordx4 v[48:51], v9, s[24:27], s85 offen sc1
    v_pk_mul_f32 v[64:65], v[64:65], v[72:73]
    v_pk_mul_f32 v[66:67], v[66:67], v[74:75]
    v_pk_mul_f32 v[68:69], v[68:69], v[76:77]
    v_pk_mul_f32 v[70:71], v[70:71], v[78:79]
    v_cvt_pk_bf16_f32 v64, v64, v65
    v_cvt_pk_bf16_f32 v65, v66, v67
    v_cvt_pk_bf16_f32 v66, v68, v69
    v_cvt_pk_bf16_f32 v67, v70, v71
    buffer_store_dwordx4 v[64:67], v9, s[24:27], s85 offen offset:1024 sc1
    s_branch L_att
L_V_Q:
    s_waitcnt vmcnt(7)
    s_barrier
    ds_read_b128 v[128:131], v1 offset:0
    ds_read_b64_tr_b16 v[28:29], v5 offset:0
    ds_read_b64_tr_b16 v[30:31], v5 offset:512
    ds_read_b128 v[132:135], v1 offset:4096
    ds_read_b64_tr_b16 v[32:33], v6 offset:0
    ds_read_b64_tr_b16 v[34:35], v6 offset:512
    ds_read_b128 v[136:139], v2 offset:0
    ds_read_b64_tr_b16 v[36:37], v5 offset:1024
    ds_read_b64_tr_b16 v[38:39], v5 offset:1536
    ds_read_b128 v[140:143], v2 offset:4096
    ds_read_b64_tr_b16 v[40:41], v6 offset:1024
    ds_read_b64_tr_b16 v[42:43], v6 offset:1536
    s_waitcnt lgkmcnt(6)
    v_mfma_f32_16x16x32_bf16 v[80:83], v[128:131], v[28:31], 0
    s_add_u32 m0, s78, 49152
    ds_read_b64_tr_b16 v[44:45], v5 offset:2048
    ds_read_b64_tr_b16 v[46:47], v5 offset:2560
    v_mfma_f32_16x16x32_bf16 v[88:91], v[132:135], v[28:31], 0
    buffer_load_dwordx4 v11, s[44:47], s65 offen lds
    s_add_u32 s66, s0, 589824
    s_cmp_ge_u32 s93, 5
    s_cselect_b32 s82, 1, 0
    s_mul_i32 s86, s82, 5
    s_sub_u32 s83, s93, s86
    v_mfma_f32_16x16x32_bf16 v[84:87], v[128:131], v[32:35], 0
    ds_read_b64_tr_b16 v[28:29], v6 offset:2048
    ds_read_b64_tr_b16 v[30:31], v6 offset:2560
    v_mfma_f32_16x16x32_bf16 v[92:95], v[132:135], v[32:35], 0
    buffer_load_dwordx4 v11, s[48:51], s65 offen offset:1024 lds
    s_add_u32 s73, s1, 688128
    s_sub_u32 s67, 786432, s0
    s_cmp_lt_u32 s94, 4
    s_cselect_b32 s86, 3, 1
    s_cmp_lt_u32 s83, s86
    s_cselect_b32 s9, 6, 7
    s_lshl_b32 s9, s9, 9
    s_waitcnt lgkmcnt(4)
    v_mfma_f32_16x16x32_bf16 v[96:99], v[36:39], v[128:131], 0
    ds_read_b64_tr_b16 v[32:33], v5 offset:12288
    ds_read_b64_tr_b16 v[34:35], v5 offset:12800
    v_mfma_f32_16x16x32_bf16 v[112:115], v[36:39], v[132:135], 0
    buffer_load_dwordx4 v11, s[52:55], s65 offen offset:2048 lds
    s_sub_u32 s74, 917504, s1
    s_add_u32 s68, s67, 196608
    s_lshl_b32 s86, s4, 5
    v_lshrrev_b32 v27, 3, v0
    v_add_u32 v25, s86, v27
    v_and_b32 v26, 7, v0
    v_mul_u32_u24 v25, s9, v25
    v_mfma_f32_16x16x32_bf16 v[100:103], v[40:43], v[128:131], 0
    s_add_u32 m0, s79, 32512
    ds_read_b64_tr_b16 v[36:37], v6 offset:12288
    ds_read_b64_tr_b16 v[38:39], v6 offset:12800
    v_mfma_f32_16x16x32_bf16 v[116:119], v[40:43], v[132:135], 0
    buffer_load_dwordx4 v10, s[28:31], s80 offen offset:256 lds
    s_add_u32 s75, s74, 229376
    v_lshl_add_u32 v25, v26, 4, v25
    s_cmp_ge_u32 s93, 10
    s_cselect_b32 s84, 2146435072, 0
    v_or_b32 v25, s84, v25
    s_mov_b64 s[20:21], s[44:45]
    s_waitcnt lgkmcnt(4)
    v_mfma_f32_16x16x32_bf16 v[104:107], v[44:47], v[128:131], 0
    ds_read_b64_tr_b16 v[40:41], v5 offset:13312
    ds_read_b64_tr_b16 v[42:43], v5 offset:13824
    v_mfma_f32_16x16x32_bf16 v[120:123], v[44:47], v[132:135], 0
    buffer_load_dwordx4 v10, s[28:31], s81 offen offset:1280 lds
    s_add_u32 s69, s67, 393216
    s_add_u32 s76, s74, 458752
    s_mov_b32 s22, 1837056
    s_mov_b32 s23, 0x20000
    s_cmp_eq_u32 s83, 1
    s_cselect_b64 s[20:21], s[48:49], s[20:21]
    v_mfma_f32_16x16x32_bf16 v[108:111], v[28:31], v[128:131], 0
    ds_read_b64_tr_b16 v[44:45], v6 offset:13312
    ds_read_b64_tr_b16 v[46:47], v6 offset:13824
    v_mfma_f32_16x16x32_bf16 v[124:127], v[28:31], v[132:135], 0
    s_add_u32 s70, s67, 589824
    s_add_u32 s77, s74, 688128
    s_add_u32 s71, s1, 229376
    s_cmp_eq_u32 s83, 2
    s_cselect_b64 s[20:21], s[52:53], s[20:21]
    s_cmp_eq_u32 s83, 3
    s_cselect_b64 s[20:21], s[56:57], s[20:21]
    s_waitcnt lgkmcnt(4)
    v_mfma_f32_16x16x32_bf16 v[80:83], v[136:139], v[32:35], v[80:83]
    s_waitcnt vmcnt(6)
    s_barrier
    ds_read_b64_tr_b16 v[28:29], v5 offset:14336
    ds_read_b64_tr_b16 v[30:31], v5 offset:14848
    v_mfma_f32_16x16x32_bf16 v[88:91], v[140:143], v[32:35], v[88:91]
    s_cmp_eq_u32 s83, 4
    s_cselect_b64 s[20:21], s[60:61], s[20:21]
    s_cmp_ge_u32 s83, 3
    s_cselect_b32 s11, 3, 0
    s_sub_u32 s11, s83, s11
    s_lshl_b32 s11, s11, 10
    v_mfma_f32_16x16x32_bf16 v[84:87], v[136:139], v[36:39], v[84:87]
    ds_read_b64_tr_b16 v[32:33], v6 offset:14336
    ds_read_b64_tr_b16 v[34:35], v6 offset:14848
    v_mfma_f32_16x16x32_bf16 v[92:95], v[140:143], v[36:39], v[92:95]
    ds_read_b128 v[144:147], v1 offset:16384
    s_mul_i32 s86, s9, s82
    s_lshl_b32 s86, s86, 8
    s_add_u32 s11, s11, s86
    s_lshl_b32 s9, s9, 3
    s_mul_i32 s88, s94, 5
    s_add_u32 s88, s88, s83
    s_lshl_b32 s88, s88, 9
    s_waitcnt lgkmcnt(5)
    v_mfma_f32_16x16x32_bf16 v[96:99], v[40:43], v[136:139], v[96:99]
    ds_read_b64_tr_b16 v[36:37], v5 offset:24576
    ds_read_b64_tr_b16 v[38:39], v5 offset:25088
    v_mfma_f32_16x16x32_bf16 v[112:115], v[40:43], v[140:143], v[112:115]
    ds_read_b128 v[148:151], v1 offset:20480
    buffer_load_dwordx4 v[64:67], v25, s[20:23], s11 offen
    s_add_u32 s11, s11, s9
    s_mul_i32 s86, s82, 40960
    s_add_u32 s88, s88, s86
    s_add_u32 s88, s88, 131072
    v_and_b32 v23, 1, v27
    v_lshl_add_u32 v22, v26, 1, v23
    v_mfma_f32_16x16x32_bf16 v[100:103], v[44:47], v[136:139], v[100:103]
    ds_read_b64_tr_b16 v[40:41], v6 offset:24576
    ds_read_b64_tr_b16 v[42:43], v6 offset:25088
    v_mfma_f32_16x16x32_bf16 v[116:119], v[44:47], v[140:143], v[116:119]
    ds_read_b128 v[152:155], v2 offset:16384
    buffer_load_dwordx4 v[68:71], v25, s[20:23], s11 offen
    s_add_u32 s11, s11, s9
    v_mov_b32 v56, 0x3f803f80
    v_mov_b32 v57, 0x3f803f80
    v_bfe_u32 v23, v0, 4, 1
    v_lshl_add_u32 v22, v22, 1, v23
    v_lshrrev_b32 v23, 5, v0
    s_waitcnt lgkmcnt(7)
    v_mfma_f32_16x16x32_bf16 v[104:107], v[28:31], v[136:139], v[104:107]
    ds_read_b64_tr_b16 v[44:45], v5 offset:25600
    ds_read_b64_tr_b16 v[46:47], v5 offset:26112
    v_mfma_f32_16x16x32_bf16 v[120:123], v[28:31], v[140:143], v[120:123]
    ds_read_b128 v[156:159], v2 offset:20480
    buffer_load_dwordx4 v[72:75], v25, s[20:23], s11 offen
    s_add_u32 s11, s11, s9
    s_waitcnt vmcnt(8)
    v_readfirstlane_b32 s5, v60
    v_lshl_add_u32 v22, v22, 1, v23
    s_lshl_b32 s86, s4, 8
    s_add_u32 s86, s86, 147456
    v_lshl_add_u32 v22, v22, 2, s86
    v_mfma_f32_16x16x32_bf16 v[108:111], v[32:35], v[136:139], v[108:111]
    ds_read_b64_tr_b16 v[28:29], v6 offset:25600
    ds_read_b64_tr_b16 v[30:31], v6 offset:26112
    v_mfma_f32_16x16x32_bf16 v[124:127], v[32:35], v[140:143], v[124:127]
    buffer_load_dwordx4 v[76:79], v25, s[20:23], s11 offen
    s_mov_b32 s20, 0x0000ffff
    s_mov_b32 s21, 0x0000ffff
    v_mfma_f32_4x4x4_16b_bf16 v[52:55], v[56:57], v[48:49], 0
    s_mul_i32 s5, s5, 0x9E3779B1
    s_lshl_b32 s86, s4, 3
    v_add_u32 v26, s86, v26
    v_lshlrev_b32 v24, 3, v26
    v_lshl_add_u32 v24, v27, 28, v24
    s_waitcnt lgkmcnt(6)
    v_mfma_f32_16x16x32_bf16 v[80:83], v[144:147], v[36:39], v[80:83]
    ds_read_b64_tr_b16 v[32:33], v5 offset:26624
    ds_read_b64_tr_b16 v[34:35], v5 offset:27136
    v_mfma_f32_16x16x32_bf16 v[88:91], v[148:151], v[36:39], v[88:91]
    v_and_b32 v20, 0x30, v9
    s_mov_b64 vcc, 0x3f80
    v_lshlrev_b64 v[20:21], v20, vcc
    v_or_b32 v24, s84, v24
    v_lshlrev_b32 v27, 8, v27
    v_lshl_add_u32 v23, v26, 2, v27
    v_add_u32 v23, 147456, v23
    s_lshl_b32 s8, s91, 2
    s_lshr_b32 s3, s92, 3
    s_add_u32 s8, s8, s3
    v_mfma_f32_16x16x32_bf16 v[84:87], v[144:147], v[40:43], v[84:87]
    s_add_u32 m0, s78, 73728
    ds_read_b64_tr_b16 v[36:37], v6 offset:26624
    ds_read_b64_tr_b16 v[38:39], v6 offset:27136
    v_mfma_f32_16x16x32_bf16 v[92:95], v[148:151], v[40:43], v[92:95]
    buffer_load_dwordx4 v11, s[44:47], s66 offen lds
    v_mfma_f32_4x4x4_16b_bf16 v[52:55], v[56:57], v[50:51], v[52:55]
    s_add_u32 s5, s5, 0x7F4A7C15
    s_lshl_b32 s8, s8, 1
    s_lshr_b32 s19, s4, 2
    s_add_u32 s8, s8, s19
    s_and_b32 s9, s92, 7
    s_lshl_b32 s9, s9, 7
    s_lshl_b32 s11, s19, 15
    s_waitcnt lgkmcnt(4)
    v_mfma_f32_16x16x32_bf16 v[96:99], v[44:47], v[144:147], v[96:99]
    ds_read_b64_tr_b16 v[40:41], v5 offset:36864
    ds_read_b64_tr_b16 v[42:43], v5 offset:37376
    v_mfma_f32_16x16x32_bf16 v[112:115], v[44:47], v[148:151], v[112:115]
    v_add_f32_dpp v52, v52, v52 row_ror:1 row_mask:0xf bank_mask:0xf
    s_nop 1
    v_add_f32_dpp v52, v52, v52 row_ror:2 row_mask:0xf bank_mask:0xf
    s_add_u32 s11, s11, s9
    s_and_b32 s16, s4, 3
    s_lshl_b32 s22, s16, 17
    s_add_u32 s22, s22, s11
    s_add_u32 s36, s36, s22
    s_addc_u32 s37, s37, 0
    s_sub_u32 s38, 524288, s22
    s_mov_b32 s39, 0x20000
    v_mfma_f32_16x16x32_bf16 v[100:103], v[28:31], v[144:147], v[100:103]
    ds_read_b64_tr_b16 v[44:45], v6 offset:36864
    ds_read_b64_tr_b16 v[46:47], v6 offset:37376
    v_mfma_f32_16x16x32_bf16 v[116:119], v[28:31], v[148:151], v[116:119]
    buffer_load_dwordx4 v11, s[48:51], s66 offen offset:1024 lds
    v_add_f32_dpp v52, v52, v52 row_ror:4 row_mask:0xf bank_mask:0xf
    s_nop 1
    v_add_f32_dpp v52, v52, v52 row_ror:8 row_mask:0xf bank_mask:0xf
    s_mul_i32 s22, s16, 458752
    s_add_u32 s22, s22, s11
    s_add_u32 s32, s32, s22
    s_addc_u32 s33, s33, 0
    s_sub_u32 s34, 1835008, s22
    s_mov_b32 s35, 0x20000
    s_lshl_b32 s6, s16, 13
    s_waitcnt lgkmcnt(4)
    v_mfma_f32_16x16x32_bf16 v[104:107], v[32:35], v[144:147], v[104:107]
    ds_read_b64_tr_b16 v[28:29], v5 offset:37888
    ds_read_b64_tr_b16 v[30:31], v5 offset:38400
    v_mfma_f32_16x16x32_bf16 v[120:123], v[32:35], v[148:151], v[120:123]
    v_mov_b32 v56, v52
    s_nop 1
    v_permlane16_swap_b32 v52, v56
    v_add_f32 v52, v52, v56
    s_lshl_b32 s3, s19, 12
    s_add_u32 s6, s6, s3
    s_mul_i32 s17, s8, 147456
    s_mul_i32 s3, s16, 28672
    s_add_u32 s17, s17, s3
    s_add_u32 s17, s17, 7340032
    s_lshl_b32 s14, s8, 14
    v_mfma_f32_16x16x32_bf16 v[108:111], v[36:39], v[144:147], v[108:111]
    ds_read_b64_tr_b16 v[32:33], v6 offset:37888
    ds_read_b64_tr_b16 v[34:35], v6 offset:38400
    v_mfma_f32_16x16x32_bf16 v[124:127], v[36:39], v[148:151], v[124:127]
    buffer_load_dwordx4 v11, s[52:55], s66 offen offset:2048 lds
    v_mov_b32 v56, v52
    s_nop 1
    v_permlane32_swap_b32 v52, v56
    v_add_f32 v52, v52, v56
    v_mul_f32 v60, 0xbb000000, v52
    s_add_u32 s14, s14, 16782336
    s_lshl_b32 s15, s8, 2
    s_add_u32 s15, s15, s16
    s_lshl_b32 s15, s15, 10
    s_add_u32 s15, s15, 17825792
    s_waitcnt lgkmcnt(4)
    v_mfma_f32_16x16x32_bf16 v[80:83], v[152:155], v[40:43], v[80:83]
    s_waitcnt vmcnt(7)
    s_barrier
    ds_read_b64_tr_b16 v[36:37], v5 offset:38912
    ds_read_b64_tr_b16 v[38:39], v5 offset:39424
    v_mfma_f32_16x16x32_bf16 v[88:91], v[156:159], v[40:43], v[88:91]
    v_mul_f32 v61, 0xbb000000, v52
    v_mov_b64 v[62:63], v[60:61]
    s_lshr_b32 s3, s8, 1
    s_lshl_b32 s3, s3, 3
    s_add_u32 s3, s3, s4
    s_lshl_b32 s13, s3, 13
    s_add_u32 s13, s13, s9
    s_lshl_b32 s23, s3, 7
    v_mfma_f32_16x16x32_bf16 v[84:87], v[152:155], v[44:47], v[84:87]
    s_add_u32 m0, s79, -384
    ds_read_b64_tr_b16 v[40:41], v6 offset:38912
    ds_read_b64_tr_b16 v[42:43], v6 offset:39424
    v_mfma_f32_16x16x32_bf16 v[92:95], v[156:159], v[44:47], v[92:95]
    buffer_load_dwordx4 v10, s[28:31], s80 offen offset:384 lds
    ds_read_b128 v[160:163], v1 offset:32768
    v_mfma_f32_4x4x4_16b_bf16 v[52:55], v[20:21], v[48:49], v[60:63]
    v_mfma_f32_4x4x4_16b_bf16 v[56:59], v[20:21], v[50:51], v[60:63]
    s_waitcnt vmcnt(4)
    v_mfma_f32_4x4x4_16b_bf16 v[12:15], v[20:21], v[64:65], 0
    v_mfma_f32_4x4x4_16b_bf16 v[16:19], v[20:21], v[66:67], 0
    s_add_u32 s23, s23, 65544
    s_lshl_b32 s8, s93, 2
    s_add_u32 s8, s8, s16
    s_waitcnt lgkmcnt(5)
    v_mfma_f32_16x16x32_bf16 v[96:99], v[28:31], v[152:155], v[96:99]
    ds_read_b64_tr_b16 v[44:45], v3 offset:0
    ds_read_b64_tr_b16 v[46:47], v3 offset:512
    v_mfma_f32_16x16x32_bf16 v[112:115], v[28:31], v[156:159], v[112:115]
    ds_read_b128 v[164:167], v1 offset:36864
    v_mul_f32 v50, v52, v52
    v_mul_f32 v51, v53, v53
    v_fmac_f32 v50, v54, v54
    v_fmac_f32 v51, v55, v55
    v_mfma_f32_4x4x4_16b_bf16 v[12:15], v[20:21], v[68:69], v[12:15]
    v_mfma_f32_4x4x4_16b_bf16 v[16:19], v[20:21], v[70:71], v[16:19]
    s_lshl_b32 s89, s8, 9
    s_add_u32 s89, s89, 65536
    s_mul_i32 s90, s94, 2560
    v_mfma_f32_16x16x32_bf16 v[100:103], v[32:35], v[152:155], v[100:103]
    ds_read_b64_tr_b16 v[28:29], v4 offset:0
    ds_read_b64_tr_b16 v[30:31], v4 offset:512
    v_mfma_f32_16x16x32_bf16 v[116:119], v[32:35], v[156:159], v[116:119]
    buffer_load_dwordx4 v10, s[28:31], s81 offen offset:1408 lds
    ds_read_b128 v[168:171], v2 offset:32768
    v_fmac_f32 v50, v56, v56
    v_fmac_f32 v51, v57, v57
    v_fmac_f32 v50, v58, v58
    v_mfma_f32_4x4x4_16b_bf16 v[12:15], v[20:21], v[72:73], v[12:15]
    v_mfma_f32_4x4x4_16b_bf16 v[16:19], v[20:21], v[74:75], v[16:19]
    s_lshl_b32 s9, s19, 8
    s_add_u32 s90, s90, s9
    s_add_u32 s90, s90, 131072
    s_waitcnt lgkmcnt(7)
    v_mfma_f32_16x16x32_bf16 v[104:107], v[36:39], v[152:155], v[104:107]
    ds_read_b64_tr_b16 v[32:33], v3 offset:1024
    ds_read_b64_tr_b16 v[34:35], v3 offset:1536
    v_mfma_f32_16x16x32_bf16 v[120:123], v[36:39], v[156:159], v[120:123]
    ds_read_b128 v[172:175], v2 offset:36864
    v_fmac_f32 v51, v59, v59
    v_add_f32 v50, v50, v51
    v_mfma_f32_4x4x4_16b_bf16 v[12:15], v[20:21], v[76:77], v[12:15]
    v_mfma_f32_4x4x4_16b_bf16 v[16:19], v[20:21], v[78:79], v[16:19]
    s_bfe_u32 s9, s95, 0x30007
    s_lshl_b32 s9, s9, 1
    s_add_u32 s9, s9, s19
    s_lshl_b32 s9, s9, 17
    s_lshl_b32 s11, s8, 11
    v_mfma_f32_16x16x32_bf16 v[108:111], v[40:43], v[152:155], v[108:111]
    s_mov_b32 m0, s78
    ds_read_b64_tr_b16 v[36:37], v4 offset:1024
    ds_read_b64_tr_b16 v[38:39], v4 offset:1536
    v_mfma_f32_16x16x32_bf16 v[124:127], v[40:43], v[156:159], v[124:127]
    buffer_load_dwordx4 v11, s[44:47], s67 offen lds
    v_add_f32_dpp v50, v50, v50 row_ror:1 row_mask:0xf bank_mask:0xf
    s_nop 1
    v_add_f32_dpp v50, v50, v50 row_ror:2 row_mask:0xf bank_mask:0xf
    v_and_b32 v64, 8, v0
    s_add_u32 s9, s9, s11
    s_lshr_b32 s11, s95, 10
    s_lshl_b32 s11, s11, 21
    s_add_u32 s82, s9, s11
    s_add_u32 s82, s82, 1048576
    s_waitcnt lgkmcnt(6)
    v_mfma_f32_16x16x32_bf16 v[80:83], v[160:163], v[44:47], v[80:83]
    ds_read_b64_tr_b16 v[40:41], v3 offset:2048
    ds_read_b64_tr_b16 v[42:43], v3 offset:2560
    v_mfma_f32_16x16x32_bf16 v[88:91], v[164:167], v[44:47], v[88:91]
    v_add_f32_dpp v50, v50, v50 row_ror:4 row_mask:0xf bank_mask:0xf
    s_nop 1
    v_add_f32_dpp v50, v50, v50 row_ror:8 row_mask:0xf bank_mask:0xf
    v_permlane32_swap_b32 v12, v13
    v_permlane32_swap_b32 v14, v15
    v_permlane32_swap_b32 v16, v17
    v_permlane32_swap_b32 v18, v19
    v_add_f32 v12, v12, v13
    v_add_f32 v14, v14, v15
    s_add_u32 s84, s9, 786432
    s_and_b32 s84, s84, 1048575
    v_mfma_f32_16x16x32_bf16 v[84:87], v[160:163], v[28:31], v[84:87]
    ds_read_b64_tr_b16 v[44:45], v4 offset:2048
    ds_read_b64_tr_b16 v[46:47], v4 offset:2560
    v_mfma_f32_16x16x32_bf16 v[92:95], v[164:167], v[28:31], v[92:95]
    buffer_load_dwordx4 v11, s[48:51], s67 offen offset:1024 lds
    v_mov_b32 v49, v50
    s_nop 1
    v_permlane16_swap_b32 v50, v49
    v_add_f32 v50, v50, v49
    v_add_f32 v16, v16, v17
    v_add_f32 v18, v18, v19
    v_cmp_eq_u32 vcc, 0, v64
    s_add_u32 s84, s84, 3145728
    s_xor_b32 s9, s9, 524288
    s_add_u32 s9, s9, 1048576
    s_waitcnt lgkmcnt(4)
    v_mfma_f32_16x16x32_bf16 v[96:99], v[32:35], v[160:163], v[96:99]
    ds_read_b64_tr_b16 v[28:29], v3 offset:12288
    ds_read_b64_tr_b16 v[30:31], v3 offset:12800
    v_mfma_f32_16x16x32_bf16 v[112:115], v[32:35], v[164:167], v[112:115]
    v_mov_b32 v49, v50
    s_nop 1
    v_permlane32_swap_b32 v50, v49
    v_add_f32 v50, v50, v49
    v_mov_b32 v49, 0x3727c5ac
    v_fmac_f32 v49, 0x3b000000, v50
    v_permlane16_swap_b32 v12, v14
    v_permlane16_swap_b32 v16, v18
    v_add_f32 v12, v12, v14
    s_mul_i32 s11, s8, 147456
    s_lshl_b32 s22, s19, 11
    v_mfma_f32_16x16x32_bf16 v[100:103], v[36:39], v[160:163], v[100:103]
    ds_read_b64_tr_b16 v[32:33], v4 offset:12288
    ds_read_b64_tr_b16 v[34:35], v4 offset:12800
    v_mfma_f32_16x16x32_bf16 v[116:119], v[36:39], v[164:167], v[116:119]
    buffer_load_dwordx4 v11, s[52:55], s67 offen offset:2048 lds
    v_rsq_f32 v54, v49
    v_mov_b32 v52, v60
    v_mov_b32 v53, s5
    v_mov_b32 v55, s5
    v_add_f32 v16, v16, v18
    s_add_u32 s11, s11, s22
    s_add_u32 s11, s11, 7340032
    s_lshl_b32 s85, s85, 12
    s_add_u32 s85, s85, s11
    s_waitcnt lgkmcnt(4)
    v_mfma_f32_16x16x32_bf16 v[104:107], v[40:43], v[160:163], v[104:107]
    ds_read_b64_tr_b16 v[36:37], v3 offset:13312
    ds_read_b64_tr_b16 v[38:39], v3 offset:13824
    v_mfma_f32_16x16x32_bf16 v[120:123], v[40:43], v[164:167], v[120:123]
    s_cmp_eq_u32 s2, 4
    s_cselect_b32 s7, 1024, 0
    v_subrev_u32 v10, s7, v10
    v_add_f32_dpp v12, v12, v12 row_ror:8 row_mask:0xf bank_mask:0xf
    v_add_f32_dpp v16, v16, v16 row_ror:8 row_mask:0xf bank_mask:0xf
    v_cndmask_b32 v12, v16, v12, vcc
    ds_write_b32 v22, v12
    s_lshl_b32 s100, s100, 12
    s_add_u32 s11, s11, s100
    v_mfma_f32_16x16x32_bf16 v[108:111], v[44:47], v[160:163], v[108:111]
    s_add_u32 m0, s79, 15872
    ds_read_b64_tr_b16 v[40:41], v4 offset:13312
    ds_read_b64_tr_b16 v[42:43], v4 offset:13824
    v_mfma_f32_16x16x32_bf16 v[124:127], v[44:47], v[164:167], v[124:127]
    buffer_load_dwordx4 v10, s[28:31], s80 offen offset:512 lds
    s_mov_b64 exec, 1
    buffer_store_dwordx4 v[52:55], off, s[24:27], s87 sc1
    s_mov_b64 exec, -1
    s_cmp_lt_u32 s94, 4
    s_cselect_b32 s83, s9, s11
    s_lshl_b32 s86, s8, 7
    s_lshl_b32 s9, s94, 1
    s_add_u32 s9, s9, s19
    s_waitcnt lgkmcnt(5)
    v_mfma_f32_16x16x32_bf16 v[80:83], v[168:171], v[28:31], v[80:83]
    s_waitcnt vmcnt(5) lgkmcnt(2)
    s_barrier
    ds_read_b64_tr_b16 v[44:45], v3 offset:14336
    ds_read_b64_tr_b16 v[46:47], v3 offset:14848
    v_mfma_f32_16x16x32_bf16 v[88:91], v[172:175], v[28:31], v[88:91]
    ds_read_b32 v12, v23
    s_add_u32 s86, s86, s9
    s_lshl_b32 s86, s86, 7
    s_add_u32 s86, s86, 16777216
    v_mfma_f32_16x16x32_bf16 v[84:87], v[168:171], v[32:35], v[84:87]
    ds_read_b64_tr_b16 v[28:29], v4 offset:14336
    ds_read_b64_tr_b16 v[30:31], v4 offset:14848
    v_mfma_f32_16x16x32_bf16 v[92:95], v[172:175], v[32:35], v[92:95]
    buffer_load_dwordx4 v10, s[28:31], s81 offen offset:1536 lds
    ds_read_b128 v[176:179], v1 offset:0
    s_and_b32 s8, s92, 3
    s_waitcnt lgkmcnt(6)
    v_mfma_f32_16x16x32_bf16 v[96:99], v[36:39], v[168:171], v[96:99]
    ds_read_b64_tr_b16 v[32:33], v3 offset:24576
    ds_read_b64_tr_b16 v[34:35], v3 offset:25088
    v_mfma_f32_16x16x32_bf16 v[112:115], v[36:39], v[172:175], v[112:115]
    ds_read_b128 v[180:183], v1 offset:4096
    s_lshl_b32 s22, s91, 2
    s_add_u32 s8, s8, s22
    v_mfma_f32_16x16x32_bf16 v[100:103], v[40:43], v[168:171], v[100:103]
    s_add_u32 m0, s78, 24576
    ds_read_b64_tr_b16 v[36:37], v4 offset:24576
    ds_read_b64_tr_b16 v[38:39], v4 offset:25088
    v_mfma_f32_16x16x32_bf16 v[116:119], v[40:43], v[172:175], v[116:119]
    buffer_load_dwordx4 v11, s[44:47], s68 offen lds
    ds_read_b128 v[184:187], v2 offset:0
    s_waitcnt lgkmcnt(9)
    v_mov_b32 v13, v12
    s_waitcnt lgkmcnt(7)
    v_mfma_f32_16x16x32_bf16 v[104:107], v[44:47], v[168:171], v[104:107]
    ds_read_b64_tr_b16 v[40:41], v3 offset:25600
    ds_read_b64_tr_b16 v[42:43], v3 offset:26112
    v_mfma_f32_16x16x32_bf16 v[120:123], v[44:47], v[172:175], v[120:123]
    ds_read_b128 v[188:191], v2 offset:4096
    v_permlane32_swap_b32 v12, v13
    v_add_f32 v12, v12, v13
    v_mov_b32 v13, v12
    v_mfma_f32_16x16x32_bf16 v[108:111], v[28:31], v[168:171], v[108:111]
    ds_read_b64_tr_b16 v[44:45], v4 offset:25600
    ds_read_b64_tr_b16 v[46:47], v4 offset:26112
    v_mfma_f32_16x16x32_bf16 v[124:127], v[28:31], v[172:175], v[124:127]
    buffer_load_dwordx4 v11, s[48:51], s68 offen offset:1024 lds
    v_permlane16_swap_b32 v12, v13
    v_add_f32 v12, v12, v13
    v_mov_b32 v15, s5
    s_waitcnt lgkmcnt(6)
    v_mfma_f32_16x16x32_bf16 v[80:83], v[176:179], v[32:35], v[80:83]
    ds_read_b64_tr_b16 v[28:29], v3 offset:26624
    ds_read_b64_tr_b16 v[30:31], v3 offset:27136
    v_mfma_f32_16x16x32_bf16 v[88:91], v[180:183], v[32:35], v[88:91]
    v_add_f32_dpp v14, v12, v12 row_ror:8 row_mask:0xf bank_mask:0xf
    buffer_store_dwordx2 v[14:15], v24, s[24:27], s88 offen sc1
    v_mfma_f32_16x16x32_bf16 v[84:87], v[176:179], v[36:39], v[84:87]
    ds_read_b64_tr_b16 v[32:33], v4 offset:26624
    ds_read_b64_tr_b16 v[34:35], v4 offset:27136
    v_mfma_f32_16x16x32_bf16 v[92:95], v[180:183], v[36:39], v[92:95]
    buffer_load_dwordx4 v11, s[52:55], s68 offen offset:2048 lds
    v_and_b32 v49, 31, v0
    v_lshlrev_b32 v49, 3, v49
    s_waitcnt lgkmcnt(4)
    v_mfma_f32_16x16x32_bf16 v[96:99], v[40:43], v[176:179], v[96:99]
    ds_read_b64_tr_b16 v[36:37], v3 offset:36864
    ds_read_b64_tr_b16 v[38:39], v3 offset:37376
    v_mfma_f32_16x16x32_bf16 v[112:115], v[40:43], v[180:183], v[112:115]
    v_and_b32 v48, 0xf0, v9
    v_lshrrev_b32 v50, 5, v0
    v_lshl_add_u32 v48, v50, 8, v48
    v_mfma_f32_16x16x32_bf16 v[100:103], v[44:47], v[176:179], v[100:103]
    s_add_u32 m0, s79, 32128
    ds_read_b64_tr_b16 v[40:41], v4 offset:36864
    ds_read_b64_tr_b16 v[42:43], v4 offset:37376
    v_mfma_f32_16x16x32_bf16 v[116:119], v[44:47], v[180:183], v[116:119]
    buffer_load_dwordx4 v10, s[28:31], s80 offen offset:640 lds
    v_mul_u32_u24 v50, 40960, v50
    s_waitcnt lgkmcnt(4)
    v_mfma_f32_16x16x32_bf16 v[104:107], v[28:31], v[176:179], v[104:107]
    ds_read_b64_tr_b16 v[44:45], v3 offset:37888
    ds_read_b64_tr_b16 v[46:47], v3 offset:38400
    v_mfma_f32_16x16x32_bf16 v[120:123], v[28:31], v[180:183], v[120:123]
    v_add_u32 v49, v49, v50
    v_lshrrev_b32 v51, 4, v0
    v_lshlrev_b32 v51, 10, v51
    v_mfma_f32_16x16x32_bf16 v[108:111], v[32:35], v[176:179], v[108:111]
    ds_read_b64_tr_b16 v[28:29], v4 offset:37888
    ds_read_b64_tr_b16 v[30:31], v4 offset:38400
    v_mfma_f32_16x16x32_bf16 v[124:127], v[32:35], v[180:183], v[124:127]
    buffer_load_dwordx4 v10, s[28:31], s81 offen offset:1664 lds
    s_lshr_b32 s19, s92, 2
    s_lshl_b32 s19, s19, 3
    s_waitcnt lgkmcnt(4)
    v_mfma_f32_16x16x32_bf16 v[80:83], v[184:187], v[36:39], v[80:83]
    s_waitcnt vmcnt(6)
    s_barrier
    ds_read_b64_tr_b16 v[32:33], v3 offset:38912
    ds_read_b64_tr_b16 v[34:35], v3 offset:39424
    v_mfma_f32_16x16x32_bf16 v[88:91], v[188:191], v[36:39], v[88:91]
    s_lshl_b32 s9, s4, 1
    v_mfma_f32_16x16x32_bf16 v[84:87], v[184:187], v[40:43], v[84:87]
    s_add_u32 m0, s78, 49152
    ds_read_b64_tr_b16 v[36:37], v4 offset:38912
    ds_read_b64_tr_b16 v[38:39], v4 offset:39424
    v_mfma_f32_16x16x32_bf16 v[92:95], v[188:191], v[40:43], v[92:95]
    buffer_load_dwordx4 v11, s[44:47], s69 offen lds
    ds_read_b128 v[192:195], v1 offset:16384
    s_waitcnt lgkmcnt(5)
    v_mfma_f32_16x16x32_bf16 v[96:99], v[44:47], v[184:187], v[96:99]
    ds_read_b64_tr_b16 v[40:41], v5 offset:0
    ds_read_b64_tr_b16 v[42:43], v5 offset:512
    v_mfma_f32_16x16x32_bf16 v[112:115], v[44:47], v[188:191], v[112:115]
    ds_read_b128 v[196:199], v1 offset:20480
    s_add_u32 s9, s9, s19
    s_add_u32 s19, s19, s4
    v_mfma_f32_16x16x32_bf16 v[100:103], v[28:31], v[184:187], v[100:103]
    ds_read_b64_tr_b16 v[44:45], v6 offset:0
    ds_read_b64_tr_b16 v[46:47], v6 offset:512
    v_mfma_f32_16x16x32_bf16 v[116:119], v[28:31], v[188:191], v[116:119]
    buffer_load_dwordx4 v11, s[48:51], s69 offen offset:1024 lds
    ds_read_b128 v[200:203], v2 offset:16384
    s_waitcnt lgkmcnt(7)
    v_mfma_f32_16x16x32_bf16 v[104:107], v[32:35], v[184:187], v[104:107]
    ds_read_b64_tr_b16 v[28:29], v5 offset:1024
    ds_read_b64_tr_b16 v[30:31], v5 offset:1536
    v_mfma_f32_16x16x32_bf16 v[120:123], v[32:35], v[188:191], v[120:123]
    ds_read_b128 v[204:207], v2 offset:20480
    s_cmp_lt_u32 s9, 8
    s_cselect_b32 s22, 0, 8
    v_mfma_f32_16x16x32_bf16 v[108:111], v[36:39], v[184:187], v[108:111]
    ds_read_b64_tr_b16 v[32:33], v6 offset:1024
    ds_read_b64_tr_b16 v[34:35], v6 offset:1536
    v_mfma_f32_16x16x32_bf16 v[124:127], v[36:39], v[188:191], v[124:127]
    buffer_load_dwordx4 v11, s[52:55], s69 offen offset:2048 lds
    s_sub_u32 s9, s9, s22
    s_mul_i32 s3, s19, 144
    s_waitcnt lgkmcnt(6)
    v_mfma_f32_16x16x32_bf16 v[80:83], v[192:195], v[40:43], v[80:83]
    ds_read_b64_tr_b16 v[36:37], v5 offset:2048
    ds_read_b64_tr_b16 v[38:39], v5 offset:2560
    v_mfma_f32_16x16x32_bf16 v[88:91], v[196:199], v[40:43], v[88:91]
    s_add_u32 s3, s3, s8
    s_lshl_b32 s3, s3, 10
    s_add_u32 s3, s3, 7454720
    v_mfma_f32_16x16x32_bf16 v[84:87], v[192:195], v[44:47], v[84:87]
    s_add_u32 m0, s79, -768
    ds_read_b64_tr_b16 v[40:41], v6 offset:2048
    ds_read_b64_tr_b16 v[42:43], v6 offset:2560
    v_mfma_f32_16x16x32_bf16 v[92:95], v[196:199], v[44:47], v[92:95]
    buffer_load_dwordx4 v10, s[28:31], s80 offen offset:768 lds
    s_and_b32 s22, s8, 1
    s_waitcnt lgkmcnt(4)
    v_mfma_f32_16x16x32_bf16 v[96:99], v[28:31], v[192:195], v[96:99]
    ds_read_b64_tr_b16 v[44:45], v5 offset:12288
    ds_read_b64_tr_b16 v[46:47], v5 offset:12800
    v_mfma_f32_16x16x32_bf16 v[112:115], v[28:31], v[196:199], v[112:115]
    s_lshl_b32 s22, s22, 9
    s_sub_u32 s3, s3, s22
    s_lshl_b32 s16, s19, 5
    v_mfma_f32_16x16x32_bf16 v[100:103], v[32:35], v[192:195], v[100:103]
    ds_read_b64_tr_b16 v[28:29], v6 offset:12288
    ds_read_b64_tr_b16 v[30:31], v6 offset:12800
    v_mfma_f32_16x16x32_bf16 v[116:119], v[32:35], v[196:199], v[116:119]
    buffer_load_dwordx4 v10, s[28:31], s81 offen offset:1792 lds
    s_add_u32 s16, s16, s8
    s_lshl_b32 s16, s16, 7
    s_waitcnt lgkmcnt(4)
    v_mfma_f32_16x16x32_bf16 v[104:107], v[36:39], v[192:195], v[104:107]
    ds_read_b64_tr_b16 v[32:33], v5 offset:13312
    ds_read_b64_tr_b16 v[34:35], v5 offset:13824
    v_mfma_f32_16x16x32_bf16 v[120:123], v[36:39], v[196:199], v[120:123]
    v_lshlrev_b32 v59, 16, v0
    s_bfe_u32 s10, s14, 0x5000f
    s_lshl_b32 s10, s10, 10
    v_mfma_f32_16x16x32_bf16 v[108:111], v[40:43], v[192:195], v[108:111]
    ds_read_b64_tr_b16 v[36:37], v6 offset:13312
    ds_read_b64_tr_b16 v[38:39], v6 offset:13824
    v_mfma_f32_16x16x32_bf16 v[124:127], v[40:43], v[196:199], v[124:127]
    s_mov_b64 exec, 0x7f
    buffer_load_dword v58, v59, s[32:35], s10 offen
    s_mov_b64 exec, 3
    buffer_load_dword v58, v59, s[36:39], s10 offen
    s_mov_b64 exec, -1
    s_waitcnt lgkmcnt(4)
    v_mfma_f32_16x16x32_bf16 v[80:83], v[200:203], v[44:47], v[80:83]
    s_waitcnt vmcnt(7)
    s_barrier
    ds_read_b64_tr_b16 v[40:41], v5 offset:14336
    ds_read_b64_tr_b16 v[42:43], v5 offset:14848
    v_mfma_f32_16x16x32_bf16 v[88:91], v[204:207], v[44:47], v[88:91]
    s_add_u32 s16, s16, 17825792
    v_mfma_f32_16x16x32_bf16 v[84:87], v[200:203], v[28:31], v[84:87]
    s_add_u32 m0, s78, 73728
    ds_read_b64_tr_b16 v[44:45], v6 offset:14336
    ds_read_b64_tr_b16 v[46:47], v6 offset:14848
    v_mfma_f32_16x16x32_bf16 v[92:95], v[204:207], v[28:31], v[92:95]
    buffer_load_dwordx4 v11, s[44:47], s70 offen lds
    ds_read_b128 v[208:211], v1 offset:32768
    s_waitcnt lgkmcnt(5)
    v_mfma_f32_16x16x32_bf16 v[96:99], v[32:35], v[200:203], v[96:99]
    ds_read_b64_tr_b16 v[28:29], v5 offset:24576
    ds_read_b64_tr_b16 v[30:31], v5 offset:25088
    v_mfma_f32_16x16x32_bf16 v[112:115], v[32:35], v[204:207], v[112:115]
    ds_read_b128 v[212:215], v1 offset:36864
    s_cmp_lt_u32 s95, 1024
    s_cselect_b32 s101, 0x3eb8aa3b, 1.0
    v_mfma_f32_16x16x32_bf16 v[100:103], v[36:39], v[200:203], v[100:103]
    ds_read_b64_tr_b16 v[32:33], v6 offset:24576
    ds_read_b64_tr_b16 v[34:35], v6 offset:25088
    v_mfma_f32_16x16x32_bf16 v[116:119], v[36:39], v[204:207], v[116:119]
    buffer_load_dwordx4 v11, s[48:51], s70 offen offset:1024 lds
    ds_read_b128 v[216:219], v2 offset:32768
    s_add_u32 s22, s91, 3
    s_waitcnt lgkmcnt(7)
    v_mfma_f32_16x16x32_bf16 v[104:107], v[40:43], v[200:203], v[104:107]
    ds_read_b64_tr_b16 v[36:37], v5 offset:25600
    ds_read_b64_tr_b16 v[38:39], v5 offset:26112
    v_mfma_f32_16x16x32_bf16 v[120:123], v[40:43], v[204:207], v[120:123]
    ds_read_b128 v[220:223], v2 offset:36864
    s_and_b32 s22, s22, 3
    s_add_u32 s42, s91, 4
    v_mfma_f32_16x16x32_bf16 v[108:111], v[44:47], v[200:203], v[108:111]
    ds_read_b64_tr_b16 v[40:41], v6 offset:25600
    ds_read_b64_tr_b16 v[42:43], v6 offset:26112
    v_mfma_f32_16x16x32_bf16 v[124:127], v[44:47], v[204:207], v[124:127]
    buffer_load_dwordx4 v11, s[52:55], s70 offen offset:2048 lds
    s_xor_b32 s43, s91, 2
    s_add_u32 s97, s91, 8
    s_waitcnt lgkmcnt(6)
    v_mfma_f32_16x16x32_bf16 v[80:83], v[208:211], v[28:31], v[80:83]
    ds_read_b64_tr_b16 v[44:45], v5 offset:26624
    ds_read_b64_tr_b16 v[46:47], v5 offset:27136
    v_mfma_f32_16x16x32_bf16 v[88:91], v[212:215], v[28:31], v[88:91]
    s_cmp_lt_u32 s91, 4
    s_cselect_b32 s22, s22, s42
    s_cselect_b32 s43, s43, s97
    v_mfma_f32_16x16x32_bf16 v[84:87], v[208:211], v[32:35], v[84:87]
    s_add_u32 m0, s79, 15488
    ds_read_b64_tr_b16 v[28:29], v6 offset:26624
    ds_read_b64_tr_b16 v[30:31], v6 offset:27136
    v_mfma_f32_16x16x32_bf16 v[92:95], v[212:215], v[32:35], v[92:95]
    buffer_load_dwordx4 v10, s[28:31], s80 offen offset:896 lds
    s_lshl_b32 s22, s22, 8
    s_waitcnt lgkmcnt(4)
    v_mfma_f32_16x16x32_bf16 v[96:99], v[36:39], v[208:211], v[96:99]
    ds_read_b64_tr_b16 v[32:33], v5 offset:36864
    ds_read_b64_tr_b16 v[34:35], v5 offset:37376
    v_mfma_f32_16x16x32_bf16 v[112:115], v[36:39], v[212:215], v[112:115]
    s_lshl_b32 s43, s43, 8
    s_lshl_b32 s42, s91, 8
    s_bfe_u32 s11, s8, 0x10001
    v_mfma_f32_16x16x32_bf16 v[100:103], v[40:43], v[208:211], v[100:103]
    ds_read_b64_tr_b16 v[36:37], v6 offset:36864
    ds_read_b64_tr_b16 v[38:39], v6 offset:37376
    v_mfma_f32_16x16x32_bf16 v[116:119], v[40:43], v[212:215], v[116:119]
    buffer_load_dwordx4 v10, s[28:31], s81 offen offset:1920 lds
    s_lshl_b32 s11, s11, 7
    s_add_u32 s11, s11, 16777216
    s_waitcnt lgkmcnt(4)
    v_mfma_f32_16x16x32_bf16 v[104:107], v[44:47], v[208:211], v[104:107]
    ds_read_b64_tr_b16 v[40:41], v5 offset:37888
    ds_read_b64_tr_b16 v[42:43], v5 offset:38400
    v_mfma_f32_16x16x32_bf16 v[120:123], v[44:47], v[212:215], v[120:123]
    s_lshl_b32 s91, s19, 14
    s_add_u32 s91, s91, s11
    s_add_u32 s91, s91, s42
    v_mfma_f32_16x16x32_bf16 v[108:111], v[28:31], v[208:211], v[108:111]
    ds_read_b64_tr_b16 v[44:45], v6 offset:37888
    ds_read_b64_tr_b16 v[46:47], v6 offset:38400
    v_mfma_f32_16x16x32_bf16 v[124:127], v[28:31], v[212:215], v[124:127]
    s_lshl_b32 s94, s9, 14
    s_add_u32 s94, s94, s11
    s_add_u32 s92, s94, s22
    s_waitcnt lgkmcnt(4)
    v_mfma_f32_16x16x32_bf16 v[80:83], v[216:219], v[32:35], v[80:83]
    s_waitcnt vmcnt(7)
    s_barrier
    ds_read_b64_tr_b16 v[28:29], v5 offset:38912
    ds_read_b64_tr_b16 v[30:31], v5 offset:39424
    v_mfma_f32_16x16x32_bf16 v[88:91], v[220:223], v[32:35], v[88:91]
    buffer_load_dwordx4 v[24:27], v48, s[24:27], s89 offen sc1
    v_mfma_f32_16x16x32_bf16 v[84:87], v[216:219], v[36:39], v[84:87]
    s_add_u32 m0, s79, -98304
    ds_read_b64_tr_b16 v[32:33], v6 offset:38912
    ds_read_b64_tr_b16 v[34:35], v6 offset:39424
    v_mfma_f32_16x16x32_bf16 v[92:95], v[220:223], v[36:39], v[92:95]
    buffer_load_dwordx4 v8, s[56:59], s1 offen lds
    ds_read_b128 v[224:227], v1 offset:0
    s_waitcnt lgkmcnt(5)
    v_mfma_f32_16x16x32_bf16 v[96:99], v[40:43], v[216:219], v[96:99]
    ds_read_b64_tr_b16 v[36:37], v3 offset:0
    ds_read_b64_tr_b16 v[38:39], v3 offset:512
    v_mfma_f32_16x16x32_bf16 v[112:115], v[40:43], v[220:223], v[112:115]
    ds_read_b128 v[228:231], v1 offset:4096
    buffer_load_dwordx2 v[10:11], v49, s[24:27], s90 offen sc1
    s_add_u32 s93, s92, 16384
    v_mfma_f32_16x16x32_bf16 v[100:103], v[44:47], v[216:219], v[100:103]
    ds_read_b64_tr_b16 v[40:41], v4 offset:0
    ds_read_b64_tr_b16 v[42:43], v4 offset:512
    v_mfma_f32_16x16x32_bf16 v[116:119], v[44:47], v[220:223], v[116:119]
    buffer_load_dwordx4 v8, s[60:63], s1 offen offset:1024 lds
    ds_read_b128 v[232:235], v2 offset:0
    s_waitcnt lgkmcnt(7)
    v_mfma_f32_16x16x32_bf16 v[104:107], v[28:31], v[216:219], v[104:107]
    ds_read_b64_tr_b16 v[44:45], v3 offset:1024
    ds_read_b64_tr_b16 v[46:47], v3 offset:1536
    v_mfma_f32_16x16x32_bf16 v[120:123], v[28:31], v[220:223], v[120:123]
    ds_read_b128 v[236:239], v2 offset:4096
    s_add_u32 s94, s94, s43
    s_add_u32 s95, s94, 16384
    v_mfma_f32_16x16x32_bf16 v[108:111], v[32:35], v[216:219], v[108:111]
    ds_read_b64_tr_b16 v[28:29], v4 offset:1024
    ds_read_b64_tr_b16 v[30:31], v4 offset:1536
    v_mfma_f32_16x16x32_bf16 v[124:127], v[32:35], v[220:223], v[124:127]
    buffer_load_dwordx2 v[12:13], v49, s[24:27], s90 offen offset:512 sc1
    s_lshr_b32 s11, s8, 1
    s_lshl_b32 s11, s11, 17
    s_waitcnt lgkmcnt(6)
    v_mfma_f32_16x16x32_bf16 v[80:83], v[224:227], v[36:39], v[80:83]
    ds_read_b64_tr_b16 v[32:33], v3 offset:2048
    ds_read_b64_tr_b16 v[34:35], v3 offset:2560
    v_mfma_f32_16x16x32_bf16 v[88:91], v[228:231], v[36:39], v[88:91]
    s_and_b32 s42, s8, 1
    s_lshl_b32 s42, s42, 10
    s_add_u32 s11, s11, s42
    v_mfma_f32_16x16x32_bf16 v[84:87], v[224:227], v[40:43], v[84:87]
    ds_read_b64_tr_b16 v[36:37], v4 offset:2048
    ds_read_b64_tr_b16 v[38:39], v4 offset:2560
    v_mfma_f32_16x16x32_bf16 v[92:95], v[228:231], v[40:43], v[92:95]
    buffer_load_dwordx2 v[14:15], v49, s[24:27], s90 offen offset:1024 sc1
    s_lshl_b32 s96, s9, 11
    s_add_u32 s96, s96, s11
    s_waitcnt lgkmcnt(4)
    v_mfma_f32_16x16x32_bf16 v[96:99], v[44:47], v[224:227], v[96:99]
    ds_read_b64_tr_b16 v[40:41], v3 offset:12288
    ds_read_b64_tr_b16 v[42:43], v3 offset:12800
    v_mfma_f32_16x16x32_bf16 v[112:115], v[44:47], v[228:231], v[112:115]
    s_add_u32 s100, s96, 5242880
    s_add_u32 s96, s96, 3145728
    s_lshl_b32 s97, s19, 11
    v_mfma_f32_16x16x32_bf16 v[100:103], v[28:31], v[224:227], v[100:103]
    ds_read_b64_tr_b16 v[44:45], v4 offset:12288
    ds_read_b64_tr_b16 v[46:47], v4 offset:12800
    v_mfma_f32_16x16x32_bf16 v[116:119], v[28:31], v[228:231], v[116:119]
    buffer_load_dwordx2 v[16:17], v49, s[24:27], s90 offen offset:1536 sc1
    s_add_u32 s97, s97, s11
    s_add_u32 s97, s97, 1048576
    s_waitcnt lgkmcnt(4)
    v_mfma_f32_16x16x32_bf16 v[104:107], v[32:35], v[224:227], v[104:107]
    ds_read_b64_tr_b16 v[28:29], v3 offset:13312
    ds_read_b64_tr_b16 v[30:31], v3 offset:13824
    v_mfma_f32_16x16x32_bf16 v[120:123], v[32:35], v[228:231], v[120:123]
    s_mov_b32 s42, 2097152
    s_mov_b32 s43, 0x20000
    v_mfma_f32_16x16x32_bf16 v[108:111], v[36:39], v[224:227], v[108:111]
    ds_read_b64_tr_b16 v[32:33], v4 offset:13312
    ds_read_b64_tr_b16 v[34:35], v4 offset:13824
    v_mfma_f32_16x16x32_bf16 v[124:127], v[36:39], v[228:231], v[124:127]
    buffer_load_dwordx2 v[18:19], v49, s[24:27], s90 offen offset:2048 sc1
    s_waitcnt lgkmcnt(4)
    v_mfma_f32_16x16x32_bf16 v[80:83], v[232:235], v[40:43], v[80:83]
    s_waitcnt vmcnt(8)
    s_barrier
    ds_read_b64_tr_b16 v[36:37], v3 offset:14336
    ds_read_b64_tr_b16 v[38:39], v3 offset:14848
    v_mfma_f32_16x16x32_bf16 v[88:91], v[236:239], v[40:43], v[88:91]
    v_mfma_f32_16x16x32_bf16 v[84:87], v[232:235], v[44:47], v[84:87]
    s_add_u32 m0, s79, -81920
    ds_read_b64_tr_b16 v[40:41], v4 offset:14336
    ds_read_b64_tr_b16 v[42:43], v4 offset:14848
    v_mfma_f32_16x16x32_bf16 v[92:95], v[236:239], v[44:47], v[92:95]
    buffer_load_dwordx4 v8, s[56:59], s71 offen lds
    ds_read_b128 v[240:243], v1 offset:16384
    s_waitcnt lgkmcnt(5)
    v_mfma_f32_16x16x32_bf16 v[96:99], v[28:31], v[232:235], v[96:99]
    ds_read_b64_tr_b16 v[44:45], v3 offset:24576
    ds_read_b64_tr_b16 v[46:47], v3 offset:25088
    v_mfma_f32_16x16x32_bf16 v[112:115], v[28:31], v[236:239], v[112:115]
    ds_read_b128 v[244:247], v1 offset:20480
    v_mfma_f32_16x16x32_bf16 v[100:103], v[32:35], v[232:235], v[100:103]
    ds_read_b64_tr_b16 v[28:29], v4 offset:24576
    ds_read_b64_tr_b16 v[30:31], v4 offset:25088
    v_mfma_f32_16x16x32_bf16 v[116:119], v[32:35], v[236:239], v[116:119]
    buffer_load_dwordx4 v8, s[60:63], s71 offen offset:1024 lds
    ds_read_b128 v[248:251], v2 offset:16384
    s_waitcnt lgkmcnt(7)
    v_mfma_f32_16x16x32_bf16 v[104:107], v[36:39], v[232:235], v[104:107]
    ds_read_b64_tr_b16 v[32:33], v3 offset:25600
    ds_read_b64_tr_b16 v[34:35], v3 offset:26112
    v_mfma_f32_16x16x32_bf16 v[120:123], v[36:39], v[236:239], v[120:123]
    ds_read_b128 v[252:255], v2 offset:20480
    v_mfma_f32_16x16x32_bf16 v[108:111], v[40:43], v[232:235], v[108:111]
    s_add_u32 m0, s79, -65536
    ds_read_b64_tr_b16 v[36:37], v4 offset:25600
    ds_read_b64_tr_b16 v[38:39], v4 offset:26112
    v_mfma_f32_16x16x32_bf16 v[124:127], v[40:43], v[236:239], v[124:127]
    buffer_load_dwordx4 v8, s[56:59], s72 offen lds
    s_waitcnt lgkmcnt(6)
    v_mfma_f32_16x16x32_bf16 v[80:83], v[240:243], v[44:47], v[80:83]
    ds_read_b64_tr_b16 v[40:41], v3 offset:26624
    ds_read_b64_tr_b16 v[42:43], v3 offset:27136
    v_mfma_f32_16x16x32_bf16 v[88:91], v[244:247], v[44:47], v[88:91]
    v_mfma_f32_16x16x32_bf16 v[84:87], v[240:243], v[28:31], v[84:87]
    ds_read_b64_tr_b16 v[44:45], v4 offset:26624
    ds_read_b64_tr_b16 v[46:47], v4 offset:27136
    v_mfma_f32_16x16x32_bf16 v[92:95], v[244:247], v[28:31], v[92:95]
    buffer_load_dwordx4 v8, s[60:63], s72 offen offset:1024 lds
    s_waitcnt lgkmcnt(4)
    v_mfma_f32_16x16x32_bf16 v[96:99], v[32:35], v[240:243], v[96:99]
    ds_read_b64_tr_b16 v[28:29], v3 offset:36864
    ds_read_b64_tr_b16 v[30:31], v3 offset:37376
    v_mfma_f32_16x16x32_bf16 v[112:115], v[32:35], v[244:247], v[112:115]
    v_mfma_f32_16x16x32_bf16 v[100:103], v[36:39], v[240:243], v[100:103]
    s_add_u32 m0, s79, 32768
    ds_read_b64_tr_b16 v[32:33], v4 offset:36864
    ds_read_b64_tr_b16 v[34:35], v4 offset:37376
    v_mfma_f32_16x16x32_bf16 v[116:119], v[36:39], v[244:247], v[116:119]
    buffer_load_dwordx4 v8, s[56:59], s74 offen lds
    s_waitcnt lgkmcnt(4)
    v_mfma_f32_16x16x32_bf16 v[104:107], v[40:43], v[240:243], v[104:107]
    ds_read_b64_tr_b16 v[36:37], v3 offset:37888
    ds_read_b64_tr_b16 v[38:39], v3 offset:38400
    v_mfma_f32_16x16x32_bf16 v[120:123], v[40:43], v[244:247], v[120:123]
    v_mfma_f32_16x16x32_bf16 v[108:111], v[44:47], v[240:243], v[108:111]
    ds_read_b64_tr_b16 v[40:41], v4 offset:37888
    ds_read_b64_tr_b16 v[42:43], v4 offset:38400
    v_mfma_f32_16x16x32_bf16 v[124:127], v[44:47], v[244:247], v[124:127]
    buffer_load_dwordx4 v8, s[60:63], s74 offen offset:1024 lds
    s_waitcnt lgkmcnt(4)
    v_mfma_f32_16x16x32_bf16 v[80:83], v[248:251], v[28:31], v[80:83]
    s_waitcnt vmcnt(10)
    s_barrier
    ds_read_b64_tr_b16 v[44:45], v3 offset:38912
    ds_read_b64_tr_b16 v[46:47], v3 offset:39424
    v_mfma_f32_16x16x32_bf16 v[88:91], v[252:255], v[28:31], v[88:91]
    v_sub_u32 v5, v5, v51
    v_sub_u32 v6, v6, v51
    v_mfma_f32_16x16x32_bf16 v[84:87], v[248:251], v[32:35], v[84:87]
    s_add_u32 m0, s79, -49152
    ds_read_b64_tr_b16 v[28:29], v4 offset:38912
    ds_read_b64_tr_b16 v[30:31], v4 offset:39424
    v_mfma_f32_16x16x32_bf16 v[92:95], v[252:255], v[32:35], v[92:95]
    buffer_load_dwordx4 v8, s[56:59], s73 offen lds
    s_waitcnt lgkmcnt(4)
    v_mfma_f32_16x16x32_bf16 v[96:99], v[36:39], v[248:251], v[96:99]
    ds_read_b64_tr_b16 v[32:33], v5 offset:0
    ds_read_b64_tr_b16 v[34:35], v5 offset:512
    v_mfma_f32_16x16x32_bf16 v[112:115], v[36:39], v[252:255], v[112:115]
    v_mfma_f32_16x16x32_bf16 v[100:103], v[40:43], v[248:251], v[100:103]
    ds_read_b64_tr_b16 v[36:37], v6 offset:0
    ds_read_b64_tr_b16 v[38:39], v6 offset:512
    v_mfma_f32_16x16x32_bf16 v[116:119], v[40:43], v[252:255], v[116:119]
    buffer_load_dwordx4 v8, s[60:63], s73 offen offset:1024 lds
    s_waitcnt lgkmcnt(4)
    v_mfma_f32_16x16x32_bf16 v[104:107], v[44:47], v[248:251], v[104:107]
    ds_read_b64_tr_b16 v[40:41], v5 offset:1024
    ds_read_b64_tr_b16 v[42:43], v5 offset:1536
    v_mfma_f32_16x16x32_bf16 v[120:123], v[44:47], v[252:255], v[120:123]
    v_mfma_f32_16x16x32_bf16 v[108:111], v[28:31], v[248:251], v[108:111]
    ds_read_b64_tr_b16 v[44:45], v6 offset:1024
    ds_read_b64_tr_b16 v[46:47], v6 offset:1536
    v_mfma_f32_16x16x32_bf16 v[124:127], v[28:31], v[252:255], v[124:127]
    s_waitcnt vmcnt(8)
    v_min3_u32 v50, v11, v13, v15
    v_max3_u32 v51, v11, v13, v15
    v_min3_u32 v50, v50, v17, v19
    v_max3_u32 v51, v51, v17, v19
    v_min3_u32 v50, v50, v25, v27
    v_max3_u32 v51, v51, v25, v27
    v_xor_b32 v50, s5, v50
    v_xor_b32 v51, s5, v51
    v_or_b32 v50, v50, v51
    v_cmp_ne_u32 vcc, 0, v50
    s_nop 0
    s_cbranch_vccz Lok_gran_9
    s_mov_b32 s18, 0
Lsp_gran_10:
    buffer_load_dwordx4 v[24:27], v48, s[24:27], s89 offen sc1
    buffer_load_dwordx2 v[10:11], v49, s[24:27], s90 offen sc1
    buffer_load_dwordx2 v[12:13], v49, s[24:27], s90 offen offset:512 sc1
    buffer_load_dwordx2 v[14:15], v49, s[24:27], s90 offen offset:1024 sc1
    buffer_load_dwordx2 v[16:17], v49, s[24:27], s90 offen offset:1536 sc1
    buffer_load_dwordx2 v[18:19], v49, s[24:27], s90 offen offset:2048 sc1
    s_waitcnt vmcnt(0)
    v_min3_u32 v50, v11, v13, v15
    v_max3_u32 v51, v11, v13, v15
    v_min3_u32 v50, v50, v17, v19
    v_max3_u32 v51, v51, v17, v19
    v_min3_u32 v50, v50, v25, v27
    v_max3_u32 v51, v51, v25, v27
    v_xor_b32 v50, s5, v50
    v_xor_b32 v51, s5, v51
    v_or_b32 v50, v50, v51
    v_cmp_ne_u32 vcc, 0, v50
    s_nop 0
    s_cbranch_vccz Lok_gran_9
    s_add_u32 s18, s18, 1
    s_cmp_lt_u32 s18, 20000
    s_cbranch_scc1 Lsp_gran_10
Lok_gran_9:
    v_mov_b32 v20, v10
    v_permlane32_swap_b32 v12, v14
    v_permlane32_swap_b32 v16, v18
    v_permlane32_swap_b32 v10, v20
    v_mov_b32 v22, v26
    v_mov_b32 v23, v26
    v_add_f32 v12, v12, v14
    v_add_f32 v16, v16, v18
    v_add_f32 v10, v10, v20
    v_permlane32_swap_b32 v22, v23
    v_mfma_f32_16x16x1_4b_f32 v[48:63], v16, v24, 0 blgp:4
    v_mfma_f32_16x16x1_4b_f32 v[64:79], v16, v24, 0 blgp:6
    v_mfma_f32_16x16x1_4b_f32 v[80:95], v24, v10, v[80:95]
    s_lshl_b32 s7, s4, 7
    s_add_u32 s7, s7, 65536
    v_mfma_f32_16x16x1_4b_f32 v[96:111], v12, v24, v[96:111] blgp:4
    v_mfma_f32_16x16x1_4b_f32 v[112:127], v12, v24, v[112:127] blgp:6
    s_waitcnt lgkmcnt(4)
    s_nop 2
    v_mfma_f32_16x16x32_bf16 v[48:51], v[32:35], v[128:131], v[48:51]
    s_add_u32 m0, s79, 49152
    ds_read_b64_tr_b16 v[28:29], v5 offset:8192
    ds_read_b64_tr_b16 v[30:31], v5 offset:8704
    v_mfma_f32_16x16x32_bf16 v[64:67], v[32:35], v[132:135], v[64:67]
    buffer_load_dwordx4 v8, s[56:59], s75 offen lds
    v_and_b32 v18, 0xf0, v9
    v_lshrrev_b32 v20, 5, v0
    v_lshl_add_u32 v19, v20, 8, v18
    v_lshrrev_b32 v19, 2, v19
    v_add_u32 v19, s7, v19
    ds_write_b32 v19, v26
    v_and_b32 v19, 0x30, v0
    v_add_u32 v19, s7, v19
    v_mfma_f32_16x16x32_bf16 v[52:55], v[36:39], v[128:131], v[52:55]
    ds_read_b64_tr_b16 v[32:33], v6 offset:8192
    ds_read_b64_tr_b16 v[34:35], v6 offset:8704
    v_mfma_f32_16x16x32_bf16 v[68:71], v[36:39], v[132:135], v[68:71]
    buffer_load_dwordx4 v8, s[60:63], s75 offen offset:1024 lds
    ds_read_b128 v[10:13], v19 offset:0
    ds_read_b128 v[14:17], v19 offset:64
    v_lshl_add_u32 v18, v20, 10, v18
    v_and_b32 v21, 0x100, v9
    v_add_u32 v18, v21, v18
    s_waitcnt lgkmcnt(7)
    v_mfma_f32_16x16x32_bf16 v[56:59], v[40:43], v[128:131], v[56:59]
    ds_read_b64_tr_b16 v[36:37], v5 offset:9216
    ds_read_b64_tr_b16 v[38:39], v5 offset:9728
    v_mfma_f32_16x16x32_bf16 v[72:75], v[40:43], v[132:135], v[72:75]
    s_waitcnt lgkmcnt(3)
    v_mul_f32 v80, v80, v10
    v_mul_f32 v81, v81, v11
    v_mul_f32 v82, v82, v12
    v_mul_f32 v83, v83, v13
    v_mul_f32 v84, v84, v10
    v_mul_f32 v85, v85, v11
    v_mul_f32 v86, v86, v12
    v_mul_f32 v87, v87, v13
    v_cvt_pk_bf16_f32 v80, v80, v81
    v_cvt_pk_bf16_f32 v81, v82, v83
    v_mfma_f32_16x16x32_bf16 v[60:63], v[44:47], v[128:131], v[60:63]
    s_waitcnt vmcnt(8)
    s_barrier
    ds_read_b64_tr_b16 v[40:41], v6 offset:9216
    ds_read_b64_tr_b16 v[42:43], v6 offset:9728
    v_mfma_f32_16x16x32_bf16 v[76:79], v[44:47], v[132:135], v[76:79]
    v_cvt_pk_bf16_f32 v82, v84, v85
    v_cvt_pk_bf16_f32 v83, v86, v87
    v_mfma_f32_16x16x32_bf16 v[48:51], v[28:31], v[136:139], v[48:51]
    ds_read_b64_tr_b16 v[44:45], v5 offset:16384
    ds_read_b64_tr_b16 v[46:47], v5 offset:16896
    v_mfma_f32_16x16x32_bf16 v[64:67], v[28:31], v[140:143], v[64:67]
    v_permlane32_swap_b32 v80, v82
    v_permlane32_swap_b32 v81, v83
    buffer_store_dwordx4 v[80:83], v18, s[24:27], s82 offen sc1
    s_waitcnt lgkmcnt(6)
    v_mul_f32 v88, v88, v14
    v_mul_f32 v89, v89, v15
    v_mul_f32 v90, v90, v16
    v_mul_f32 v91, v91, v17
    v_mul_f32 v92, v92, v14
    v_mul_f32 v93, v93, v15
    v_mfma_f32_16x16x32_bf16 v[52:55], v[32:35], v[136:139], v[52:55]
    ds_read_b64_tr_b16 v[28:29], v6 offset:16384
    ds_read_b64_tr_b16 v[30:31], v6 offset:16896
    v_mfma_f32_16x16x32_bf16 v[68:71], v[32:35], v[140:143], v[68:71]
    v_mul_f32 v94, v94, v16
    v_mul_f32 v95, v95, v17
    v_cvt_pk_bf16_f32 v88, v88, v89
    v_cvt_pk_bf16_f32 v89, v90, v91
    v_cvt_pk_bf16_f32 v90, v92, v93
    v_cvt_pk_bf16_f32 v91, v94, v95
    s_waitcnt lgkmcnt(4)
    v_mfma_f32_16x16x32_bf16 v[56:59], v[36:39], v[136:139], v[56:59]
    ds_read_b64_tr_b16 v[32:33], v5 offset:17408
    ds_read_b64_tr_b16 v[34:35], v5 offset:17920
    v_mfma_f32_16x16x32_bf16 v[72:75], v[36:39], v[140:143], v[72:75]
    v_permlane32_swap_b32 v88, v90
    v_permlane32_swap_b32 v89, v91
    buffer_store_dwordx4 v[88:91], v18, s[24:27], s82 offen offset:512 sc1
    v_mul_f32 v24, 0x3eb8aa3b, v22
    v_mul_f32 v25, 0x3eb8aa3b, v23
    v_mul_f32 v96, v96, v24
    v_mul_f32 v97, v97, v24
    v_mul_f32 v98, v98, v24
    v_mul_f32 v99, v99, v24
    v_mfma_f32_16x16x32_bf16 v[60:63], v[40:43], v[136:139], v[60:63]
    ds_read_b64_tr_b16 v[36:37], v6 offset:17408
    ds_read_b64_tr_b16 v[38:39], v6 offset:17920
    v_mfma_f32_16x16x32_bf16 v[76:79], v[40:43], v[140:143], v[76:79]
    v_mul_f32 v112, v112, v25
    v_mul_f32 v113, v113, v25
    v_mul_f32 v114, v114, v25
    v_mul_f32 v115, v115, v25
    v_cvt_pk_bf16_f32 v96, v96, v97
    v_cvt_pk_bf16_f32 v97, v98, v99
    v_cvt_pk_bf16_f32 v98, v112, v113
    v_cvt_pk_bf16_f32 v99, v114, v115
    s_waitcnt lgkmcnt(4)
    v_mfma_f32_16x16x32_bf16 v[48:51], v[44:47], v[144:147], v[48:51]
    ds_read_b64_tr_b16 v[40:41], v5 offset:24576
    ds_read_b64_tr_b16 v[42:43], v5 offset:25088
    v_mfma_f32_16x16x32_bf16 v[64:67], v[44:47], v[148:151], v[64:67]
    v_permlane16_swap_b32 v96, v98
    v_permlane16_swap_b32 v97, v99
    buffer_store_dwordx4 v[96:99], v9, s[24:27], s83 offen sc1
    v_mul_f32 v100, v100, v24
    v_mul_f32 v101, v101, v24
    v_mul_f32 v102, v102, v24
    v_mul_f32 v103, v103, v24
    v_mul_f32 v116, v116, v25
    v_mul_f32 v117, v117, v25
    v_mfma_f32_16x16x32_bf16 v[52:55], v[28:31], v[144:147], v[52:55]
    ds_read_b64_tr_b16 v[44:45], v6 offset:24576
    ds_read_b64_tr_b16 v[46:47], v6 offset:25088
    v_mfma_f32_16x16x32_bf16 v[68:71], v[28:31], v[148:151], v[68:71]
    v_mul_f32 v118, v118, v25
    v_mul_f32 v119, v119, v25
    v_cvt_pk_bf16_f32 v100, v100, v101
    v_cvt_pk_bf16_f32 v101, v102, v103
    v_cvt_pk_bf16_f32 v102, v116, v117
    v_cvt_pk_bf16_f32 v103, v118, v119
    s_waitcnt lgkmcnt(4)
    v_mfma_f32_16x16x32_bf16 v[56:59], v[32:35], v[144:147], v[56:59]
    ds_read_b64_tr_b16 v[28:29], v5 offset:25600
    ds_read_b64_tr_b16 v[30:31], v5 offset:26112
    v_mfma_f32_16x16x32_bf16 v[72:75], v[32:35], v[148:151], v[72:75]
    v_permlane16_swap_b32 v100, v102
    v_permlane16_swap_b32 v101, v103
    buffer_store_dwordx4 v[100:103], v9, s[24:27], s83 offen offset:1024 sc1
    v_mul_f32 v104, v104, v22
    v_mul_f32 v105, v105, v22
    v_mul_f32 v106, v106, v22
    v_mul_f32 v107, v107, v22
    v_mul_f32 v120, v120, v23
    v_mul_f32 v121, v121, v23
    v_mfma_f32_16x16x32_bf16 v[60:63], v[36:39], v[144:147], v[60:63]
    s_waitcnt vmcnt(10)
    s_barrier
    ds_read_b64_tr_b16 v[32:33], v6 offset:25600
    ds_read_b64_tr_b16 v[34:35], v6 offset:26112
    v_mfma_f32_16x16x32_bf16 v[76:79], v[36:39], v[148:151], v[76:79]
    v_mul_f32 v122, v122, v23
    v_mul_f32 v123, v123, v23
    v_cvt_pk_bf16_f32 v104, v104, v105
    v_cvt_pk_bf16_f32 v105, v106, v107
    v_cvt_pk_bf16_f32 v106, v120, v121
    v_cvt_pk_bf16_f32 v107, v122, v123
    s_waitcnt lgkmcnt(4)
    v_mfma_f32_16x16x32_bf16 v[48:51], v[40:43], v[152:155], v[48:51]
    s_add_u32 m0, s79, -98304
    ds_read_b64_tr_b16 v[36:37], v5 offset:32768
    ds_read_b64_tr_b16 v[38:39], v5 offset:33280
    v_mfma_f32_16x16x32_bf16 v[64:67], v[40:43], v[156:159], v[64:67]
    buffer_load_dwordx4 v8, s[56:59], s76 offen lds
    v_permlane16_swap_b32 v104, v106
    v_permlane16_swap_b32 v105, v107
    buffer_store_dwordx4 v[104:107], v9, s[24:27], s84 offen sc1
    v_mul_f32 v108, v108, v22
    v_mul_f32 v109, v109, v22
    v_mul_f32 v110, v110, v22
    v_mul_f32 v111, v111, v22
    v_mfma_f32_16x16x32_bf16 v[52:55], v[44:47], v[152:155], v[52:55]
    ds_read_b64_tr_b16 v[40:41], v6 offset:32768
    ds_read_b64_tr_b16 v[42:43], v6 offset:33280
    v_mfma_f32_16x16x32_bf16 v[68:71], v[44:47], v[156:159], v[68:71]
    buffer_load_dwordx4 v8, s[60:63], s76 offen offset:1024 lds
    v_mul_f32 v124, v124, v23
    v_mul_f32 v125, v125, v23
    v_mul_f32 v126, v126, v23
    v_mul_f32 v127, v127, v23
    v_cvt_pk_bf16_f32 v108, v108, v109
    v_cvt_pk_bf16_f32 v109, v110, v111
    v_cvt_pk_bf16_f32 v110, v124, v125
    v_cvt_pk_bf16_f32 v111, v126, v127
    s_waitcnt lgkmcnt(4)
    v_mfma_f32_16x16x32_bf16 v[56:59], v[28:31], v[152:155], v[56:59]
    ds_read_b64_tr_b16 v[44:45], v5 offset:33792
    ds_read_b64_tr_b16 v[46:47], v5 offset:34304
    v_mfma_f32_16x16x32_bf16 v[72:75], v[28:31], v[156:159], v[72:75]
    v_permlane16_swap_b32 v108, v110
    v_permlane16_swap_b32 v109, v111
    buffer_store_dwordx4 v[108:111], v9, s[24:27], s84 offen offset:1024 sc1
    v_mfma_f32_16x16x32_bf16 v[60:63], v[32:35], v[152:155], v[60:63]
    ds_read_b64_tr_b16 v[28:29], v6 offset:33792
    ds_read_b64_tr_b16 v[30:31], v6 offset:34304
    v_mfma_f32_16x16x32_bf16 v[76:79], v[32:35], v[156:159], v[76:79]
    v_lshrrev_b32 v2, 3, v0
    v_and_b32 v3, 6, v2
    v_and_b32 v4, 7, v0
    s_waitcnt lgkmcnt(4)
    v_mfma_f32_16x16x32_bf16 v[48:51], v[36:39], v[160:163], v[48:51]
    ds_read_b64_tr_b16 v[32:33], v5 offset:40960
    ds_read_b64_tr_b16 v[34:35], v5 offset:41472
    v_mfma_f32_16x16x32_bf16 v[64:67], v[36:39], v[164:167], v[64:67]
    v_xor_b32 v3, v3, v4
    v_lshlrev_b32 v3, 4, v3
    v_lshl_add_u32 v1, v2, 10, v3
    v_mfma_f32_16x16x32_bf16 v[52:55], v[40:43], v[160:163], v[52:55]
    ds_read_b64_tr_b16 v[36:37], v6 offset:40960
    ds_read_b64_tr_b16 v[38:39], v6 offset:41472
    v_mfma_f32_16x16x32_bf16 v[68:71], v[40:43], v[164:167], v[68:71]
    v_add_u32 v2, 7168, v1
    v_add_u32 v3, 14336, v1
    v_add_u32 v4, 21504, v1
    s_waitcnt lgkmcnt(4)
    v_mfma_f32_16x16x32_bf16 v[56:59], v[44:47], v[160:163], v[56:59]
    ds_read_b64_tr_b16 v[40:41], v5 offset:41984
    ds_read_b64_tr_b16 v[42:43], v5 offset:42496
    v_mfma_f32_16x16x32_bf16 v[72:75], v[44:47], v[164:167], v[72:75]
    s_mov_b32 s22, 0
    v_mfma_f32_16x16x32_bf16 v[60:63], v[28:31], v[160:163], v[60:63]
    s_waitcnt vmcnt(10)
    s_barrier
    ds_read_b64_tr_b16 v[44:45], v6 offset:41984
    ds_read_b64_tr_b16 v[46:47], v6 offset:42496
    v_mfma_f32_16x16x32_bf16 v[76:79], v[28:31], v[164:167], v[76:79]
    s_waitcnt vmcnt(0)
    v_lshlrev_b32 v94, 2, v0
    v_mov_b32 v95, s5
    s_mov_b32 exec_hi, 0
    buffer_store_dword v95, v94, s[24:27], s86 offen sc1
    s_mov_b32 exec_hi, -1
    s_add_u32 s86, s86, 8192
    s_waitcnt lgkmcnt(4)
    v_mfma_f32_16x16x32_bf16 v[48:51], v[32:35], v[168:171], v[48:51]
    s_add_u32 m0, s79, -81920
    ds_read_b64_tr_b16 v[28:29], v5 offset:49152
    ds_read_b64_tr_b16 v[30:31], v5 offset:49664
    v_mfma_f32_16x16x32_bf16 v[64:67], v[32:35], v[172:175], v[64:67]
    buffer_load_dwordx4 v8, s[56:59], s77 offen lds
    v_lshlrev_b32 v92, 16, v0
    s_bfe_u32 s10, s14, 0x2000f
    s_bfe_u32 s9, s13, 0x30007
    s_lshl3_add_u32 s10, s10, s9
    s_lshl_b32 s10, s10, 10
    s_lshl_b32 s9, s9, 7
    s_sub_u32 s10, s10, s9
    v_mfma_f32_16x16x32_bf16 v[52:55], v[36:39], v[168:171], v[52:55]
    ds_read_b64_tr_b16 v[32:33], v6 offset:49152
    ds_read_b64_tr_b16 v[34:35], v6 offset:49664
    v_mfma_f32_16x16x32_bf16 v[68:71], v[36:39], v[172:175], v[68:71]
    buffer_load_dwordx4 v8, s[60:63], s77 offen offset:1024 lds
    s_add_u32 s9, s32, s10
    s_sub_u32 s9, 384, s9
    s_and_b32 s9, s9, 0x380
    s_add_u32 s9, s9, s10
    s_mov_b64 exec, 15
    v_add_u32 v87, s9, v92
    buffer_load_dword v87, v87, s[32:35], 0 offen
    s_mov_b64 exec, -1
    s_waitcnt lgkmcnt(4)
    v_mfma_f32_16x16x32_bf16 v[56:59], v[40:43], v[168:171], v[56:59]
    ds_read_b64_tr_b16 v[36:37], v5 offset:50176
    ds_read_b64_tr_b16 v[38:39], v5 offset:50688
    v_mfma_f32_16x16x32_bf16 v[72:75], v[40:43], v[172:175], v[72:75]
    v_mfma_f32_16x16x32_bf16 v[60:63], v[44:47], v[168:171], v[60:63]
    s_add_u32 m0, s6, 98304
    ds_read_b64_tr_b16 v[40:41], v6 offset:50176
    ds_read_b64_tr_b16 v[42:43], v6 offset:50688
    v_mfma_f32_16x16x32_bf16 v[76:79], v[44:47], v[172:175], v[76:79]
    buffer_load_dwordx4 v1, s[32:35], s22 offen lds
    v_lshrrev_b32 v27, 5, v0
    v_and_b32 v26, 31, v0
    s_waitcnt lgkmcnt(4)
    v_mfma_f32_16x16x32_bf16 v[48:51], v[28:31], v[176:179], v[48:51]
    ds_read_b64_tr_b16 v[44:45], v5 offset:57344
    ds_read_b64_tr_b16 v[46:47], v5 offset:57856
    v_mfma_f32_16x16x32_bf16 v[64:67], v[28:31], v[180:183], v[64:67]
    v_lshlrev_b32 v27, 2, v27
    v_sub_u32 v27, v26, v27
    v_cmp_le_i32 s[44:45], 0, v27
    v_cmp_le_i32 s[46:47], 1, v27
    v_mfma_f32_16x16x32_bf16 v[52:55], v[32:35], v[176:179], v[52:55]
    ds_read_b64_tr_b16 v[28:29], v6 offset:57344
    ds_read_b64_tr_b16 v[30:31], v6 offset:57856
    v_mfma_f32_16x16x32_bf16 v[68:71], v[32:35], v[180:183], v[68:71]
    buffer_load_dwordx4 v2, s[32:35], s22 offen offset:1024 lds
    v_cmp_le_i32 s[48:49], 2, v27
    v_cmp_le_i32 s[50:51], 3, v27
    v_cmp_le_i32 s[52:53], 8, v27
    s_waitcnt lgkmcnt(4)
    v_mfma_f32_16x16x32_bf16 v[56:59], v[36:39], v[176:179], v[56:59]
    ds_read_b64_tr_b16 v[32:33], v5 offset:58368
    ds_read_b64_tr_b16 v[34:35], v5 offset:58880
    v_add_u32 v5, 131072, v5
    v_mfma_f32_16x16x32_bf16 v[72:75], v[36:39], v[180:183], v[72:75]
    v_cmp_le_i32 s[54:55], 9, v27
    v_cmp_le_i32 s[56:57], 10, v27
    v_cmp_le_i32 s[58:59], 11, v27
    v_cmp_le_i32 s[60:61], 16, v27
    v_mfma_f32_16x16x32_bf16 v[60:63], v[40:43], v[176:179], v[60:63]
    s_barrier
    ds_read_b64_tr_b16 v[36:37], v6 offset:58368
    ds_read_b64_tr_b16 v[38:39], v6 offset:58880
    v_add_u32 v6, 131072, v6
    v_mfma_f32_16x16x32_bf16 v[76:79], v[40:43], v[180:183], v[76:79]
    buffer_load_dwordx4 v3, s[32:35], s22 offen offset:2048 lds
    v_cmp_le_i32 s[62:63], 17, v27
    s_waitcnt lgkmcnt(4)
    v_mfma_f32_16x16x32_bf16 v[48:51], v[44:47], v[184:187], v[48:51]
    ds_read_b64_tr_b16 v[40:41], v5 offset:0
    ds_read_b64_tr_b16 v[42:43], v5 offset:512
    v_mfma_f32_16x16x32_bf16 v[64:67], v[44:47], v[188:191], v[64:67]
    v_cmp_le_i32 s[64:65], 18, v27
    v_cmp_le_i32 s[66:67], 19, v27
    v_cmp_le_i32 s[68:69], 24, v27
    v_cmp_le_i32 s[70:71], 25, v27
    v_mfma_f32_16x16x32_bf16 v[52:55], v[28:31], v[184:187], v[52:55]
    ds_read_b64_tr_b16 v[44:45], v6 offset:0
    ds_read_b64_tr_b16 v[46:47], v6 offset:512
    v_mfma_f32_16x16x32_bf16 v[68:71], v[28:31], v[188:191], v[68:71]
    buffer_load_dwordx4 v4, s[32:35], s22 offen offset:3072 lds
    v_cmp_le_i32 s[72:73], 26, v27
    v_cmp_le_i32 s[74:75], 27, v27
    s_lshl_b32 s8, s4, 10
    s_waitcnt lgkmcnt(4)
    v_mfma_f32_16x16x32_bf16 v[56:59], v[32:35], v[184:187], v[56:59]
    ds_read_b64_tr_b16 v[28:29], v5 offset:1024
    ds_read_b64_tr_b16 v[30:31], v5 offset:1536
    v_mfma_f32_16x16x32_bf16 v[72:75], v[32:35], v[188:191], v[72:75]
    s_add_u32 s9, s8, 131072
    v_add_u32 v102, s9, v9
    v_and_b32 v103, 0xf0, v9
    v_lshrrev_b32 v27, 5, v0
    v_mfma_f32_16x16x32_bf16 v[60:63], v[36:39], v[184:187], v[60:63]
    s_mov_b32 s22, 65536
    s_add_u32 m0, s6, 65536
    ds_read_b64_tr_b16 v[32:33], v6 offset:1024
    ds_read_b64_tr_b16 v[34:35], v6 offset:1536
    v_mfma_f32_16x16x32_bf16 v[76:79], v[36:39], v[188:191], v[76:79]
    buffer_load_dwordx4 v1, s[32:35], s22 offen lds
    s_waitcnt lgkmcnt(4)
    v_mfma_f32_16x16x32_bf16 v[48:51], v[40:43], v[192:195], v[48:51]
    ds_read_b64_tr_b16 v[36:37], v5 offset:8192
    ds_read_b64_tr_b16 v[38:39], v5 offset:8704
    v_mfma_f32_16x16x32_bf16 v[64:67], v[40:43], v[196:199], v[64:67]
    v_lshl_add_u32 v103, v27, 8, v103
    v_and_b32 v8, 16, v0
    v_lshl_add_u32 v8, v8, 6, v103
    s_add_u32 s9, s8, 147456
    v_mfma_f32_16x16x32_bf16 v[52:55], v[44:47], v[192:195], v[52:55]
    ds_read_b64_tr_b16 v[40:41], v6 offset:8192
    ds_read_b64_tr_b16 v[42:43], v6 offset:8704
    v_mfma_f32_16x16x32_bf16 v[68:71], v[44:47], v[196:199], v[68:71]
    buffer_load_dwordx4 v2, s[32:35], s22 offen offset:1024 lds
    v_add_u32 v103, s9, v103
    v_mov_b32 v27, 0xffff
    v_mov_b32 v26, 0xff7fffff
    s_waitcnt lgkmcnt(4)
    v_mfma_f32_16x16x32_bf16 v[56:59], v[28:31], v[192:195], v[56:59]
    ds_read_b64_tr_b16 v[44:45], v5 offset:9216
    ds_read_b64_tr_b16 v[46:47], v5 offset:9728
    v_mfma_f32_16x16x32_bf16 v[72:75], v[28:31], v[196:199], v[72:75]
    v_mov_b32 v101, s91
    v_writelane_b32 v101, s92, 1
    v_writelane_b32 v101, s93, 2
    v_writelane_b32 v101, s94, 3
    v_mfma_f32_16x16x32_bf16 v[60:63], v[32:35], v[192:195], v[60:63]
    s_barrier
    ds_read_b64_tr_b16 v[28:29], v6 offset:9216
    ds_read_b64_tr_b16 v[30:31], v6 offset:9728
    v_mfma_f32_16x16x32_bf16 v[76:79], v[32:35], v[196:199], v[76:79]
    buffer_load_dwordx4 v3, s[32:35], s22 offen offset:2048 lds
    v_writelane_b32 v101, s95, 4
    s_waitcnt lgkmcnt(4)
    v_mfma_f32_16x16x32_bf16 v[48:51], v[36:39], v[200:203], v[48:51]
    ds_read_b64_tr_b16 v[32:33], v5 offset:16384
    ds_read_b64_tr_b16 v[34:35], v5 offset:16896
    v_mfma_f32_16x16x32_bf16 v[64:67], v[36:39], v[204:207], v[64:67]
    v_cndmask_b32 v120, 0, v27, s[44:45]
    v_cndmask_b32 v121, 0, v27, s[48:49]
    v_cndmask_b32 v122, 0, v27, s[52:53]
    v_cndmask_b32 v123, 0, v27, s[56:57]
    v_mfma_f32_16x16x32_bf16 v[52:55], v[40:43], v[200:203], v[52:55]
    ds_read_b64_tr_b16 v[36:37], v6 offset:16384
    ds_read_b64_tr_b16 v[38:39], v6 offset:16896
    v_mfma_f32_16x16x32_bf16 v[68:71], v[40:43], v[204:207], v[68:71]
    buffer_load_dwordx4 v4, s[32:35], s22 offen offset:3072 lds
    v_cndmask_b32 v124, 0, v27, s[60:61]
    v_cndmask_b32 v125, 0, v27, s[64:65]
    v_cndmask_b32 v126, 0, v27, s[68:69]
    s_waitcnt lgkmcnt(4)
    v_mfma_f32_16x16x32_bf16 v[56:59], v[44:47], v[200:203], v[56:59]
    ds_read_b64_tr_b16 v[40:41], v5 offset:17408
    ds_read_b64_tr_b16 v[42:43], v5 offset:17920
    v_mfma_f32_16x16x32_bf16 v[72:75], v[44:47], v[204:207], v[72:75]
    buffer_load_dword v100, v101, s[24:27], 0 offen sc1
    v_cndmask_b32 v127, 0, v27, s[72:73]
    v_cndmask_b32 v120, v120, -1, s[46:47]
    v_mfma_f32_16x16x32_bf16 v[60:63], v[28:31], v[200:203], v[60:63]
    ds_read_b64_tr_b16 v[44:45], v6 offset:17408
    ds_read_b64_tr_b16 v[46:47], v6 offset:17920
    v_mfma_f32_16x16x32_bf16 v[76:79], v[28:31], v[204:207], v[76:79]
    v_cndmask_b32 v121, v121, -1, s[50:51]
    v_cndmask_b32 v122, v122, -1, s[54:55]
    v_cndmask_b32 v123, v123, -1, s[58:59]
    v_cndmask_b32 v124, v124, -1, s[62:63]
    s_waitcnt lgkmcnt(4)
    v_mfma_f32_16x16x32_bf16 v[48:51], v[32:35], v[208:211], v[48:51]
    s_mov_b32 s22, 131072
    s_add_u32 m0, s6, 32768
    ds_read_b64_tr_b16 v[28:29], v5 offset:24576
    ds_read_b64_tr_b16 v[30:31], v5 offset:25088
    v_mfma_f32_16x16x32_bf16 v[64:67], v[32:35], v[212:215], v[64:67]
    buffer_load_dwordx4 v1, s[32:35], s22 offen lds
    v_mfma_f32_16x16x32_bf16 v[52:55], v[36:39], v[208:211], v[52:55]
    ds_read_b64_tr_b16 v[32:33], v6 offset:24576
    ds_read_b64_tr_b16 v[34:35], v6 offset:25088
    v_mfma_f32_16x16x32_bf16 v[68:71], v[36:39], v[212:215], v[68:71]
    v_cndmask_b32 v125, v125, -1, s[66:67]
    v_cndmask_b32 v126, v126, -1, s[70:71]
    v_cndmask_b32 v127, v127, -1, s[74:75]
    v_mov_b32 v104, 0x3f803f80
    s_waitcnt lgkmcnt(4)
    v_mfma_f32_16x16x32_bf16 v[56:59], v[40:43], v[208:211], v[56:59]
    ds_read_b64_tr_b16 v[36:37], v5 offset:25600
    ds_read_b64_tr_b16 v[38:39], v5 offset:26112
    v_subrev_u32 v5, 131072, v5
    v_mfma_f32_16x16x32_bf16 v[72:75], v[40:43], v[212:215], v[72:75]
    buffer_load_dwordx4 v2, s[32:35], s22 offen offset:1024 lds
    v_mov_b32 v105, 0x3f803f80
    v_mov_b32 v106, 0x3f803f80
    v_mov_b32 v107, 0x3f803f80
    v_mfma_f32_16x16x32_bf16 v[60:63], v[44:47], v[208:211], v[60:63]
    s_barrier
    ds_read_b64_tr_b16 v[40:41], v6 offset:25600
    ds_read_b64_tr_b16 v[42:43], v6 offset:26112
    v_subrev_u32 v6, 131072, v6
    v_mfma_f32_16x16x32_bf16 v[76:79], v[44:47], v[212:215], v[76:79]
    v_mov_b32 v108, 0x3f803f80
    v_mov_b32 v109, 0x3f803f80
    s_waitcnt lgkmcnt(4)
    v_mfma_f32_16x16x32_bf16 v[48:51], v[28:31], v[216:219], v[48:51]
    ds_read_b64_tr_b16 v[44:45], v5 offset:0
    ds_read_b64_tr_b16 v[46:47], v5 offset:512
    v_mfma_f32_16x16x32_bf16 v[64:67], v[28:31], v[220:223], v[64:67]
    v_mov_b32 v110, 0x3f803f80
    v_mov_b32 v111, 0x3f803f80
    v_mov_b32 v112, 0x3f803f80
    v_mov_b32 v113, 0x3f803f80
    v_mfma_f32_16x16x32_bf16 v[52:55], v[32:35], v[216:219], v[52:55]
    s_add_u32 m0, s79, 32768
    ds_read_b64_tr_b16 v[28:29], v6 offset:0
    ds_read_b64_tr_b16 v[30:31], v6 offset:512
    v_mfma_f32_16x16x32_bf16 v[68:71], v[32:35], v[220:223], v[68:71]
    s_waitcnt vmcnt(2)
    v_cmp_ne_u32 vcc, s5, v100
    s_nop 0
    s_cbranch_vccz Lok_A_11
    s_mov_b32 s18, 0
Lsp_A_12:
    buffer_load_dword v100, v101, s[24:27], 0 offen sc1
    s_waitcnt vmcnt(0)
    v_cmp_ne_u32 vcc, s5, v100
    s_nop 0
    s_cbranch_vccz Lok_A_11
    s_add_u32 s18, s18, 1
    s_cmp_lt_u32 s18, 20000
    s_cbranch_scc1 Lsp_A_12
Lok_A_11:
    buffer_load_dwordx4 v9, s[24:27], s96 offen sc1 lds
    s_waitcnt lgkmcnt(4)
    v_mfma_f32_16x16x32_bf16 v[56:59], v[36:39], v[216:219], v[56:59]
    ds_read_b64_tr_b16 v[32:33], v5 offset:1024
    ds_read_b64_tr_b16 v[34:35], v5 offset:1536
    v_mfma_f32_16x16x32_bf16 v[72:75], v[36:39], v[220:223], v[72:75]
    v_mov_b32 v114, 0x3f803f80
    v_mov_b32 v115, 0x3f803f80
    v_mov_b32 v116, 0x3f803f80
    v_mov_b32 v117, 0x3f803f80
    v_mfma_f32_16x16x32_bf16 v[60:63], v[40:43], v[216:219], v[60:63]
    s_add_u32 m0, s79, 31744
    ds_read_b64_tr_b16 v[36:37], v6 offset:1024
    ds_read_b64_tr_b16 v[38:39], v6 offset:1536
    v_mfma_f32_16x16x32_bf16 v[76:79], v[40:43], v[220:223], v[76:79]
    buffer_load_dwordx4 v9, s[24:27], s96 offen offset:2048 sc1 lds
    v_mov_b32 v118, 0x3f803f80
    v_mov_b32 v119, 0x3f803f80
    s_waitcnt lgkmcnt(4)
    v_mfma_f32_16x16x32_bf16 v[48:51], v[44:47], v[224:227], v[48:51]
    ds_read_b64_tr_b16 v[40:41], v5 offset:8192
    ds_read_b64_tr_b16 v[42:43], v5 offset:8704
    v_mfma_f32_16x16x32_bf16 v[64:67], v[44:47], v[228:231], v[64:67]
    v_mfma_f32_16x16x32_bf16 v[52:55], v[28:31], v[224:227], v[52:55]
    ds_read_b64_tr_b16 v[44:45], v6 offset:8192
    ds_read_b64_tr_b16 v[46:47], v6 offset:8704
    v_mfma_f32_16x16x32_bf16 v[68:71], v[28:31], v[228:231], v[68:71]
    buffer_load_dwordx4 v[96:99], v9, s[24:27], s97 offen sc1
    s_waitcnt lgkmcnt(4)
    v_mfma_f32_16x16x32_bf16 v[56:59], v[32:35], v[224:227], v[56:59]
    ds_read_b64_tr_b16 v[28:29], v5 offset:9216
    ds_read_b64_tr_b16 v[30:31], v5 offset:9728
    v_mfma_f32_16x16x32_bf16 v[72:75], v[32:35], v[228:231], v[72:75]
    v_mfma_f32_16x16x32_bf16 v[60:63], v[36:39], v[224:227], v[60:63]
    s_barrier
    s_add_u32 m0, s6, 32768
    ds_read_b64_tr_b16 v[32:33], v6 offset:9216
    ds_read_b64_tr_b16 v[34:35], v6 offset:9728
    v_mfma_f32_16x16x32_bf16 v[76:79], v[36:39], v[228:231], v[76:79]
    buffer_load_dwordx4 v3, s[32:35], s22 offen offset:2048 lds
    s_waitcnt lgkmcnt(4)
    v_mfma_f32_16x16x32_bf16 v[48:51], v[40:43], v[232:235], v[48:51]
    ds_read_b64_tr_b16 v[36:37], v5 offset:16384
    ds_read_b64_tr_b16 v[38:39], v5 offset:16896
    v_mfma_f32_16x16x32_bf16 v[64:67], v[40:43], v[236:239], v[64:67]
    v_mfma_f32_16x16x32_bf16 v[52:55], v[44:47], v[232:235], v[52:55]
    ds_read_b64_tr_b16 v[40:41], v6 offset:16384
    ds_read_b64_tr_b16 v[42:43], v6 offset:16896
    v_mfma_f32_16x16x32_bf16 v[68:71], v[44:47], v[236:239], v[68:71]
    buffer_load_dwordx4 v4, s[32:35], s22 offen offset:3072 lds
    s_waitcnt lgkmcnt(4)
    v_mfma_f32_16x16x32_bf16 v[56:59], v[28:31], v[232:235], v[56:59]
    s_add_u32 m0, s79, 49152
    ds_read_b64_tr_b16 v[44:45], v5 offset:17408
    ds_read_b64_tr_b16 v[46:47], v5 offset:17920
    v_mfma_f32_16x16x32_bf16 v[72:75], v[28:31], v[236:239], v[72:75]
    buffer_load_dwordx4 v9, s[24:27], s100 offen sc1 lds
    v_mfma_f32_16x16x32_bf16 v[60:63], v[32:35], v[232:235], v[60:63]
    ds_read_b64_tr_b16 v[28:29], v6 offset:17408
    ds_read_b64_tr_b16 v[30:31], v6 offset:17920
    v_mfma_f32_16x16x32_bf16 v[76:79], v[32:35], v[236:239], v[76:79]
    s_waitcnt lgkmcnt(4)
    v_mfma_f32_16x16x32_bf16 v[48:51], v[36:39], v[240:243], v[48:51]
    ds_read_b64_tr_b16 v[32:33], v5 offset:24576
    ds_read_b64_tr_b16 v[34:35], v5 offset:25088
    v_mfma_f32_16x16x32_bf16 v[64:67], v[36:39], v[244:247], v[64:67]
    v_mfma_f32_16x16x32_bf16 v[52:55], v[40:43], v[240:243], v[52:55]
    s_add_u32 m0, s79, 48128
    ds_read_b64_tr_b16 v[36:37], v6 offset:24576
    ds_read_b64_tr_b16 v[38:39], v6 offset:25088
    v_mfma_f32_16x16x32_bf16 v[68:71], v[40:43], v[244:247], v[68:71]
    buffer_load_dwordx4 v9, s[24:27], s100 offen offset:2048 sc1 lds
    s_waitcnt lgkmcnt(4)
    v_mfma_f32_16x16x32_bf16 v[56:59], v[44:47], v[240:243], v[56:59]
    ds_read_b64_tr_b16 v[40:41], v5 offset:25600
    ds_read_b64_tr_b16 v[42:43], v5 offset:26112
    v_mfma_f32_16x16x32_bf16 v[72:75], v[44:47], v[244:247], v[72:75]
    v_mfma_f32_16x16x32_bf16 v[60:63], v[28:31], v[240:243], v[60:63]
    s_barrier
    ds_read_b64_tr_b16 v[44:45], v6 offset:25600
    ds_read_b64_tr_b16 v[46:47], v6 offset:26112
    v_mfma_f32_16x16x32_bf16 v[76:79], v[28:31], v[244:247], v[76:79]
    s_waitcnt lgkmcnt(4)
    v_mfma_f32_16x16x32_bf16 v[48:51], v[32:35], v[248:251], v[48:51]
    v_mfma_f32_16x16x32_bf16 v[64:67], v[32:35], v[252:255], v[64:67]
    s_and_b32 s7, s4, 3
    s_mul_i32 s7, s7, 768
    v_min_u32 v101, 5, v0
    v_lshl_add_u32 v101, v101, 7, s7
    buffer_load_dword v100, v101, s[24:27], s14 offen sc1
    v_mfma_f32_16x16x32_bf16 v[52:55], v[36:39], v[248:251], v[52:55]
    v_mfma_f32_16x16x32_bf16 v[68:71], v[36:39], v[252:255], v[68:71]
    s_waitcnt lgkmcnt(0)
    v_mfma_f32_16x16x32_bf16 v[56:59], v[40:43], v[248:251], v[56:59]
    v_mfma_f32_16x16x32_bf16 v[72:75], v[40:43], v[252:255], v[72:75]
    v_mfma_f32_16x16x32_bf16 v[60:63], v[44:47], v[248:251], v[60:63]
    v_mfma_f32_16x16x32_bf16 v[76:79], v[44:47], v[252:255], v[76:79]
    s_nop 4
    v_pk_mul_f32 v[48:49], v[48:49], v[56:57]
    v_pk_mul_f32 v[50:51], v[50:51], v[58:59]
    v_pk_mul_f32 v[52:53], v[52:53], v[60:61]
    v_pk_mul_f32 v[54:55], v[54:55], v[62:63]
    v_cvt_pk_bf16_f32 v48, v48, v49
    v_cvt_pk_bf16_f32 v49, v50, v51
    v_cvt_pk_bf16_f32 v50, v52, v53
    v_cvt_pk_bf16_f32 v51, v54, v55
    buffer_store_dwordx4 v[48:51], v9, s[24:27], s85 offen sc1
    v_pk_mul_f32 v[64:65], v[64:65], v[72:73]
    v_pk_mul_f32 v[66:67], v[66:67], v[74:75]
    v_pk_mul_f32 v[68:69], v[68:69], v[76:77]
    v_pk_mul_f32 v[70:71], v[70:71], v[78:79]
    v_cvt_pk_bf16_f32 v64, v64, v65
    v_cvt_pk_bf16_f32 v65, v66, v67
    v_cvt_pk_bf16_f32 v66, v68, v69
    v_cvt_pk_bf16_f32 v67, v70, v71
    buffer_store_dwordx4 v[64:67], v9, s[24:27], s85 offen offset:1024 sc1
L_att:
    s_waitcnt vmcnt(3)
    s_barrier
    ds_read_b128 v[36:39], v102 offset:7168
    ds_read_b128 v[40:43], v102 offset:6144
    s_mov_b64 exec, s[20:21]
    ds_read_b128 v[104:107], v103 offset:7168
    ds_read_b128 v[108:111], v103 offset:7680
    s_mov_b64 exec, -1
    s_waitcnt lgkmcnt(3)
    v_mfma_f32_32x32x16_bf16 v[64:79], v[36:39], v[96:99], 0
    s_waitcnt vmcnt(2)
    v_cmp_ne_u32 vcc, s5, v100
    s_nop 0
    s_cbranch_vccz Lok_H_13
    s_mov_b32 s18, 0
Lsp_H_14:
    buffer_load_dword v100, v101, s[24:27], s14 offen sc1
    s_waitcnt vmcnt(0)
    v_cmp_ne_u32 vcc, s5, v100
    s_nop 0
    s_cbranch_vccz Lok_H_13
    s_add_u32 s18, s18, 1
    s_cmp_lt_u32 s18, 20000
    s_cbranch_scc1 Lsp_H_14
Lok_H_13:
    s_add_u32 s10, s17, 0
    buffer_load_dwordx4 v[144:147], v9, s[24:27], s10 offen sc1
    buffer_load_dwordx4 v[148:151], v9, s[24:27], s10 offen offset:1024 sc1
    s_cmp_eq_u32 s19, 0
    s_cbranch_scc1 L_q0
    s_nop 2
    v_max3_f32 v26, v64, v65, v26
    v_max3_f32 v26, v66, v67, v26
    v_max3_f32 v26, v68, v69, v26
    v_max3_f32 v26, v70, v71, v26
    v_max3_f32 v26, v72, v73, v26
    v_max3_f32 v26, v74, v75, v26
    v_max3_f32 v26, v76, v77, v26
    v_max3_f32 v26, v78, v79, v26
L_q0_back:
    v_mov_b32 v27, v26
    s_nop 1
    v_permlane32_swap_b32 v26, v27
    v_max_f32 v26, v26, v27
    v_sub_f32 v27, 0xc2900000, v26
    v_sub_f32 v26, 0xc2900000, v26
    v_mov_b64 v[10:11], v[26:27]
    v_mov_b64 v[12:13], v[26:27]
    v_mov_b64 v[14:15], v[26:27]
    v_mov_b64 v[16:17], v[26:27]
    v_mov_b64 v[18:19], v[26:27]
    v_mov_b64 v[20:21], v[26:27]
    v_mov_b64 v[22:23], v[26:27]
    v_mov_b64 v[24:25], v[26:27]
    s_cmp_lg_u32 s19, 0
    s_cbranch_scc1 Lc_15
    v_mov_b32 v10, 0xff000000
    v_mov_b32 v11, 0xff000000
    v_mov_b32 v12, 0xff000000
    v_mov_b32 v13, 0xff000000
    v_mov_b32 v14, 0xff000000
    v_mov_b32 v15, 0xff000000
    v_mov_b32 v16, 0xff000000
    v_mov_b32 v17, 0xff000000
    v_mov_b32 v18, 0xff000000
    v_mov_b32 v19, 0xff000000
    v_mov_b32 v20, 0xff000000
    v_mov_b32 v21, 0xff000000
    v_mov_b32 v22, 0xff000000
    v_mov_b32 v23, 0xff000000
    v_mov_b32 v24, 0xff000000
    v_mov_b32 v25, 0xff000000
Lc_15:
    s_nop 1
    v_mfma_f32_32x32x16_bf16 v[48:63], v[36:39], v[96:99], v[10:25]
    s_waitcnt vmcnt(2)
    v_lshlrev_b32 v94, 2, v0
    v_mov_b32 v95, s5
    s_mov_b32 exec_hi, 0
    buffer_store_dword v95, v94, s[24:27], s86 offen sc1
    s_mov_b32 exec_hi, -1
    buffer_load_dwordx4 v[152:155], v9, s[24:27], s10 offen offset:2048 sc1
    s_cmp_lg_u32 s19, 1
    s_cbranch_scc1 Lc_16
    v_mov_b32 v10, 0xff000000
    v_mov_b32 v11, 0xff000000
    v_mov_b32 v12, 0xff000000
    v_mov_b32 v13, 0xff000000
    v_mov_b32 v14, 0xff000000
    v_mov_b32 v15, 0xff000000
    v_mov_b32 v16, 0xff000000
    v_mov_b32 v17, 0xff000000
    v_mov_b32 v18, 0xff000000
    v_mov_b32 v19, 0xff000000
    v_mov_b32 v20, 0xff000000
    v_mov_b32 v21, 0xff000000
    v_mov_b32 v22, 0xff000000
    v_mov_b32 v23, 0xff000000
    v_mov_b32 v24, 0xff000000
    v_mov_b32 v25, 0xff000000
Lc_16:
    s_waitcnt lgkmcnt(2)
    s_nop 0
    v_mfma_f32_32x32x16_bf16 v[64:79], v[40:43], v[96:99], v[10:25]
    ds_read_b128 v[36:39], v102 offset:5120
    s_mov_b64 exec, s[20:21]
    ds_read_b128 v[112:115], v103 offset:6144
    ds_read_b128 v[116:119], v103 offset:6656
    s_mov_b64 exec, -1
    v_exp_f32 v48, v48
    v_exp_f32 v49, v49
    v_exp_f32 v50, v50
    v_exp_f32 v51, v51
    v_exp_f32 v52, v52
    v_exp_f32 v53, v53
    v_exp_f32 v54, v54
    v_exp_f32 v55, v55
    v_cvt_pk_bf16_f32 v28, v48, v49
    v_cvt_pk_bf16_f32 v29, v50, v51
    v_cvt_pk_bf16_f32 v30, v52, v53
    v_cvt_pk_bf16_f32 v31, v54, v55
    s_waitcnt lgkmcnt(3)
    s_nop 0
    v_mfma_f32_32x32x16_bf16 v[128:143], v[104:107], v[28:31], 0
    buffer_load_dwordx4 v[156:159], v9, s[24:27], s10 offen offset:3072 sc1
    s_add_u32 s10, s17, 4096
    buffer_load_dwordx4 v[160:163], v9, s[24:27], s10 offen sc1
    v_exp_f32 v56, v56
    v_exp_f32 v57, v57
    v_exp_f32 v58, v58
    v_exp_f32 v59, v59
    v_exp_f32 v60, v60
    v_exp_f32 v61, v61
    v_exp_f32 v62, v62
    v_exp_f32 v63, v63
    v_cvt_pk_bf16_f32 v32, v56, v57
    v_cvt_pk_bf16_f32 v33, v58, v59
    v_cvt_pk_bf16_f32 v34, v60, v61
    v_cvt_pk_bf16_f32 v35, v62, v63
    s_nop 1
    v_mfma_f32_32x32x16_bf16 v[128:143], v[108:111], v[32:35], v[128:143]
    buffer_load_dwordx4 v[164:167], v9, s[24:27], s10 offen offset:1024 sc1
    buffer_load_dwordx4 v[168:171], v9, s[24:27], s10 offen offset:2048 sc1
    s_cmp_lg_u32 s19, 2
    s_cbranch_scc1 Lc_17
    v_mov_b32 v10, 0xff000000
    v_mov_b32 v11, 0xff000000
    v_mov_b32 v12, 0xff000000
    v_mov_b32 v13, 0xff000000
    v_mov_b32 v14, 0xff000000
    v_mov_b32 v15, 0xff000000
    v_mov_b32 v16, 0xff000000
    v_mov_b32 v17, 0xff000000
    v_mov_b32 v18, 0xff000000
    v_mov_b32 v19, 0xff000000
    v_mov_b32 v20, 0xff000000
    v_mov_b32 v21, 0xff000000
    v_mov_b32 v22, 0xff000000
    v_mov_b32 v23, 0xff000000
    v_mov_b32 v24, 0xff000000
    v_mov_b32 v25, 0xff000000
Lc_17:
    s_waitcnt lgkmcnt(2)
    s_nop 0
    v_mfma_f32_32x32x16_bf16 v[48:63], v[36:39], v[96:99], v[10:25]
    ds_read_b128 v[40:43], v102 offset:4096
    s_mov_b64 exec, s[20:21]
    ds_read_b128 v[104:107], v103 offset:5120
    ds_read_b128 v[108:111], v103 offset:5632
    s_mov_b64 exec, -1
    v_exp_f32 v64, v64
    v_exp_f32 v65, v65
    v_exp_f32 v66, v66
    v_exp_f32 v67, v67
    v_exp_f32 v68, v68
    v_exp_f32 v69, v69
    v_exp_f32 v70, v70
    v_exp_f32 v71, v71
    v_cvt_pk_bf16_f32 v28, v64, v65
    v_cvt_pk_bf16_f32 v29, v66, v67
    v_cvt_pk_bf16_f32 v30, v68, v69
    v_cvt_pk_bf16_f32 v31, v70, v71
    s_waitcnt lgkmcnt(3)
    s_nop 0
    v_mfma_f32_32x32x16_bf16 v[128:143], v[112:115], v[28:31], v[128:143]
    buffer_load_dwordx4 v[172:175], v9, s[24:27], s10 offen offset:3072 sc1
    s_add_u32 s10, s17, 8192
    buffer_load_dwordx4 v[176:179], v9, s[24:27], s10 offen sc1
    v_exp_f32 v72, v72
    v_exp_f32 v73, v73
    v_exp_f32 v74, v74
    v_exp_f32 v75, v75
    v_exp_f32 v76, v76
    v_exp_f32 v77, v77
    v_exp_f32 v78, v78
    v_exp_f32 v79, v79
    v_cvt_pk_bf16_f32 v32, v72, v73
    v_cvt_pk_bf16_f32 v33, v74, v75
    v_cvt_pk_bf16_f32 v34, v76, v77
    v_cvt_pk_bf16_f32 v35, v78, v79
    s_nop 1
    v_mfma_f32_32x32x16_bf16 v[128:143], v[116:119], v[32:35], v[128:143]
    buffer_load_dwordx4 v[180:183], v9, s[24:27], s10 offen offset:1024 sc1
    buffer_load_dwordx4 v[184:187], v9, s[24:27], s10 offen offset:2048 sc1
    s_cmp_lg_u32 s19, 3
    s_cbranch_scc1 Lc_18
    v_mov_b32 v10, 0xff000000
    v_mov_b32 v11, 0xff000000
    v_mov_b32 v12, 0xff000000
    v_mov_b32 v13, 0xff000000
    v_mov_b32 v14, 0xff000000
    v_mov_b32 v15, 0xff000000
    v_mov_b32 v16, 0xff000000
    v_mov_b32 v17, 0xff000000
    v_mov_b32 v18, 0xff000000
    v_mov_b32 v19, 0xff000000
    v_mov_b32 v20, 0xff000000
    v_mov_b32 v21, 0xff000000
    v_mov_b32 v22, 0xff000000
    v_mov_b32 v23, 0xff000000
    v_mov_b32 v24, 0xff000000
    v_mov_b32 v25, 0xff000000
Lc_18:
    s_waitcnt lgkmcnt(2)
    s_nop 0
    v_mfma_f32_32x32x16_bf16 v[64:79], v[40:43], v[96:99], v[10:25]
    ds_read_b128 v[36:39], v102 offset:3072
    s_mov_b64 exec, s[20:21]
    ds_read_b128 v[112:115], v103 offset:4096
    ds_read_b128 v[116:119], v103 offset:4608
    s_mov_b64 exec, -1
    v_exp_f32 v48, v48
    v_exp_f32 v49, v49
    v_exp_f32 v50, v50
    v_exp_f32 v51, v51
    v_exp_f32 v52, v52
    v_exp_f32 v53, v53
    v_exp_f32 v54, v54
    v_exp_f32 v55, v55
    v_cvt_pk_bf16_f32 v28, v48, v49
    v_cvt_pk_bf16_f32 v29, v50, v51
    v_cvt_pk_bf16_f32 v30, v52, v53
    v_cvt_pk_bf16_f32 v31, v54, v55
    s_waitcnt lgkmcnt(3)
    s_nop 0
    v_mfma_f32_32x32x16_bf16 v[128:143], v[104:107], v[28:31], v[128:143]
    buffer_load_dwordx4 v[188:191], v9, s[24:27], s10 offen offset:3072 sc1
    v_exp_f32 v56, v56
    v_exp_f32 v57, v57
    v_exp_f32 v58, v58
    v_exp_f32 v59, v59
    v_exp_f32 v60, v60
    v_exp_f32 v61, v61
    v_exp_f32 v62, v62
    v_exp_f32 v63, v63
    v_cvt_pk_bf16_f32 v32, v56, v57
    v_cvt_pk_bf16_f32 v33, v58, v59
    v_cvt_pk_bf16_f32 v34, v60, v61
    v_cvt_pk_bf16_f32 v35, v62, v63
    s_nop 1
    v_mfma_f32_32x32x16_bf16 v[128:143], v[108:111], v[32:35], v[128:143]
    s_mov_b32 m0, s6
    s_mov_b32 s22, 196608
    buffer_load_dwordx4 v1, s[32:35], s22 offen lds
    s_cmp_lg_u32 s19, 4
    s_cbranch_scc1 Lc_19
    v_mov_b32 v10, 0xff000000
    v_mov_b32 v11, 0xff000000
    v_mov_b32 v12, 0xff000000
    v_mov_b32 v13, 0xff000000
    v_mov_b32 v14, 0xff000000
    v_mov_b32 v15, 0xff000000
    v_mov_b32 v16, 0xff000000
    v_mov_b32 v17, 0xff000000
    v_mov_b32 v18, 0xff000000
    v_mov_b32 v19, 0xff000000
    v_mov_b32 v20, 0xff000000
    v_mov_b32 v21, 0xff000000
    v_mov_b32 v22, 0xff000000
    v_mov_b32 v23, 0xff000000
    v_mov_b32 v24, 0xff000000
    v_mov_b32 v25, 0xff000000
Lc_19:
    s_waitcnt lgkmcnt(2)
    s_nop 0
    v_mfma_f32_32x32x16_bf16 v[48:63], v[36:39], v[96:99], v[10:25]
    ds_read_b128 v[40:43], v102 offset:2048
    s_mov_b64 exec, s[20:21]
    ds_read_b128 v[104:107], v103 offset:3072
    ds_read_b128 v[108:111], v103 offset:3584
    s_mov_b64 exec, -1
    v_lshlrev_b32 v44, 16, v0
    s_bfe_u32 s8, s14, 0x2000f
    s_bfe_u32 s9, s13, 0x30007
    s_lshl3_add_u32 s8, s8, s9
    s_lshl_b32 s8, s8, 10
    s_lshl_b32 s9, s9, 7
    s_sub_u32 s8, s8, s9
    s_add_u32 s9, s32, s8
    s_sub_u32 s9, 384, s9
    s_and_b32 s9, s9, 0x380
    s_add_u32 s9, s9, s8
    s_mov_b64 exec, 112
    v_add_u32 v46, s9, v44
    buffer_load_dword v46, v46, s[32:35], 0 offen
    s_add_u32 s9, s36, s8
    s_sub_u32 s9, 384, s9
    s_and_b32 s9, s9, 0x380
    s_add_u32 s9, s9, s8
    s_mov_b64 exec, 3
    v_add_u32 v45, s9, v44
    buffer_load_dword v45, v45, s[36:39], 0 offen
    s_mov_b64 exec, -1
    v_exp_f32 v64, v64
    v_exp_f32 v65, v65
    v_exp_f32 v66, v66
    v_exp_f32 v67, v67
    v_exp_f32 v68, v68
    v_exp_f32 v69, v69
    v_exp_f32 v70, v70
    v_exp_f32 v71, v71
    v_cvt_pk_bf16_f32 v28, v64, v65
    v_cvt_pk_bf16_f32 v29, v66, v67
    v_cvt_pk_bf16_f32 v30, v68, v69
    v_cvt_pk_bf16_f32 v31, v70, v71
    s_waitcnt lgkmcnt(3)
    s_nop 0
    v_mfma_f32_32x32x16_bf16 v[128:143], v[112:115], v[28:31], v[128:143]
    buffer_load_dwordx4 v2, s[32:35], s22 offen offset:1024 lds
    v_exp_f32 v72, v72
    v_exp_f32 v73, v73
    v_exp_f32 v74, v74
    v_exp_f32 v75, v75
    v_exp_f32 v76, v76
    v_exp_f32 v77, v77
    v_exp_f32 v78, v78
    v_exp_f32 v79, v79
    v_cvt_pk_bf16_f32 v32, v72, v73
    v_cvt_pk_bf16_f32 v33, v74, v75
    v_cvt_pk_bf16_f32 v34, v76, v77
    v_cvt_pk_bf16_f32 v35, v78, v79
    s_nop 1
    v_mfma_f32_32x32x16_bf16 v[128:143], v[116:119], v[32:35], v[128:143]
    buffer_load_dwordx4 v3, s[32:35], s22 offen offset:2048 lds
    s_cmp_lg_u32 s19, 5
    s_cbranch_scc1 Lc_20
    v_mov_b32 v10, 0xff000000
    v_mov_b32 v11, 0xff000000
    v_mov_b32 v12, 0xff000000
    v_mov_b32 v13, 0xff000000
    v_mov_b32 v14, 0xff000000
    v_mov_b32 v15, 0xff000000
    v_mov_b32 v16, 0xff000000
    v_mov_b32 v17, 0xff000000
    v_mov_b32 v18, 0xff000000
    v_mov_b32 v19, 0xff000000
    v_mov_b32 v20, 0xff000000
    v_mov_b32 v21, 0xff000000
    v_mov_b32 v22, 0xff000000
    v_mov_b32 v23, 0xff000000
    v_mov_b32 v24, 0xff000000
    v_mov_b32 v25, 0xff000000
Lc_20:
    s_waitcnt lgkmcnt(2)
    s_nop 0
    v_mfma_f32_32x32x16_bf16 v[64:79], v[40:43], v[96:99], v[10:25]
    ds_read_b128 v[36:39], v102 offset:1024
    s_mov_b64 exec, s[20:21]
    ds_read_b128 v[112:115], v103 offset:2048
    ds_read_b128 v[116:119], v103 offset:2560
    s_mov_b64 exec, -1
    s_and_b32 s7, s4, 3
    s_lshl_b32 s7, s7, 10
    v_min_u32 v101, 7, v0
    v_lshl_add_u32 v101, v101, 7, s7
    buffer_load_dword v100, v101, s[24:27], s14 offen offset:3072 sc1
    v_exp_f32 v48, v48
    v_exp_f32 v49, v49
    v_exp_f32 v50, v50
    v_exp_f32 v51, v51
    v_exp_f32 v52, v52
    v_exp_f32 v53, v53
    v_exp_f32 v54, v54
    v_exp_f32 v55, v55
    v_cvt_pk_bf16_f32 v28, v48, v49
    v_cvt_pk_bf16_f32 v29, v50, v51
    v_cvt_pk_bf16_f32 v30, v52, v53
    v_cvt_pk_bf16_f32 v31, v54, v55
    s_waitcnt lgkmcnt(3)
    s_nop 0
    v_mfma_f32_32x32x16_bf16 v[128:143], v[104:107], v[28:31], v[128:143]
    buffer_load_dwordx4 v4, s[32:35], s22 offen offset:3072 lds
    v_exp_f32 v56, v56
    v_exp_f32 v57, v57
    v_exp_f32 v58, v58
    v_exp_f32 v59, v59
    v_exp_f32 v60, v60
    v_exp_f32 v61, v61
    v_exp_f32 v62, v62
    v_exp_f32 v63, v63
    v_cvt_pk_bf16_f32 v32, v56, v57
    v_cvt_pk_bf16_f32 v33, v58, v59
    v_cvt_pk_bf16_f32 v34, v60, v61
    v_cvt_pk_bf16_f32 v35, v62, v63
    s_nop 1
    v_mfma_f32_32x32x16_bf16 v[128:143], v[108:111], v[32:35], v[128:143]
    s_cmp_lg_u32 s19, 6
    s_cbranch_scc1 Lc_21
    v_mov_b32 v10, 0xff000000
    v_mov_b32 v11, 0xff000000
    v_mov_b32 v12, 0xff000000
    v_mov_b32 v13, 0xff000000
    v_mov_b32 v14, 0xff000000
    v_mov_b32 v15, 0xff000000
    v_mov_b32 v16, 0xff000000
    v_mov_b32 v17, 0xff000000
    v_mov_b32 v18, 0xff000000
    v_mov_b32 v19, 0xff000000
    v_mov_b32 v20, 0xff000000
    v_mov_b32 v21, 0xff000000
    v_mov_b32 v22, 0xff000000
    v_mov_b32 v23, 0xff000000
    v_mov_b32 v24, 0xff000000
    v_mov_b32 v25, 0xff000000
Lc_21:
    s_waitcnt lgkmcnt(2)
    s_nop 0
    v_mfma_f32_32x32x16_bf16 v[48:63], v[36:39], v[96:99], v[10:25]
    ds_read_b128 v[40:43], v102 offset:0
    s_mov_b64 exec, s[20:21]
    ds_read_b128 v[104:107], v103 offset:1024
    ds_read_b128 v[108:111], v103 offset:1536
    s_mov_b64 exec, -1
    v_exp_f32 v64, v64
    v_exp_f32 v65, v65
    v_exp_f32 v66, v66
    v_exp_f32 v67, v67
    v_exp_f32 v68, v68
    v_exp_f32 v69, v69
    v_exp_f32 v70, v70
    v_exp_f32 v71, v71
    v_cvt_pk_bf16_f32 v28, v64, v65
    v_cvt_pk_bf16_f32 v29, v66, v67
    v_cvt_pk_bf16_f32 v30, v68, v69
    v_cvt_pk_bf16_f32 v31, v70, v71
    s_waitcnt lgkmcnt(3)
    s_nop 0
    v_mfma_f32_32x32x16_bf16 v[128:143], v[112:115], v[28:31], v[128:143]
    v_exp_f32 v72, v72
    v_exp_f32 v73, v73
    v_exp_f32 v74, v74
    v_exp_f32 v75, v75
    v_exp_f32 v76, v76
    v_exp_f32 v77, v77
    v_exp_f32 v78, v78
    v_exp_f32 v79, v79
    v_cvt_pk_bf16_f32 v32, v72, v73
    v_cvt_pk_bf16_f32 v33, v74, v75
    v_cvt_pk_bf16_f32 v34, v76, v77
    v_cvt_pk_bf16_f32 v35, v78, v79
    s_nop 1
    v_mfma_f32_32x32x16_bf16 v[128:143], v[116:119], v[32:35], v[128:143]
    s_cmp_lg_u32 s19, 7
    s_cbranch_scc1 Lc_22
    v_mov_b32 v10, 0xff000000
    v_mov_b32 v11, 0xff000000
    v_mov_b32 v12, 0xff000000
    v_mov_b32 v13, 0xff000000
    v_mov_b32 v14, 0xff000000
    v_mov_b32 v15, 0xff000000
    v_mov_b32 v16, 0xff000000
    v_mov_b32 v17, 0xff000000
    v_mov_b32 v18, 0xff000000
    v_mov_b32 v19, 0xff000000
    v_mov_b32 v20, 0xff000000
    v_mov_b32 v21, 0xff000000
    v_mov_b32 v22, 0xff000000
    v_mov_b32 v23, 0xff000000
    v_mov_b32 v24, 0xff000000
    v_mov_b32 v25, 0xff000000
Lc_22:
    s_waitcnt lgkmcnt(2)
    s_nop 0
    v_mfma_f32_32x32x16_bf16 v[64:79], v[40:43], v[96:99], v[10:25]
    ds_read_b128 v[36:39], v102 offset:8192
    s_mov_b64 exec, s[20:21]
    ds_read_b128 v[112:115], v103 offset:0
    ds_read_b128 v[116:119], v103 offset:512
    s_mov_b64 exec, -1
    s_waitcnt vmcnt(1)
    v_cmp_ne_u32 vcc, s5, v100
    s_nop 0
    s_cbranch_vccz Lok_B_23
    s_mov_b32 s18, 0
Lsp_B_24:
    buffer_load_dword v100, v101, s[24:27], s14 offen offset:3072 sc1
    s_waitcnt vmcnt(0)
    v_cmp_ne_u32 vcc, s5, v100
    s_nop 0
    s_cbranch_vccz Lok_B_23
    s_add_u32 s18, s18, 1
    s_cmp_lt_u32 s18, 20000
    s_cbranch_scc1 Lsp_B_24
Lok_B_23:
    v_exp_f32 v48, v48
    v_exp_f32 v49, v49
    v_exp_f32 v50, v50
    v_exp_f32 v51, v51
    v_exp_f32 v52, v52
    v_exp_f32 v53, v53
    v_exp_f32 v54, v54
    v_exp_f32 v55, v55
    v_cvt_pk_bf16_f32 v28, v48, v49
    v_cvt_pk_bf16_f32 v29, v50, v51
    v_cvt_pk_bf16_f32 v30, v52, v53
    v_cvt_pk_bf16_f32 v31, v54, v55
    s_waitcnt lgkmcnt(3)
    s_nop 0
    v_mfma_f32_32x32x16_bf16 v[128:143], v[104:107], v[28:31], v[128:143]
    s_add_u32 s10, s17, 12288
    buffer_load_dwordx4 v[192:195], v9, s[24:27], s10 offen sc1
    buffer_load_dwordx4 v[196:199], v9, s[24:27], s10 offen offset:1024 sc1
    buffer_load_dwordx4 v[200:203], v9, s[24:27], s10 offen offset:2048 sc1
    v_exp_f32 v56, v56
    v_exp_f32 v57, v57
    v_exp_f32 v58, v58
    v_exp_f32 v59, v59
    v_exp_f32 v60, v60
    v_exp_f32 v61, v61
    v_exp_f32 v62, v62
    v_exp_f32 v63, v63
    v_cvt_pk_bf16_f32 v32, v56, v57
    v_cvt_pk_bf16_f32 v33, v58, v59
    v_cvt_pk_bf16_f32 v34, v60, v61
    v_cvt_pk_bf16_f32 v35, v62, v63
    s_nop 1
    v_mfma_f32_32x32x16_bf16 v[128:143], v[108:111], v[32:35], v[128:143]
    buffer_load_dwordx4 v[204:207], v9, s[24:27], s10 offen offset:3072 sc1
    s_add_u32 s10, s17, 16384
    buffer_load_dwordx4 v[208:211], v9, s[24:27], s10 offen sc1
    buffer_load_dwordx4 v[212:215], v9, s[24:27], s10 offen offset:1024 sc1
    s_cmp_ge_u32 s19, 8
    s_cbranch_scc1 Lc_25
    v_mov_b32 v10, v26
    v_mov_b32 v11, v26
    v_mov_b32 v12, v26
    v_mov_b32 v13, v26
    v_mov_b32 v14, v26
    v_mov_b32 v15, v26
    v_mov_b32 v16, v26
    v_mov_b32 v17, v26
    v_mov_b32 v18, v26
    v_mov_b32 v19, v26
    v_mov_b32 v20, v26
    v_mov_b32 v21, v26
    v_mov_b32 v22, v26
    v_mov_b32 v23, v26
    v_mov_b32 v24, v26
    v_mov_b32 v25, v26
Lc_25:
    s_waitcnt lgkmcnt(2)
    s_nop 0
    v_mfma_f32_32x32x16_bf16 v[48:63], v[36:39], v[96:99], v[10:25]
    s_mov_b64 exec, s[20:21]
    ds_read_b128 v[104:107], v103 offset:8192
    ds_read_b128 v[108:111], v103 offset:8704
    s_mov_b64 exec, -1
    s_nop 7
    v_cndmask_b32 v48, v64, v48, s[44:45]
    v_cndmask_b32 v49, v65, v49, s[46:47]
    v_cndmask_b32 v50, v66, v50, s[48:49]
    v_cndmask_b32 v51, v67, v51, s[50:51]
    v_cndmask_b32 v52, v68, v52, s[52:53]
    v_cndmask_b32 v53, v69, v53, s[54:55]
    v_cndmask_b32 v54, v70, v54, s[56:57]
    v_cndmask_b32 v55, v71, v55, s[58:59]
    v_cndmask_b32 v56, v72, v56, s[60:61]
    v_cndmask_b32 v57, v73, v57, s[62:63]
    v_cndmask_b32 v58, v74, v58, s[64:65]
    v_cndmask_b32 v59, v75, v59, s[66:67]
    v_cndmask_b32 v60, v76, v60, s[68:69]
    v_cndmask_b32 v61, v77, v61, s[70:71]
    v_cndmask_b32 v62, v78, v62, s[72:73]
    v_cndmask_b32 v63, v79, v63, s[74:75]
    v_exp_f32 v48, v48
    v_exp_f32 v49, v49
    v_exp_f32 v50, v50
    v_exp_f32 v51, v51
    v_exp_f32 v52, v52
    v_exp_f32 v53, v53
    v_exp_f32 v54, v54
    v_exp_f32 v55, v55
    v_cvt_pk_bf16_f32 v28, v48, v49
    v_cvt_pk_bf16_f32 v29, v50, v51
    v_cvt_pk_bf16_f32 v30, v52, v53
    v_cvt_pk_bf16_f32 v31, v54, v55
    v_bfi_b32 v88, v120, 0, v28
    v_and_b32 v80, v120, v28
    v_bfi_b32 v89, v121, 0, v29
    v_and_b32 v81, v121, v29
    v_bfi_b32 v90, v122, 0, v30
    v_and_b32 v82, v122, v30
    v_bfi_b32 v91, v123, 0, v31
    v_and_b32 v83, v123, v31
    s_waitcnt lgkmcnt(2)
    v_mfma_f32_32x32x16_bf16 v[128:143], v[112:115], v[88:91], v[128:143]
    s_waitcnt lgkmcnt(0)
    v_mfma_f32_32x32x16_bf16 v[128:143], v[104:107], v[80:83], v[128:143]
    buffer_load_dwordx4 v[216:219], v9, s[24:27], s10 offen offset:2048 sc1
    buffer_load_dwordx4 v[220:223], v9, s[24:27], s10 offen offset:3072 sc1
    s_add_u32 s10, s17, 20480
    buffer_load_dwordx4 v[224:227], v9, s[24:27], s10 offen sc1
    v_exp_f32 v56, v56
    v_exp_f32 v57, v57
    v_exp_f32 v58, v58
    v_exp_f32 v59, v59
    v_exp_f32 v60, v60
    v_exp_f32 v61, v61
    v_exp_f32 v62, v62
    v_exp_f32 v63, v63
    v_cvt_pk_bf16_f32 v32, v56, v57
    v_cvt_pk_bf16_f32 v33, v58, v59
    v_cvt_pk_bf16_f32 v34, v60, v61
    v_cvt_pk_bf16_f32 v35, v62, v63
    v_bfi_b32 v92, v124, 0, v32
    v_and_b32 v84, v124, v32
    v_bfi_b32 v93, v125, 0, v33
    v_and_b32 v85, v125, v33
    v_bfi_b32 v94, v126, 0, v34
    v_and_b32 v86, v126, v34
    v_bfi_b32 v95, v127, 0, v35
    v_and_b32 v87, v127, v35
    s_nop 0
    v_mfma_f32_32x32x16_bf16 v[128:143], v[116:119], v[92:95], v[128:143]
    v_mfma_f32_32x32x16_bf16 v[128:143], v[108:111], v[84:87], v[128:143]
    buffer_load_dwordx4 v[228:231], v9, s[24:27], s10 offen offset:1024 sc1
    buffer_load_dwordx4 v[232:235], v9, s[24:27], s10 offen offset:2048 sc1
    buffer_load_dwordx4 v[236:239], v9, s[24:27], s10 offen offset:3072 sc1
    v_lshrrev_b32 v17, 2, v0
    v_and_b32 v16, 6, v17
    v_and_b32 v18, 3, v0
    v_lshl_add_u32 v16, v16, 1, v18
    v_lshlrev_b32 v16, 3, v16
    s_and_b32 s7, s4, 2
    s_lshl_b32 s7, s7, 5
    v_xor_b32 v16, s7, v16
    v_lshl_add_u32 v10, v17, 7, v16
    s_and_b32 s7, s6, 0xe000
    s_add_u32 s7, s7, 65536
    v_add_u32 v10, s7, v10
    v_xor_b32 v11, 32, v10
    v_xor_b32 v12, 64, v10
    v_xor_b32 v13, 96, v10
    v_lshrrev_b32 v14, 5, v0
    v_lshlrev_b32 v14, 10, v14
    v_subrev_u32 v14, 65536, v14
    s_mov_b32 s44, 262144
    s_mov_b32 s45, 327680
    s_mov_b32 s46, 393216
    s_mov_b32 s47, 0
    s_mov_b32 s48, 65536
    v_add_f32_e64 v44, |v128|, |v129|
    v_add_f32_e64 v45, |v130|, |v131|
    v_add_f32_e64 v46, |v132|, |v133|
    v_add_f32_e64 v47, |v134|, |v135|
    v_pk_add_f32 v[44:45], v[44:45], v[46:47]
    v_add_f32 v44, v44, v45
    v_add_f32 v45, v44, v136
    v_cmp_nle_f32 vcc, 0x0d800000, v44
    s_nop 0
    s_cbranch_vccnz L_fb
    v_cmp_ngt_f32 vcc, 0x7b800000, v45
    s_nop 0
    s_cbranch_vccnz L_fb
L_fb_back:
    v_rcp_f32 v44, v136
    s_nop 0
    v_mov_b32 v45, v44
    v_pk_mul_f32 v[128:129], v[128:129], v[44:45]
    v_pk_mul_f32 v[130:131], v[130:131], v[44:45]
    v_pk_mul_f32 v[132:133], v[132:133], v[44:45]
    v_pk_mul_f32 v[134:135], v[134:135], v[44:45]
    v_cvt_pk_bf16_f32 v20, v128, v129
    v_cvt_pk_bf16_f32 v21, v130, v131
    v_cvt_pk_bf16_f32 v22, v132, v133
    v_cvt_pk_bf16_f32 v23, v134, v135
    buffer_store_dwordx4 v[20:23], v8, s[24:27], s3 offen sc1
    s_add_u32 s10, s17, 24576
    buffer_load_dwordx4 v[240:243], v9, s[24:27], s10 offen sc1
    buffer_load_dwordx4 v[244:247], v9, s[24:27], s10 offen offset:1024 sc1
    buffer_load_dwordx4 v[248:251], v9, s[24:27], s10 offen offset:2048 sc1
    buffer_load_dwordx4 v[252:255], v9, s[24:27], s10 offen offset:3072 sc1
    s_barrier
    ds_read_b64_tr_b16 v[24:25], v10 offset:32768
    ds_read_b64_tr_b16 v[26:27], v10 offset:34816
    ds_read_b64_tr_b16 v[28:29], v12 offset:32768
    ds_read_b64_tr_b16 v[30:31], v12 offset:34816
    ds_read_b64_tr_b16 v[32:33], v11 offset:32768
    ds_read_b64_tr_b16 v[34:35], v11 offset:34816
    ds_read_b64_tr_b16 v[36:37], v13 offset:32768
    ds_read_b64_tr_b16 v[38:39], v13 offset:34816
    s_waitcnt lgkmcnt(4)
    v_mfma_f32_16x16x32_bf16 v[80:83], v[24:27], v[144:147], 0
    s_add_u32 m0, s6, 131072
    ds_read_b64_tr_b16 v[40:41], v10 offset:36864
    ds_read_b64_tr_b16 v[42:43], v10 offset:38912
    v_mfma_f32_16x16x32_bf16 v[84:87], v[24:27], v[148:151], 0
    buffer_load_dwordx4 v1, s[32:35], s44 offen lds
    v_mfma_f32_16x16x32_bf16 v[96:99], v[28:31], v[144:147], 0
    ds_read_b64_tr_b16 v[24:25], v12 offset:36864
    ds_read_b64_tr_b16 v[26:27], v12 offset:38912
    v_mfma_f32_16x16x32_bf16 v[100:103], v[28:31], v[148:151], 0
    s_waitcnt lgkmcnt(4)
    v_mfma_f32_16x16x32_bf16 v[88:91], v[32:35], v[144:147], 0
    ds_read_b64_tr_b16 v[28:29], v11 offset:36864
    ds_read_b64_tr_b16 v[30:31], v11 offset:38912
    v_mfma_f32_16x16x32_bf16 v[92:95], v[32:35], v[148:151], 0
    buffer_load_dwordx4 v2, s[32:35], s44 offen offset:1024 lds
    v_mfma_f32_16x16x32_bf16 v[104:107], v[36:39], v[144:147], 0
    s_barrier
    ds_read_b64_tr_b16 v[32:33], v13 offset:36864
    ds_read_b64_tr_b16 v[34:35], v13 offset:38912
    v_mfma_f32_16x16x32_bf16 v[108:111], v[36:39], v[148:151], 0
    s_waitcnt lgkmcnt(4)
    v_mfma_f32_16x16x32_bf16 v[80:83], v[40:43], v[152:155], v[80:83]
    ds_read_b64_tr_b16 v[36:37], v10 offset:0
    ds_read_b64_tr_b16 v[38:39], v10 offset:2048
    v_mfma_f32_16x16x32_bf16 v[84:87], v[40:43], v[156:159], v[84:87]
    buffer_load_dwordx4 v3, s[32:35], s44 offen offset:2048 lds
    v_mfma_f32_16x16x32_bf16 v[96:99], v[24:27], v[152:155], v[96:99]
    ds_read_b64_tr_b16 v[40:41], v12 offset:0
    ds_read_b64_tr_b16 v[42:43], v12 offset:2048
    v_mfma_f32_16x16x32_bf16 v[100:103], v[24:27], v[156:159], v[100:103]
    s_waitcnt lgkmcnt(4)
    v_mfma_f32_16x16x32_bf16 v[88:91], v[28:31], v[152:155], v[88:91]
    ds_read_b64_tr_b16 v[24:25], v11 offset:0
    ds_read_b64_tr_b16 v[26:27], v11 offset:2048
    v_mfma_f32_16x16x32_bf16 v[92:95], v[28:31], v[156:159], v[92:95]
    buffer_load_dwordx4 v4, s[32:35], s44 offen offset:3072 lds
    v_mfma_f32_16x16x32_bf16 v[104:107], v[32:35], v[152:155], v[104:107]
    ds_read_b64_tr_b16 v[28:29], v13 offset:0
    ds_read_b64_tr_b16 v[30:31], v13 offset:2048
    v_mfma_f32_16x16x32_bf16 v[108:111], v[32:35], v[156:159], v[108:111]
    s_waitcnt lgkmcnt(4)
    v_mfma_f32_16x16x32_bf16 v[80:83], v[36:39], v[160:163], v[80:83]
    ds_read_b64_tr_b16 v[32:33], v10 offset:4096
    ds_read_b64_tr_b16 v[34:35], v10 offset:6144
    v_subrev_u32 v10, 65536, v10
    v_mfma_f32_16x16x32_bf16 v[84:87], v[36:39], v[164:167], v[84:87]
    v_lshrrev_b32 v19, 3, v0
    v_and_b32 v18, 7, v0
    v_lshlrev_b32 v18, 4, v18
    v_lshl_add_u32 v18, v19, 10, v18
    v_mfma_f32_16x16x32_bf16 v[96:99], v[40:43], v[160:163], v[96:99]
    ds_read_b64_tr_b16 v[36:37], v12 offset:4096
    ds_read_b64_tr_b16 v[38:39], v12 offset:6144
    v_subrev_u32 v12, 65536, v12
    v_mfma_f32_16x16x32_bf16 v[100:103], v[40:43], v[164:167], v[100:103]
    s_waitcnt vmcnt(8)
    v_lshlrev_b32 v22, 2, v0
    v_mov_b32 v23, s5
    s_mov_b32 exec_hi, 0
    buffer_store_dword v23, v22, s[24:27], s16 offen sc1
    s_mov_b32 exec_hi, -1
    s_waitcnt lgkmcnt(4)
    v_mfma_f32_16x16x32_bf16 v[88:91], v[24:27], v[160:163], v[88:91]
    ds_read_b64_tr_b16 v[40:41], v11 offset:4096
    ds_read_b64_tr_b16 v[42:43], v11 offset:6144
    v_subrev_u32 v11, 65536, v11
    v_mfma_f32_16x16x32_bf16 v[92:95], v[24:27], v[164:167], v[92:95]
    v_lshlrev_b32 v19, 4, v19
    buffer_load_dword v5, v19, s[24:27], s23 offen sc1
    v_mfma_f32_16x16x32_bf16 v[104:107], v[28:31], v[160:163], v[104:107]
    s_barrier
    ds_read_b64_tr_b16 v[24:25], v13 offset:4096
    ds_read_b64_tr_b16 v[26:27], v13 offset:6144
    v_subrev_u32 v13, 65536, v13
    v_mfma_f32_16x16x32_bf16 v[108:111], v[28:31], v[164:167], v[108:111]
    buffer_load_dwordx4 v[44:47], v18, s[28:31], s13 offen
    s_waitcnt lgkmcnt(4)
    v_mfma_f32_16x16x32_bf16 v[80:83], v[32:35], v[168:171], v[80:83]
    s_add_u32 m0, s6, 98304
    ds_read_b64_tr_b16 v[28:29], v10 offset:32768
    ds_read_b64_tr_b16 v[30:31], v10 offset:34816
    v_mfma_f32_16x16x32_bf16 v[84:87], v[32:35], v[172:175], v[84:87]
    buffer_load_dwordx4 v1, s[32:35], s45 offen lds
    v_mfma_f32_16x16x32_bf16 v[96:99], v[36:39], v[168:171], v[96:99]
    ds_read_b64_tr_b16 v[32:33], v12 offset:32768
    ds_read_b64_tr_b16 v[34:35], v12 offset:34816
    v_mfma_f32_16x16x32_bf16 v[100:103], v[36:39], v[172:175], v[100:103]
    s_waitcnt lgkmcnt(4)
    v_mfma_f32_16x16x32_bf16 v[88:91], v[40:43], v[168:171], v[88:91]
    ds_read_b64_tr_b16 v[36:37], v11 offset:32768
    ds_read_b64_tr_b16 v[38:39], v11 offset:34816
    v_mfma_f32_16x16x32_bf16 v[92:95], v[40:43], v[172:175], v[92:95]
    buffer_load_dwordx4 v2, s[32:35], s45 offen offset:1024 lds
    v_mfma_f32_16x16x32_bf16 v[104:107], v[24:27], v[168:171], v[104:107]
    ds_read_b64_tr_b16 v[40:41], v13 offset:32768
    ds_read_b64_tr_b16 v[42:43], v13 offset:34816
    v_mfma_f32_16x16x32_bf16 v[108:111], v[24:27], v[172:175], v[108:111]
    s_waitcnt lgkmcnt(4)
    v_mfma_f32_16x16x32_bf16 v[80:83], v[28:31], v[176:179], v[80:83]
    ds_read_b64_tr_b16 v[24:25], v10 offset:36864
    ds_read_b64_tr_b16 v[26:27], v10 offset:38912
    v_mfma_f32_16x16x32_bf16 v[84:87], v[28:31], v[180:183], v[84:87]
    buffer_load_dwordx4 v3, s[32:35], s45 offen offset:2048 lds
    v_mfma_f32_16x16x32_bf16 v[96:99], v[32:35], v[176:179], v[96:99]
    ds_read_b64_tr_b16 v[28:29], v12 offset:36864
    ds_read_b64_tr_b16 v[30:31], v12 offset:38912
    v_mfma_f32_16x16x32_bf16 v[100:103], v[32:35], v[180:183], v[100:103]
    s_waitcnt lgkmcnt(4)
    v_mfma_f32_16x16x32_bf16 v[88:91], v[36:39], v[176:179], v[88:91]
    ds_read_b64_tr_b16 v[32:33], v11 offset:36864
    ds_read_b64_tr_b16 v[34:35], v11 offset:38912
    v_mfma_f32_16x16x32_bf16 v[92:95], v[36:39], v[180:183], v[92:95]
    buffer_load_dwordx4 v4, s[32:35], s45 offen offset:3072 lds
    v_mfma_f32_16x16x32_bf16 v[104:107], v[40:43], v[176:179], v[104:107]
    s_barrier
    ds_read_b64_tr_b16 v[36:37], v13 offset:36864
    ds_read_b64_tr_b16 v[38:39], v13 offset:38912
    v_mfma_f32_16x16x32_bf16 v[108:111], v[40:43], v[180:183], v[108:111]
    s_waitcnt lgkmcnt(4)
    v_mfma_f32_16x16x32_bf16 v[80:83], v[24:27], v[184:187], v[80:83]
    s_add_u32 m0, s6, 65536
    ds_read_b64_tr_b16 v[40:41], v10 offset:0
    ds_read_b64_tr_b16 v[42:43], v10 offset:2048
    v_mfma_f32_16x16x32_bf16 v[84:87], v[24:27], v[188:191], v[84:87]
    buffer_load_dwordx4 v1, s[32:35], s46 offen lds
    v_mfma_f32_16x16x32_bf16 v[96:99], v[28:31], v[184:187], v[96:99]
    ds_read_b64_tr_b16 v[24:25], v12 offset:0
    ds_read_b64_tr_b16 v[26:27], v12 offset:2048
    v_mfma_f32_16x16x32_bf16 v[100:103], v[28:31], v[188:191], v[100:103]
    s_waitcnt lgkmcnt(4)
    v_mfma_f32_16x16x32_bf16 v[88:91], v[32:35], v[184:187], v[88:91]
    ds_read_b64_tr_b16 v[28:29], v11 offset:0
    ds_read_b64_tr_b16 v[30:31], v11 offset:2048
    v_mfma_f32_16x16x32_bf16 v[92:95], v[32:35], v[188:191], v[92:95]
    buffer_load_dwordx4 v2, s[32:35], s46 offen offset:1024 lds
    v_mfma_f32_16x16x32_bf16 v[104:107], v[36:39], v[184:187], v[104:107]
    ds_read_b64_tr_b16 v[32:33], v13 offset:0
    ds_read_b64_tr_b16 v[34:35], v13 offset:2048
    v_mfma_f32_16x16x32_bf16 v[108:111], v[36:39], v[188:191], v[108:111]
    s_waitcnt lgkmcnt(4)
    v_mfma_f32_16x16x32_bf16 v[80:83], v[40:43], v[192:195], v[80:83]
    ds_read_b64_tr_b16 v[36:37], v10 offset:4096
    ds_read_b64_tr_b16 v[38:39], v10 offset:6144
    v_add_u32 v10, 131072, v10
    v_mfma_f32_16x16x32_bf16 v[84:87], v[40:43], v[196:199], v[84:87]
    buffer_load_dwordx4 v3, s[32:35], s46 offen offset:2048 lds
    v_and_b32 v144, 15, v0
    v_lshrrev_b32 v145, 4, v0
    v_and_b32 v146, 7, v0
    v_mfma_f32_16x16x32_bf16 v[96:99], v[24:27], v[192:195], v[96:99]
    ds_read_b64_tr_b16 v[40:41], v12 offset:4096
    ds_read_b64_tr_b16 v[42:43], v12 offset:6144
    v_add_u32 v12, 131072, v12
    v_mfma_f32_16x16x32_bf16 v[100:103], v[24:27], v[196:199], v[100:103]
    s_lshl_b32 s11, s4, 12
    s_add_u32 s11, s11, 98304
    v_lshl_add_u32 v144, v144, 7, s11
    s_bfe_u32 s11, s4, 0x10001
    v_xor_b32 v180, s11, v145
    s_waitcnt lgkmcnt(4)
    v_mfma_f32_16x16x32_bf16 v[88:91], v[28:31], v[192:195], v[88:91]
    ds_read_b64_tr_b16 v[24:25], v11 offset:4096
    ds_read_b64_tr_b16 v[26:27], v11 offset:6144
    v_add_u32 v11, 131072, v11
    v_mfma_f32_16x16x32_bf16 v[92:95], v[28:31], v[196:199], v[92:95]
    buffer_load_dwordx4 v4, s[32:35], s46 offen offset:3072 lds
    v_xor_b32 v180, v180, v146
    v_lshl_add_u32 v180, v180, 4, v144
    v_xor_b32 v181, 16, v180
    v_mfma_f32_16x16x32_bf16 v[104:107], v[32:35], v[192:195], v[104:107]
    s_waitcnt vmcnt(11)
    s_barrier
    ds_read_b64_tr_b16 v[28:29], v13 offset:4096
    ds_read_b64_tr_b16 v[30:31], v13 offset:6144
    v_add_u32 v13, 131072, v13
    v_mfma_f32_16x16x32_bf16 v[108:111], v[32:35], v[196:199], v[108:111]
    v_xor_b32 v182, 64, v180
    v_xor_b32 v183, 80, v180
    s_waitcnt lgkmcnt(4)
    v_mfma_f32_16x16x32_bf16 v[80:83], v[36:39], v[200:203], v[80:83]
    s_add_u32 m0, s6, 32768
    ds_read_b64_tr_b16 v[32:33], v10 offset:0
    ds_read_b64_tr_b16 v[34:35], v10 offset:2048
    v_mfma_f32_16x16x32_bf16 v[84:87], v[36:39], v[204:207], v[84:87]
    buffer_load_dwordx4 v1, s[36:39], s47 offen lds
    v_lshrrev_b32 v144, 3, v0
    v_xor_b32 v145, v144, v146
    v_mfma_f32_16x16x32_bf16 v[96:99], v[40:43], v[200:203], v[96:99]
    ds_read_b64_tr_b16 v[36:37], v12 offset:0
    ds_read_b64_tr_b16 v[38:39], v12 offset:2048
    v_mfma_f32_16x16x32_bf16 v[100:103], v[40:43], v[204:207], v[100:103]
    s_and_b32 s11, s4, 3
    s_lshl_b32 s11, s11, 10
    s_lshr_b32 s8, s4, 2
    s_lshl_b32 s8, s8, 14
    s_add_u32 s11, s11, s8
    s_add_u32 s11, s11, 98304
    v_lshl_add_u32 v144, v144, 7, s11
    v_bfe_u32 v147, v0, 2, 1
    v_lshl_add_u32 v144, v147, 13, v144
    s_waitcnt lgkmcnt(4)
    v_mfma_f32_16x16x32_bf16 v[88:91], v[24:27], v[200:203], v[88:91]
    ds_read_b64_tr_b16 v[40:41], v11 offset:0
    ds_read_b64_tr_b16 v[42:43], v11 offset:2048
    v_mfma_f32_16x16x32_bf16 v[92:95], v[24:27], v[204:207], v[92:95]
    buffer_load_dwordx4 v2, s[36:39], s47 offen offset:1024 lds
    v_and_b32 v146, 3, v0
    v_lshl_add_u32 v146, v146, 1, v147
    v_bfe_u32 v145, v0, 3, 3
    v_mfma_f32_16x16x32_bf16 v[104:107], v[28:31], v[200:203], v[104:107]
    ds_read_b64_tr_b16 v[24:25], v13 offset:0
    ds_read_b64_tr_b16 v[26:27], v13 offset:2048
    v_mfma_f32_16x16x32_bf16 v[108:111], v[28:31], v[204:207], v[108:111]
    v_xor_b32 v146, v146, v145
    v_lshl_add_u32 v188, v146, 4, v144
    v_xor_b32 v189, 16, v188
    v_xor_b32 v186, 8192, v188
    s_waitcnt lgkmcnt(4)
    v_mfma_f32_16x16x32_bf16 v[80:83], v[32:35], v[208:211], v[80:83]
    ds_read_b64_tr_b16 v[28:29], v10 offset:4096
    ds_read_b64_tr_b16 v[30:31], v10 offset:6144
    v_subrev_u32 v10, 65536, v10
    v_mfma_f32_16x16x32_bf16 v[84:87], v[32:35], v[212:215], v[84:87]
    buffer_load_dwordx4 v3, s[36:39], s47 offen offset:2048 lds
    v_xor_b32 v187, 8192, v189
    v_subrev_u32 v176, 0x8000, v180
    v_subrev_u32 v178, 0x8000, v182
    v_mfma_f32_16x16x32_bf16 v[96:99], v[36:39], v[208:211], v[96:99]
    ds_read_b64_tr_b16 v[32:33], v12 offset:4096
    ds_read_b64_tr_b16 v[34:35], v12 offset:6144
    v_subrev_u32 v12, 65536, v12
    v_mfma_f32_16x16x32_bf16 v[100:103], v[36:39], v[212:215], v[100:103]
    v_subrev_u32 v184, 0x8000, v188
    v_subrev_u32 v185, 0x8000, v189
    s_waitcnt lgkmcnt(4)
    v_mfma_f32_16x16x32_bf16 v[88:91], v[40:43], v[208:211], v[88:91]
    ds_read_b64_tr_b16 v[36:37], v11 offset:4096
    ds_read_b64_tr_b16 v[38:39], v11 offset:6144
    v_subrev_u32 v11, 65536, v11
    v_mfma_f32_16x16x32_bf16 v[92:95], v[40:43], v[212:215], v[92:95]
    buffer_load_dwordx4 v4, s[36:39], s47 offen offset:3072 lds
    v_min_u32 v20, 7, v0
    v_lshlrev_b32 v20, 7, v20
    v_mfma_f32_16x16x32_bf16 v[104:107], v[24:27], v[208:211], v[104:107]
    s_waitcnt vmcnt(8)
    s_barrier
    ds_read_b64_tr_b16 v[40:41], v13 offset:4096
    ds_read_b64_tr_b16 v[42:43], v13 offset:6144
    v_subrev_u32 v13, 65536, v13
    v_mfma_f32_16x16x32_bf16 v[108:111], v[24:27], v[212:215], v[108:111]
    buffer_load_dword v21, v20, s[24:27], s15 offen sc1
    s_waitcnt lgkmcnt(4)
    v_mfma_f32_16x16x32_bf16 v[80:83], v[28:31], v[216:219], v[80:83]
    s_mov_b32 m0, s6
    ds_read_b64_tr_b16 v[24:25], v10 offset:32768
    ds_read_b64_tr_b16 v[26:27], v10 offset:34816
    v_mfma_f32_16x16x32_bf16 v[84:87], v[28:31], v[220:223], v[84:87]
    buffer_load_dwordx4 v1, s[36:39], s48 offen lds
    s_and_b32 s7, s4, 3
    v_mfma_f32_16x16x32_bf16 v[96:99], v[32:35], v[216:219], v[96:99]
    ds_read_b64_tr_b16 v[28:29], v12 offset:32768
    ds_read_b64_tr_b16 v[30:31], v12 offset:34816
    v_mfma_f32_16x16x32_bf16 v[100:103], v[32:35], v[220:223], v[100:103]
    s_mul_i32 s7, s7, 20480
    s_sub_u32 s7, s17, s7
    s_add_u32 s7, s7, 114688
    s_waitcnt lgkmcnt(4)
    v_mfma_f32_16x16x32_bf16 v[88:91], v[36:39], v[216:219], v[88:91]
    ds_read_b64_tr_b16 v[32:33], v11 offset:32768
    ds_read_b64_tr_b16 v[34:35], v11 offset:34816
    v_mfma_f32_16x16x32_bf16 v[92:95], v[36:39], v[220:223], v[92:95]
    buffer_load_dwordx4 v2, s[36:39], s48 offen offset:1024 lds
    s_add_u32 s9, s7, 0
    s_add_u32 s10, s7, 4096
    v_mfma_f32_16x16x32_bf16 v[104:107], v[40:43], v[216:219], v[104:107]
    ds_read_b64_tr_b16 v[36:37], v13 offset:32768
    ds_read_b64_tr_b16 v[38:39], v13 offset:34816
    v_mfma_f32_16x16x32_bf16 v[108:111], v[40:43], v[220:223], v[108:111]
    s_waitcnt lgkmcnt(4)
    v_mfma_f32_16x16x32_bf16 v[80:83], v[24:27], v[224:227], v[80:83]
    ds_read_b64_tr_b16 v[40:41], v10 offset:36864
    ds_read_b64_tr_b16 v[42:43], v10 offset:38912
    v_mfma_f32_16x16x32_bf16 v[84:87], v[24:27], v[228:231], v[84:87]
    buffer_load_dwordx4 v3, s[36:39], s48 offen offset:2048 lds
    v_mfma_f32_16x16x32_bf16 v[96:99], v[28:31], v[224:227], v[96:99]
    ds_read_b64_tr_b16 v[24:25], v12 offset:36864
    ds_read_b64_tr_b16 v[26:27], v12 offset:38912
    v_mfma_f32_16x16x32_bf16 v[100:103], v[28:31], v[228:231], v[100:103]
    v_and_b32 v22, 15, v0
    s_cmp_eq_u32 s12, 0
    s_cselect_b32 s7, 0, 2146435072
    v_lshl_or_b32 v22, v22, 16, s7
    s_waitcnt lgkmcnt(4)
    v_mfma_f32_16x16x32_bf16 v[88:91], v[32:35], v[224:227], v[88:91]
    ds_read_b64_tr_b16 v[28:29], v13 offset:36864
    ds_read_b64_tr_b16 v[30:31], v13 offset:38912
    v_mfma_f32_16x16x32_bf16 v[92:95], v[32:35], v[228:231], v[92:95]
    buffer_load_dwordx4 v4, s[36:39], s48 offen offset:3072 lds
    s_mov_b32 s22, 16785408
    v_mfma_f32_16x16x32_bf16 v[104:107], v[36:39], v[224:227], v[104:107]
    s_waitcnt vmcnt(9)
    s_barrier
    ds_read_b64_tr_b16 v[32:33], v12 offset:0
    ds_read_b64_tr_b16 v[34:35], v12 offset:2048
    v_mfma_f32_16x16x32_bf16 v[108:111], v[36:39], v[228:231], v[108:111]
    s_waitcnt lgkmcnt(4)
    v_mfma_f32_16x16x32_bf16 v[80:83], v[40:43], v[232:235], v[80:83]
    ds_read_b64_tr_b16 v[36:37], v13 offset:0
    ds_read_b64_tr_b16 v[38:39], v13 offset:2048
    v_mfma_f32_16x16x32_bf16 v[84:87], v[40:43], v[236:239], v[84:87]
    s_waitcnt vmcnt(4)
    v_cmp_ne_u32 vcc, s5, v21
    s_nop 0
    s_cbranch_vccz Lok_O_26
    s_mov_b32 s18, 0
Lsp_O_27:
    buffer_load_dword v21, v20, s[24:27], s15 offen sc1
    s_waitcnt vmcnt(0)
    v_cmp_ne_u32 vcc, s5, v21
    s_nop 0
    s_cbranch_vccz Lok_O_26
    s_add_u32 s18, s18, 1
    s_cmp_lt_u32 s18, 20000
    s_cbranch_scc1 Lsp_O_27
Lok_O_26:
    buffer_load_dwordx4 v[48:51], v9, s[24:27], s9 offen sc1
    v_mfma_f32_16x16x32_bf16 v[96:99], v[24:27], v[232:235], v[96:99]
    ds_read_b64_tr_b16 v[40:41], v12 offset:4096
    ds_read_b64_tr_b16 v[42:43], v12 offset:6144
    v_add_u32 v12, v14, v12
    v_mfma_f32_16x16x32_bf16 v[100:103], v[24:27], v[236:239], v[100:103]
    buffer_load_dword v208, v22, s[24:27], s22 offen sc1
    s_waitcnt lgkmcnt(4)
    v_mfma_f32_16x16x32_bf16 v[104:107], v[28:31], v[232:235], v[104:107]
    ds_read_b64_tr_b16 v[24:25], v13 offset:4096
    ds_read_b64_tr_b16 v[26:27], v13 offset:6144
    v_add_u32 v13, v14, v13
    v_mfma_f32_16x16x32_bf16 v[108:111], v[28:31], v[236:239], v[108:111]
    buffer_load_dwordx4 v[52:55], v9, s[24:27], s9 offen offset:1024 sc1
    v_mfma_f32_16x16x32_bf16 v[96:99], v[32:35], v[240:243], v[96:99]
    ds_read_b64_tr_b16 v[28:29], v11 offset:36864
    ds_read_b64_tr_b16 v[30:31], v11 offset:38912
    v_mfma_f32_16x16x32_bf16 v[100:103], v[32:35], v[244:247], v[100:103]
    s_waitcnt lgkmcnt(4)
    v_mfma_f32_16x16x32_bf16 v[104:107], v[36:39], v[240:243], v[104:107]
    ds_read_b64_tr_b16 v[32:33], v10 offset:0
    ds_read_b64_tr_b16 v[34:35], v10 offset:2048
    v_mfma_f32_16x16x32_bf16 v[108:111], v[36:39], v[244:247], v[108:111]
    buffer_load_dwordx4 v[56:59], v9, s[24:27], s9 offen offset:2048 sc1
    v_mfma_f32_16x16x32_bf16 v[96:99], v[40:43], v[248:251], v[96:99]
    ds_read_b64_tr_b16 v[36:37], v11 offset:0
    ds_read_b64_tr_b16 v[38:39], v11 offset:2048
    v_mfma_f32_16x16x32_bf16 v[100:103], v[40:43], v[252:255], v[100:103]
    s_waitcnt lgkmcnt(4)
    v_mfma_f32_16x16x32_bf16 v[104:107], v[24:27], v[248:251], v[104:107]
    ds_read_b64_tr_b16 v[40:41], v10 offset:4096
    ds_read_b64_tr_b16 v[42:43], v10 offset:6144
    v_add_u32 v10, v14, v10
    v_mfma_f32_16x16x32_bf16 v[108:111], v[24:27], v[252:255], v[108:111]
    buffer_load_dwordx4 v[60:63], v9, s[24:27], s9 offen offset:3072 sc1
    v_mfma_f32_16x16x32_bf16 v[88:91], v[28:31], v[232:235], v[88:91]
    s_barrier
    ds_read_b64_tr_b16 v[24:25], v11 offset:4096
    ds_read_b64_tr_b16 v[26:27], v11 offset:6144
    v_add_u32 v11, v14, v11
    v_mfma_f32_16x16x32_bf16 v[92:95], v[28:31], v[236:239], v[92:95]
    s_waitcnt lgkmcnt(4)
    v_mfma_f32_16x16x32_bf16 v[80:83], v[32:35], v[240:243], v[80:83]
    ds_read_b64_tr_b16 v[28:29], v10 offset:32768
    ds_read_b64_tr_b16 v[30:31], v10 offset:33792
    v_mfma_f32_16x16x32_bf16 v[84:87], v[32:35], v[244:247], v[84:87]
    buffer_load_dwordx4 v[64:67], v9, s[24:27], s10 offen sc1
    v_mfma_f32_16x16x32_bf16 v[88:91], v[36:39], v[240:243], v[88:91]
    ds_read_b64_tr_b16 v[32:33], v12 offset:32768
    ds_read_b64_tr_b16 v[34:35], v12 offset:33792
    v_mfma_f32_16x16x32_bf16 v[92:95], v[36:39], v[244:247], v[92:95]
    ds_write_b128 v181, v[96:99] offset:32768
    s_waitcnt lgkmcnt(5)
    v_mfma_f32_16x16x32_bf16 v[80:83], v[40:43], v[248:251], v[80:83]
    ds_read_b64_tr_b16 v[36:37], v11 offset:32768
    ds_read_b64_tr_b16 v[38:39], v11 offset:33792
    v_mfma_f32_16x16x32_bf16 v[84:87], v[40:43], v[252:255], v[84:87]
    buffer_load_dwordx4 v[68:71], v9, s[24:27], s10 offen offset:1024 sc1
    ds_write_b128 v181, v[100:103] offset:34816
    v_mfma_f32_16x16x32_bf16 v[88:91], v[24:27], v[248:251], v[88:91]
    ds_read_b64_tr_b16 v[40:41], v13 offset:32768
    ds_read_b64_tr_b16 v[42:43], v13 offset:33792
    v_mfma_f32_16x16x32_bf16 v[92:95], v[24:27], v[252:255], v[92:95]
    ds_write_b128 v183, v[104:107] offset:32768
    s_waitcnt vmcnt(6) lgkmcnt(7)
    v_mfma_f32_16x16x32_bf16 v[112:115], v[28:31], v[48:51], 0
    ds_read_b64_tr_b16 v[24:25], v10 offset:36864
    ds_read_b64_tr_b16 v[26:27], v10 offset:37888
    s_waitcnt vmcnt(4)
    v_mfma_f32_16x16x32_bf16 v[116:119], v[28:31], v[52:55], 0
    buffer_load_dwordx4 v[72:75], v9, s[24:27], s10 offen offset:2048 sc1
    ds_write_b128 v183, v[108:111] offset:34816
    v_mfma_f32_16x16x32_bf16 v[128:131], v[32:35], v[48:51], 0
    ds_read_b64_tr_b16 v[28:29], v12 offset:36864
    ds_read_b64_tr_b16 v[30:31], v12 offset:37888
    v_mfma_f32_16x16x32_bf16 v[132:135], v[32:35], v[52:55], 0
    s_waitcnt lgkmcnt(6)
    v_mfma_f32_16x16x32_bf16 v[120:123], v[36:39], v[48:51], 0
    ds_read_b64_tr_b16 v[32:33], v13 offset:36864
    ds_read_b64_tr_b16 v[34:35], v13 offset:37888
    v_mfma_f32_16x16x32_bf16 v[124:127], v[36:39], v[52:55], 0
    buffer_load_dwordx4 v[76:79], v9, s[24:27], s10 offen offset:3072 sc1
    ds_write_b128 v180, v[80:83] offset:0
    v_mfma_f32_16x16x32_bf16 v[136:139], v[40:43], v[48:51], 0
    s_waitcnt lgkmcnt(5)
    s_barrier
    ds_read_b64_tr_b16 v[36:37], v12 offset:0
    ds_read_b64_tr_b16 v[38:39], v12 offset:1024
    v_mfma_f32_16x16x32_bf16 v[140:143], v[40:43], v[52:55], 0
    ds_write_b128 v180, v[84:87] offset:2048
    ds_read_b128 v[144:147], v186 offset:32768
    ds_read_b128 v[148:151], v187 offset:32768
    ds_read_b128 v[152:155], v186 offset:36864
    s_waitcnt vmcnt(5) lgkmcnt(9)
    v_mfma_f32_16x16x32_bf16 v[112:115], v[24:27], v[56:59], v[112:115]
    s_mov_b32 s50, 0xbfb8aa3b
    s_mov_b32 s51, 0xbfb8aa3b
    ds_read_b64_tr_b16 v[40:41], v13 offset:0
    ds_read_b64_tr_b16 v[42:43], v13 offset:1024
    s_waitcnt vmcnt(4)
    v_mfma_f32_16x16x32_bf16 v[116:119], v[24:27], v[60:63], v[116:119]
    ds_write_b128 v182, v[88:91] offset:0
    ds_read_b128 v[156:159], v187 offset:36864
    v_mfma_f32_16x16x32_bf16 v[128:131], v[28:31], v[56:59], v[128:131]
    ds_read_b64_tr_b16 v[24:25], v12 offset:4096
    ds_read_b64_tr_b16 v[26:27], v12 offset:5120
    v_mfma_f32_16x16x32_bf16 v[132:135], v[28:31], v[60:63], v[132:135]
    ds_write_b128 v182, v[92:95] offset:2048
    s_waitcnt lgkmcnt(11)
    v_mfma_f32_16x16x32_bf16 v[136:139], v[32:35], v[56:59], v[136:139]
    ds_read_b64_tr_b16 v[28:29], v13 offset:4096
    ds_read_b64_tr_b16 v[30:31], v13 offset:5120
    v_mfma_f32_16x16x32_bf16 v[140:143], v[32:35], v[60:63], v[140:143]
    s_cmp_lg_u32 s12, 0
    s_cbranch_scc1 Lnn_28
    v_cmp_ne_u32 vcc, s5, v208
    s_nop 0
    s_cbranch_vccz Lok_N_29
    s_mov_b32 s18, 0
Lsp_N_30:
    buffer_load_dword v208, v22, s[24:27], s22 offen sc1
    s_waitcnt vmcnt(0)
    v_cmp_ne_u32 vcc, s5, v208
    s_nop 0
    s_cbranch_vccz Lok_N_29
    s_add_u32 s18, s18, 1
    s_cmp_lt_u32 s18, 20000
    s_cbranch_scc1 Lsp_N_30
Lok_N_29:
    s_mov_b64 exec, 1
    v_mov_b32 v209, s5
    buffer_store_dword v209, off, s[24:27], 0 sc1
    s_mov_b64 exec, -1
Lnn_28:
    s_waitcnt lgkmcnt(5)
    v_add_f32 v192, v144, v152
    v_add_f32 v193, v145, v153
    v_add_f32 v194, v146, v154
    s_waitcnt vmcnt(3)
    v_mfma_f32_16x16x32_bf16 v[128:131], v[36:39], v[64:67], v[128:131]
    ds_read_b64_tr_b16 v[32:33], v11 offset:36864
    ds_read_b64_tr_b16 v[34:35], v11 offset:37888
    s_waitcnt vmcnt(2)
    v_mfma_f32_16x16x32_bf16 v[132:135], v[36:39], v[68:71], v[132:135]
    v_add_f32 v195, v147, v155
    v_add_f32 v196, v148, v156
    v_add_f32 v197, v149, v157
    v_add_f32 v198, v150, v158
    v_add_f32 v199, v151, v159
    s_waitcnt lgkmcnt(5)
    v_mfma_f32_16x16x32_bf16 v[136:139], v[40:43], v[64:67], v[136:139]
    ds_read_b64_tr_b16 v[36:37], v10 offset:0
    ds_read_b64_tr_b16 v[38:39], v10 offset:1024
    v_mfma_f32_16x16x32_bf16 v[140:143], v[40:43], v[68:71], v[140:143]
    v_mul_f32 v5, v5, v5
    v_mul_f32 v4, 0xbfb8aa3b, v5
    v_mul_f32 v5, 0xbfb8aa3b, v5
    v_lshlrev_b32 v210, 16, v44
    v_and_b32 v211, 0xffff0000, v44
    s_waitcnt vmcnt(1)
    v_mfma_f32_16x16x32_bf16 v[128:131], v[24:27], v[72:75], v[128:131]
    ds_read_b64_tr_b16 v[40:41], v11 offset:0
    ds_read_b64_tr_b16 v[42:43], v11 offset:1024
    s_waitcnt vmcnt(0)
    v_mfma_f32_16x16x32_bf16 v[132:135], v[24:27], v[76:79], v[132:135]
    v_lshlrev_b32 v212, 16, v45
    v_and_b32 v213, 0xffff0000, v45
    v_lshlrev_b32 v214, 16, v46
    v_and_b32 v215, 0xffff0000, v46
    v_lshlrev_b32 v216, 16, v47
    s_waitcnt lgkmcnt(4)
    v_mfma_f32_16x16x32_bf16 v[136:139], v[28:31], v[72:75], v[136:139]
    s_barrier
    ds_read_b64_tr_b16 v[24:25], v10 offset:4096
    ds_read_b64_tr_b16 v[26:27], v10 offset:5120
    v_mfma_f32_16x16x32_bf16 v[140:143], v[28:31], v[76:79], v[140:143]
    ds_read_b128 v[160:163], v188 offset:0
    ds_read_b128 v[164:167], v189 offset:0
    ds_read_b128 v[168:171], v188 offset:4096
    ds_read_b128 v[172:175], v189 offset:4096
    v_and_b32 v217, 0xffff0000, v47
    v_mfma_f32_16x16x32_bf16 v[120:123], v[32:35], v[56:59], v[120:123]
    ds_read_b64_tr_b16 v[28:29], v11 offset:4096
    ds_read_b64_tr_b16 v[30:31], v11 offset:5120
    v_mfma_f32_16x16x32_bf16 v[124:127], v[32:35], v[60:63], v[124:127]
    s_waitcnt lgkmcnt(8)
    v_mfma_f32_16x16x32_bf16 v[112:115], v[36:39], v[64:67], v[112:115]
    v_mfma_f32_16x16x32_bf16 v[116:119], v[36:39], v[68:71], v[116:119]
    ds_write_b128 v181, v[128:131] offset:32768
    v_mfma_f32_16x16x32_bf16 v[120:123], v[40:43], v[64:67], v[120:123]
    v_mfma_f32_16x16x32_bf16 v[124:127], v[40:43], v[68:71], v[124:127]
    ds_write_b128 v181, v[132:135] offset:34816
    s_waitcnt lgkmcnt(2)
    v_mfma_f32_16x16x32_bf16 v[112:115], v[24:27], v[72:75], v[112:115]
    v_mfma_f32_16x16x32_bf16 v[116:119], v[24:27], v[76:79], v[116:119]
    ds_write_b128 v183, v[136:139] offset:32768
    v_mfma_f32_16x16x32_bf16 v[120:123], v[28:31], v[72:75], v[120:123]
    v_mfma_f32_16x16x32_bf16 v[124:127], v[28:31], v[76:79], v[124:127]
    ds_write_b128 v183, v[140:143] offset:34816
    v_pk_add_f32 v[192:193], v[192:193], v[160:161]
    v_pk_add_f32 v[194:195], v[194:195], v[162:163]
    v_pk_add_f32 v[196:197], v[196:197], v[164:165]
    v_pk_add_f32 v[198:199], v[198:199], v[166:167]
    v_pk_add_f32 v[192:193], v[192:193], v[168:169]
    v_pk_add_f32 v[194:195], v[194:195], v[170:171]
    v_pk_add_f32 v[196:197], v[196:197], v[172:173]
    v_pk_add_f32 v[198:199], v[198:199], v[174:175]
    ds_write_b128 v176, v[112:115] offset:0
    ds_write_b128 v176, v[116:119] offset:2048
    ds_write_b128 v178, v[120:123] offset:0
    ds_write_b128 v178, v[124:127] offset:2048
    v_pk_mul_f32 v[192:193], v[192:193], v[4:5]
    v_pk_mul_f32 v[194:195], v[194:195], v[4:5]
    v_pk_mul_f32 v[196:197], v[196:197], v[4:5]
    v_pk_mul_f32 v[198:199], v[198:199], v[4:5]
    v_exp_f32 v200, v192
    v_exp_f32 v201, v193
    v_exp_f32 v202, v194
    v_exp_f32 v203, v195
    v_exp_f32 v204, v196
    v_exp_f32 v205, v197
    v_exp_f32 v206, v198
    v_exp_f32 v207, v199
    v_pk_fma_f32 v[200:201], v[200:201], s[50:51], s[50:51]
    v_pk_fma_f32 v[202:203], v[202:203], s[50:51], s[50:51]
    v_pk_fma_f32 v[204:205], v[204:205], s[50:51], s[50:51]
    v_pk_fma_f32 v[206:207], v[206:207], s[50:51], s[50:51]
    v_rcp_f32 v200, v200
    v_rcp_f32 v201, v201
    v_rcp_f32 v202, v202
    v_rcp_f32 v203, v203
    v_rcp_f32 v204, v204
    v_rcp_f32 v205, v205
    v_rcp_f32 v206, v206
    v_rcp_f32 v207, v207
    v_pk_mul_f32 v[192:193], v[192:193], v[200:201]
    v_pk_mul_f32 v[194:195], v[194:195], v[202:203]
    v_pk_mul_f32 v[196:197], v[196:197], v[204:205]
    v_pk_mul_f32 v[198:199], v[198:199], v[206:207]
    s_waitcnt lgkmcnt(0)
    s_barrier
    ds_read_b128 v[220:223], v186 offset:32768
    ds_read_b128 v[224:227], v187 offset:32768
    ds_read_b128 v[228:231], v186 offset:36864
    ds_read_b128 v[232:235], v187 offset:36864
    ds_read_b128 v[236:239], v184 offset:0
    ds_read_b128 v[240:243], v185 offset:0
    ds_read_b128 v[244:247], v184 offset:4096
    ds_read_b128 v[248:251], v185 offset:4096
    s_waitcnt lgkmcnt(4)
    v_pk_add_f32 v[200:201], v[220:221], v[228:229]
    v_pk_add_f32 v[202:203], v[222:223], v[230:231]
    v_pk_add_f32 v[204:205], v[224:225], v[232:233]
    v_pk_add_f32 v[206:207], v[226:227], v[234:235]
    s_waitcnt lgkmcnt(2)
    v_pk_add_f32 v[200:201], v[200:201], v[236:237]
    v_pk_add_f32 v[202:203], v[202:203], v[238:239]
    v_pk_add_f32 v[204:205], v[204:205], v[240:241]
    v_pk_add_f32 v[206:207], v[206:207], v[242:243]
    s_waitcnt lgkmcnt(0)
    v_pk_add_f32 v[200:201], v[200:201], v[244:245]
    v_pk_add_f32 v[202:203], v[202:203], v[246:247]
    v_pk_add_f32 v[204:205], v[204:205], v[248:249]
    v_pk_add_f32 v[206:207], v[206:207], v[250:251]
    v_pk_fma_f32 v[210:211], v[200:201], v[192:193], v[210:211]
    v_pk_fma_f32 v[212:213], v[202:203], v[194:195], v[212:213]
    v_pk_fma_f32 v[214:215], v[204:205], v[196:197], v[214:215]
    v_pk_fma_f32 v[216:217], v[206:207], v[198:199], v[216:217]
    v_cvt_pk_bf16_f32 v236, v210, v211
    v_cvt_pk_bf16_f32 v237, v212, v213
    v_cvt_pk_bf16_f32 v238, v214, v215
    v_cvt_pk_bf16_f32 v239, v216, v217
    buffer_store_dwordx4 v[236:239], v18, s[40:43], s13 offen sc1
L_exit:
    s_endpgm
L_end:
L_q0:
    ds_read_b128 v[28:31], v102 offset:8192
    v_mov_b32 v27, 0xff000000
    s_waitcnt lgkmcnt(0)
    v_mfma_f32_32x32x16_bf16 v[128:143], v[28:31], v[96:99], 0
    s_nop 11
    v_cndmask_b32 v128, v27, v128, s[44:45]
    v_cndmask_b32 v129, v27, v129, s[46:47]
    v_cndmask_b32 v130, v27, v130, s[48:49]
    v_cndmask_b32 v131, v27, v131, s[50:51]
    v_cndmask_b32 v132, v27, v132, s[52:53]
    v_cndmask_b32 v133, v27, v133, s[54:55]
    v_cndmask_b32 v134, v27, v134, s[56:57]
    v_cndmask_b32 v135, v27, v135, s[58:59]
    v_cndmask_b32 v136, v27, v136, s[60:61]
    v_cndmask_b32 v137, v27, v137, s[62:63]
    v_cndmask_b32 v138, v27, v138, s[64:65]
    v_cndmask_b32 v139, v27, v139, s[66:67]
    v_cndmask_b32 v140, v27, v140, s[68:69]
    v_cndmask_b32 v141, v27, v141, s[70:71]
    v_cndmask_b32 v142, v27, v142, s[72:73]
    v_cndmask_b32 v143, v27, v143, s[74:75]
    v_max3_f32 v26, v128, v129, v26
    v_max3_f32 v26, v130, v131, v26
    v_max3_f32 v26, v132, v133, v26
    v_max3_f32 v26, v134, v135, v26
    v_max3_f32 v26, v136, v137, v26
    v_max3_f32 v26, v138, v139, v26
    v_max3_f32 v26, v140, v141, v26
    v_max3_f32 v26, v142, v143, v26
    s_branch L_q0_back
L_fb:
    v_lshrrev_b32 v27, 5, v0
    v_and_b32 v26, 31, v0
    v_lshlrev_b32 v27, 2, v27
    v_sub_u32 v27, v26, v27
    v_cmp_le_i32 s[44:45], 0, v27
    v_cmp_le_i32 s[46:47], 1, v27
    v_cmp_le_i32 s[48:49], 2, v27
    v_cmp_le_i32 s[50:51], 3, v27
    v_mov_b32 v26, 0xff7fffff
    v_mov_b32 v10, 0
    v_mov_b32 v11, 0
    v_mov_b32 v12, 0
    v_mov_b32 v13, 0
    v_mov_b32 v14, 0
    v_mov_b32 v15, 0
    v_mov_b32 v16, 0
    v_mov_b32 v17, 0
    v_mov_b32 v18, 0
    v_mov_b32 v19, 0
    v_mov_b32 v20, 0
    v_mov_b32 v21, 0
    v_mov_b32 v22, 0
    v_mov_b32 v23, 0
    v_mov_b32 v24, 0
    v_mov_b32 v25, 0
    ds_read_b128 v[36:39], v102 offset:7168
    ds_read_b128 v[40:43], v102 offset:6144
    s_cmp_lg_u32 s19, 0
    s_cbranch_scc1 Lc_31
    v_mov_b32 v10, 0xff000000
    v_mov_b32 v11, 0xff000000
    v_mov_b32 v12, 0xff000000
    v_mov_b32 v13, 0xff000000
    v_mov_b32 v14, 0xff000000
    v_mov_b32 v15, 0xff000000
    v_mov_b32 v16, 0xff000000
    v_mov_b32 v17, 0xff000000
    v_mov_b32 v18, 0xff000000
    v_mov_b32 v19, 0xff000000
    v_mov_b32 v20, 0xff000000
    v_mov_b32 v21, 0xff000000
    v_mov_b32 v22, 0xff000000
    v_mov_b32 v23, 0xff000000
    v_mov_b32 v24, 0xff000000
    v_mov_b32 v25, 0xff000000
Lc_31:
    s_waitcnt lgkmcnt(1)
    s_nop 0
    v_mfma_f32_32x32x16_bf16 v[48:63], v[36:39], v[96:99], v[10:25]
    s_cmp_lg_u32 s19, 1
    s_cbranch_scc1 Lc_32
    s_nop 4
    v_mov_b32 v10, 0xff000000
    v_mov_b32 v11, 0xff000000
    v_mov_b32 v12, 0xff000000
    v_mov_b32 v13, 0xff000000
    v_mov_b32 v14, 0xff000000
    v_mov_b32 v15, 0xff000000
    v_mov_b32 v16, 0xff000000
    v_mov_b32 v17, 0xff000000
    v_mov_b32 v18, 0xff000000
    v_mov_b32 v19, 0xff000000
    v_mov_b32 v20, 0xff000000
    v_mov_b32 v21, 0xff000000
    v_mov_b32 v22, 0xff000000
    v_mov_b32 v23, 0xff000000
    v_mov_b32 v24, 0xff000000
    v_mov_b32 v25, 0xff000000
Lc_32:
    s_waitcnt lgkmcnt(0)
    s_nop 0
    v_mfma_f32_32x32x16_bf16 v[64:79], v[40:43], v[96:99], v[10:25]
    ds_read_b128 v[36:39], v102 offset:5120
    s_nop 5
    v_max3_f32 v26, v48, v49, v26
    v_max3_f32 v26, v50, v51, v26
    v_max3_f32 v26, v52, v53, v26
    v_max3_f32 v26, v54, v55, v26
    v_max3_f32 v26, v56, v57, v26
    v_max3_f32 v26, v58, v59, v26
    v_max3_f32 v26, v60, v61, v26
    v_max3_f32 v26, v62, v63, v26
    s_cmp_lg_u32 s19, 2
    s_cbranch_scc1 Lc_33
    v_mov_b32 v10, 0xff000000
    v_mov_b32 v11, 0xff000000
    v_mov_b32 v12, 0xff000000
    v_mov_b32 v13, 0xff000000
    v_mov_b32 v14, 0xff000000
    v_mov_b32 v15, 0xff000000
    v_mov_b32 v16, 0xff000000
    v_mov_b32 v17, 0xff000000
    v_mov_b32 v18, 0xff000000
    v_mov_b32 v19, 0xff000000
    v_mov_b32 v20, 0xff000000
    v_mov_b32 v21, 0xff000000
    v_mov_b32 v22, 0xff000000
    v_mov_b32 v23, 0xff000000
    v_mov_b32 v24, 0xff000000
    v_mov_b32 v25, 0xff000000
Lc_33:
    s_waitcnt lgkmcnt(0)
    s_nop 0
    v_mfma_f32_32x32x16_bf16 v[48:63], v[36:39], v[96:99], v[10:25]
    ds_read_b128 v[40:43], v102 offset:4096
    v_max3_f32 v26, v64, v65, v26
    v_max3_f32 v26, v66, v67, v26
    v_max3_f32 v26, v68, v69, v26
    v_max3_f32 v26, v70, v71, v26
    v_max3_f32 v26, v72, v73, v26
    v_max3_f32 v26, v74, v75, v26
    v_max3_f32 v26, v76, v77, v26
    v_max3_f32 v26, v78, v79, v26
    s_cmp_lg_u32 s19, 3
    s_cbranch_scc1 Lc_34
    v_mov_b32 v10, 0xff000000
    v_mov_b32 v11, 0xff000000
    v_mov_b32 v12, 0xff000000
    v_mov_b32 v13, 0xff000000
    v_mov_b32 v14, 0xff000000
    v_mov_b32 v15, 0xff000000
    v_mov_b32 v16, 0xff000000
    v_mov_b32 v17, 0xff000000
    v_mov_b32 v18, 0xff000000
    v_mov_b32 v19, 0xff000000
    v_mov_b32 v20, 0xff000000
    v_mov_b32 v21, 0xff000000
    v_mov_b32 v22, 0xff000000
    v_mov_b32 v23, 0xff000000
    v_mov_b32 v24, 0xff000000
    v_mov_b32 v25, 0xff000000
Lc_34:
    s_waitcnt lgkmcnt(0)
    s_nop 0
    v_mfma_f32_32x32x16_bf16 v[64:79], v[40:43], v[96:99], v[10:25]
    ds_read_b128 v[36:39], v102 offset:3072
    v_max3_f32 v26, v48, v49, v26
    v_max3_f32 v26, v50, v51, v26
    v_max3_f32 v26, v52, v53, v26
    v_max3_f32 v26, v54, v55, v26
    v_max3_f32 v26, v56, v57, v26
    v_max3_f32 v26, v58, v59, v26
    v_max3_f32 v26, v60, v61, v26
    v_max3_f32 v26, v62, v63, v26
    s_cmp_lg_u32 s19, 4
    s_cbranch_scc1 Lc_35
    v_mov_b32 v10, 0xff000000
    v_mov_b32 v11, 0xff000000
    v_mov_b32 v12, 0xff000000
    v_mov_b32 v13, 0xff000000
    v_mov_b32 v14, 0xff000000
    v_mov_b32 v15, 0xff000000
    v_mov_b32 v16, 0xff000000
    v_mov_b32 v17, 0xff000000
    v_mov_b32 v18, 0xff000000
    v_mov_b32 v19, 0xff000000
    v_mov_b32 v20, 0xff000000
    v_mov_b32 v21, 0xff000000
    v_mov_b32 v22, 0xff000000
    v_mov_b32 v23, 0xff000000
    v_mov_b32 v24, 0xff000000
    v_mov_b32 v25, 0xff000000
Lc_35:
    s_waitcnt lgkmcnt(0)
    s_nop 0
    v_mfma_f32_32x32x16_bf16 v[48:63], v[36:39], v[96:99], v[10:25]
    ds_read_b128 v[40:43], v102 offset:2048
    v_max3_f32 v26, v64, v65, v26
    v_max3_f32 v26, v66, v67, v26
    v_max3_f32 v26, v68, v69, v26
    v_max3_f32 v26, v70, v71, v26
    v_max3_f32 v26, v72, v73, v26
    v_max3_f32 v26, v74, v75, v26
    v_max3_f32 v26, v76, v77, v26
    v_max3_f32 v26, v78, v79, v26
    s_cmp_lg_u32 s19, 5
    s_cbranch_scc1 Lc_36
    v_mov_b32 v10, 0xff000000
    v_mov_b32 v11, 0xff000000
    v_mov_b32 v12, 0xff000000
    v_mov_b32 v13, 0xff000000
    v_mov_b32 v14, 0xff000000
    v_mov_b32 v15, 0xff000000
    v_mov_b32 v16, 0xff000000
    v_mov_b32 v17, 0xff000000
    v_mov_b32 v18, 0xff000000
    v_mov_b32 v19, 0xff000000
    v_mov_b32 v20, 0xff000000
    v_mov_b32 v21, 0xff000000
    v_mov_b32 v22, 0xff000000
    v_mov_b32 v23, 0xff000000
    v_mov_b32 v24, 0xff000000
    v_mov_b32 v25, 0xff000000
Lc_36:
    s_waitcnt lgkmcnt(0)
    s_nop 0
    v_mfma_f32_32x32x16_bf16 v[64:79], v[40:43], v[96:99], v[10:25]
    ds_read_b128 v[36:39], v102 offset:1024
    v_max3_f32 v26, v48, v49, v26
    v_max3_f32 v26, v50, v51, v26
    v_max3_f32 v26, v52, v53, v26
    v_max3_f32 v26, v54, v55, v26
    v_max3_f32 v26, v56, v57, v26
    v_max3_f32 v26, v58, v59, v26
    v_max3_f32 v26, v60, v61, v26
    v_max3_f32 v26, v62, v63, v26
    s_cmp_lg_u32 s19, 6
    s_cbranch_scc1 Lc_37
    v_mov_b32 v10, 0xff000000
    v_mov_b32 v11, 0xff000000
    v_mov_b32 v12, 0xff000000
    v_mov_b32 v13, 0xff000000
    v_mov_b32 v14, 0xff000000
    v_mov_b32 v15, 0xff000000
    v_mov_b32 v16, 0xff000000
    v_mov_b32 v17, 0xff000000
    v_mov_b32 v18, 0xff000000
    v_mov_b32 v19, 0xff000000
    v_mov_b32 v20, 0xff000000
    v_mov_b32 v21, 0xff000000
    v_mov_b32 v22, 0xff000000
    v_mov_b32 v23, 0xff000000
    v_mov_b32 v24, 0xff000000
    v_mov_b32 v25, 0xff000000
Lc_37:
    s_waitcnt lgkmcnt(0)
    s_nop 0
    v_mfma_f32_32x32x16_bf16 v[48:63], v[36:39], v[96:99], v[10:25]
    ds_read_b128 v[40:43], v102 offset:0
    v_max3_f32 v26, v64, v65, v26
    v_max3_f32 v26, v66, v67, v26
    v_max3_f32 v26, v68, v69, v26
    v_max3_f32 v26, v70, v71, v26
    v_max3_f32 v26, v72, v73, v26
    v_max3_f32 v26, v74, v75, v26
    v_max3_f32 v26, v76, v77, v26
    v_max3_f32 v26, v78, v79, v26
    s_cmp_lg_u32 s19, 7
    s_cbranch_scc1 Lc_38
    v_mov_b32 v10, 0xff000000
    v_mov_b32 v11, 0xff000000
    v_mov_b32 v12, 0xff000000
    v_mov_b32 v13, 0xff000000
    v_mov_b32 v14, 0xff000000
    v_mov_b32 v15, 0xff000000
    v_mov_b32 v16, 0xff000000
    v_mov_b32 v17, 0xff000000
    v_mov_b32 v18, 0xff000000
    v_mov_b32 v19, 0xff000000
    v_mov_b32 v20, 0xff000000
    v_mov_b32 v21, 0xff000000
    v_mov_b32 v22, 0xff000000
    v_mov_b32 v23, 0xff000000
    v_mov_b32 v24, 0xff000000
    v_mov_b32 v25, 0xff000000
Lc_38:
    s_waitcnt lgkmcnt(0)
    s_nop 0
    v_mfma_f32_32x32x16_bf16 v[64:79], v[40:43], v[96:99], v[10:25]
    ds_read_b128 v[36:39], v102 offset:8192
    v_max3_f32 v26, v48, v49, v26
    v_max3_f32 v26, v50, v51, v26
    v_max3_f32 v26, v52, v53, v26
    v_max3_f32 v26, v54, v55, v26
    v_max3_f32 v26, v56, v57, v26
    v_max3_f32 v26, v58, v59, v26
    v_max3_f32 v26, v60, v61, v26
    v_max3_f32 v26, v62, v63, v26
    s_cmp_ge_u32 s19, 8
    s_cbranch_scc1 Lc_39
    v_mov_b32 v10, 0
    v_mov_b32 v11, 0
    v_mov_b32 v12, 0
    v_mov_b32 v13, 0
    v_mov_b32 v14, 0
    v_mov_b32 v15, 0
    v_mov_b32 v16, 0
    v_mov_b32 v17, 0
    v_mov_b32 v18, 0
    v_mov_b32 v19, 0
    v_mov_b32 v20, 0
    v_mov_b32 v21, 0
    v_mov_b32 v22, 0
    v_mov_b32 v23, 0
    v_mov_b32 v24, 0
    v_mov_b32 v25, 0
Lc_39:
    s_waitcnt lgkmcnt(0)
    s_nop 0
    v_mfma_f32_32x32x16_bf16 v[48:63], v[36:39], v[96:99], v[10:25]
    s_nop 11
    v_cndmask_b32 v48, v64, v48, s[44:45]
    v_cndmask_b32 v49, v65, v49, s[46:47]
    v_cndmask_b32 v50, v66, v50, s[48:49]
    v_cndmask_b32 v51, v67, v51, s[50:51]
    v_cndmask_b32 v52, v68, v52, s[52:53]
    v_cndmask_b32 v53, v69, v53, s[54:55]
    v_cndmask_b32 v54, v70, v54, s[56:57]
    v_cndmask_b32 v55, v71, v55, s[58:59]
    v_cndmask_b32 v56, v72, v56, s[60:61]
    v_cndmask_b32 v57, v73, v57, s[62:63]
    v_cndmask_b32 v58, v74, v58, s[64:65]
    v_cndmask_b32 v59, v75, v59, s[66:67]
    v_cndmask_b32 v60, v76, v60, s[68:69]
    v_cndmask_b32 v61, v77, v61, s[70:71]
    v_cndmask_b32 v62, v78, v62, s[72:73]
    v_cndmask_b32 v63, v79, v63, s[74:75]
    ds_read_b128 v[36:39], v102 offset:7168
    ds_read_b128 v[40:43], v102 offset:6144
    v_max3_f32 v26, v48, v49, v26
    v_max3_f32 v26, v50, v51, v26
    v_max3_f32 v26, v52, v53, v26
    v_max3_f32 v26, v54, v55, v26
    v_max3_f32 v26, v56, v57, v26
    v_max3_f32 v26, v58, v59, v26
    v_max3_f32 v26, v60, v61, v26
    v_max3_f32 v26, v62, v63, v26
    v_mov_b32 v27, v26
    s_nop 1
    v_permlane32_swap_b32 v26, v27
    v_max_f32 v26, v26, v27
    v_sub_f32 v27, 0, v26
    v_sub_f32 v26, 0, v26
    v_mov_b64 v[10:11], v[26:27]
    v_mov_b64 v[12:13], v[26:27]
    v_mov_b64 v[14:15], v[26:27]
    v_mov_b64 v[16:17], v[26:27]
    v_mov_b64 v[18:19], v[26:27]
    v_mov_b64 v[20:21], v[26:27]
    v_mov_b64 v[22:23], v[26:27]
    v_mov_b64 v[24:25], v[26:27]
    s_mov_b64 exec, s[20:21]
    ds_read_b128 v[104:107], v103 offset:7168
    ds_read_b128 v[108:111], v103 offset:7680
    s_mov_b64 exec, -1
    s_cmp_lg_u32 s19, 0
    s_cbranch_scc1 Lc_40
    v_mov_b32 v10, 0xff000000
    v_mov_b32 v11, 0xff000000
    v_mov_b32 v12, 0xff000000
    v_mov_b32 v13, 0xff000000
    v_mov_b32 v14, 0xff000000
    v_mov_b32 v15, 0xff000000
    v_mov_b32 v16, 0xff000000
    v_mov_b32 v17, 0xff000000
    v_mov_b32 v18, 0xff000000
    v_mov_b32 v19, 0xff000000
    v_mov_b32 v20, 0xff000000
    v_mov_b32 v21, 0xff000000
    v_mov_b32 v22, 0xff000000
    v_mov_b32 v23, 0xff000000
    v_mov_b32 v24, 0xff000000
    v_mov_b32 v25, 0xff000000
Lc_40:
    s_waitcnt lgkmcnt(3)
    s_nop 0
    v_mfma_f32_32x32x16_bf16 v[48:63], v[36:39], v[96:99], v[10:25]
    s_cmp_lg_u32 s19, 1
    s_cbranch_scc1 Lc_41
    s_nop 4
    v_mov_b32 v10, 0xff000000
    v_mov_b32 v11, 0xff000000
    v_mov_b32 v12, 0xff000000
    v_mov_b32 v13, 0xff000000
    v_mov_b32 v14, 0xff000000
    v_mov_b32 v15, 0xff000000
    v_mov_b32 v16, 0xff000000
    v_mov_b32 v17, 0xff000000
    v_mov_b32 v18, 0xff000000
    v_mov_b32 v19, 0xff000000
    v_mov_b32 v20, 0xff000000
    v_mov_b32 v21, 0xff000000
    v_mov_b32 v22, 0xff000000
    v_mov_b32 v23, 0xff000000
    v_mov_b32 v24, 0xff000000
    v_mov_b32 v25, 0xff000000
Lc_41:
    s_waitcnt lgkmcnt(2)
    s_nop 0
    v_mfma_f32_32x32x16_bf16 v[64:79], v[40:43], v[96:99], v[10:25]
    ds_read_b128 v[36:39], v102 offset:5120
    s_mov_b64 exec, s[20:21]
    ds_read_b128 v[112:115], v103 offset:6144
    ds_read_b128 v[116:119], v103 offset:6656
    s_mov_b64 exec, -1
    s_nop 1
    v_exp_f32 v48, v48
    v_exp_f32 v49, v49
    v_exp_f32 v50, v50
    v_exp_f32 v51, v51
    v_exp_f32 v52, v52
    v_exp_f32 v53, v53
    v_exp_f32 v54, v54
    v_exp_f32 v55, v55
    v_cvt_pk_bf16_f32 v28, v48, v49
    v_cvt_pk_bf16_f32 v29, v50, v51
    v_cvt_pk_bf16_f32 v30, v52, v53
    v_cvt_pk_bf16_f32 v31, v54, v55
    s_waitcnt lgkmcnt(3)
    s_nop 0
    v_mfma_f32_32x32x16_bf16 v[128:143], v[104:107], v[28:31], 0
    v_exp_f32 v56, v56
    v_exp_f32 v57, v57
    v_exp_f32 v58, v58
    v_exp_f32 v59, v59
    v_exp_f32 v60, v60
    v_exp_f32 v61, v61
    v_exp_f32 v62, v62
    v_exp_f32 v63, v63
    v_cvt_pk_bf16_f32 v32, v56, v57
    v_cvt_pk_bf16_f32 v33, v58, v59
    v_cvt_pk_bf16_f32 v34, v60, v61
    v_cvt_pk_bf16_f32 v35, v62, v63
    s_nop 1
    v_mfma_f32_32x32x16_bf16 v[128:143], v[108:111], v[32:35], v[128:143]
    s_cmp_lg_u32 s19, 2
    s_cbranch_scc1 Lc_42
    v_mov_b32 v10, 0xff000000
    v_mov_b32 v11, 0xff000000
    v_mov_b32 v12, 0xff000000
    v_mov_b32 v13, 0xff000000
    v_mov_b32 v14, 0xff000000
    v_mov_b32 v15, 0xff000000
    v_mov_b32 v16, 0xff000000
    v_mov_b32 v17, 0xff000000
    v_mov_b32 v18, 0xff000000
    v_mov_b32 v19, 0xff000000
    v_mov_b32 v20, 0xff000000
    v_mov_b32 v21, 0xff000000
    v_mov_b32 v22, 0xff000000
    v_mov_b32 v23, 0xff000000
    v_mov_b32 v24, 0xff000000
    v_mov_b32 v25, 0xff000000
Lc_42:
    s_waitcnt lgkmcnt(2)
    s_nop 0
    v_mfma_f32_32x32x16_bf16 v[48:63], v[36:39], v[96:99], v[10:25]
    ds_read_b128 v[40:43], v102 offset:4096
    s_mov_b64 exec, s[20:21]
    ds_read_b128 v[104:107], v103 offset:5120
    ds_read_b128 v[108:111], v103 offset:5632
    s_mov_b64 exec, -1
    v_exp_f32 v64, v64
    v_exp_f32 v65, v65
    v_exp_f32 v66, v66
    v_exp_f32 v67, v67
    v_exp_f32 v68, v68
    v_exp_f32 v69, v69
    v_exp_f32 v70, v70
    v_exp_f32 v71, v71
    v_cvt_pk_bf16_f32 v28, v64, v65
    v_cvt_pk_bf16_f32 v29, v66, v67
    v_cvt_pk_bf16_f32 v30, v68, v69
    v_cvt_pk_bf16_f32 v31, v70, v71
    s_waitcnt lgkmcnt(3)
    s_nop 0
    v_mfma_f32_32x32x16_bf16 v[128:143], v[112:115], v[28:31], v[128:143]
    v_exp_f32 v72, v72
    v_exp_f32 v73, v73
    v_exp_f32 v74, v74
    v_exp_f32 v75, v75
    v_exp_f32 v76, v76
    v_exp_f32 v77, v77
    v_exp_f32 v78, v78
    v_exp_f32 v79, v79
    v_cvt_pk_bf16_f32 v32, v72, v73
    v_cvt_pk_bf16_f32 v33, v74, v75
    v_cvt_pk_bf16_f32 v34, v76, v77
    v_cvt_pk_bf16_f32 v35, v78, v79
    s_nop 1
    v_mfma_f32_32x32x16_bf16 v[128:143], v[116:119], v[32:35], v[128:143]
    s_cmp_lg_u32 s19, 3
    s_cbranch_scc1 Lc_43
    v_mov_b32 v10, 0xff000000
    v_mov_b32 v11, 0xff000000
    v_mov_b32 v12, 0xff000000
    v_mov_b32 v13, 0xff000000
    v_mov_b32 v14, 0xff000000
    v_mov_b32 v15, 0xff000000
    v_mov_b32 v16, 0xff000000
    v_mov_b32 v17, 0xff000000
    v_mov_b32 v18, 0xff000000
    v_mov_b32 v19, 0xff000000
    v_mov_b32 v20, 0xff000000
    v_mov_b32 v21, 0xff000000
    v_mov_b32 v22, 0xff000000
    v_mov_b32 v23, 0xff000000
    v_mov_b32 v24, 0xff000000
    v_mov_b32 v25, 0xff000000
Lc_43:
    s_waitcnt lgkmcnt(2)
    s_nop 0
    v_mfma_f32_32x32x16_bf16 v[64:79], v[40:43], v[96:99], v[10:25]
    ds_read_b128 v[36:39], v102 offset:3072
    s_mov_b64 exec, s[20:21]
    ds_read_b128 v[112:115], v103 offset:4096
    ds_read_b128 v[116:119], v103 offset:4608
    s_mov_b64 exec, -1
    v_exp_f32 v48, v48
    v_exp_f32 v49, v49
    v_exp_f32 v50, v50
    v_exp_f32 v51, v51
    v_exp_f32 v52, v52
    v_exp_f32 v53, v53
    v_exp_f32 v54, v54
    v_exp_f32 v55, v55
    v_cvt_pk_bf16_f32 v28, v48, v49
    v_cvt_pk_bf16_f32 v29, v50, v51
    v_cvt_pk_bf16_f32 v30, v52, v53
    v_cvt_pk_bf16_f32 v31, v54, v55
    s_waitcnt lgkmcnt(3)
    s_nop 0
    v_mfma_f32_32x32x16_bf16 v[128:143], v[104:107], v[28:31], v[128:143]
    v_exp_f32 v56, v56
    v_exp_f32 v57, v57
    v_exp_f32 v58, v58
    v_exp_f32 v59, v59
    v_exp_f32 v60, v60
    v_exp_f32 v61, v61
    v_exp_f32 v62, v62
    v_exp_f32 v63, v63
    v_cvt_pk_bf16_f32 v32, v56, v57
    v_cvt_pk_bf16_f32 v33, v58, v59
    v_cvt_pk_bf16_f32 v34, v60, v61
    v_cvt_pk_bf16_f32 v35, v62, v63
    s_nop 1
    v_mfma_f32_32x32x16_bf16 v[128:143], v[108:111], v[32:35], v[128:143]
    s_cmp_lg_u32 s19, 4
    s_cbranch_scc1 Lc_44
    v_mov_b32 v10, 0xff000000
    v_mov_b32 v11, 0xff000000
    v_mov_b32 v12, 0xff000000
    v_mov_b32 v13, 0xff000000
    v_mov_b32 v14, 0xff000000
    v_mov_b32 v15, 0xff000000
    v_mov_b32 v16, 0xff000000
    v_mov_b32 v17, 0xff000000
    v_mov_b32 v18, 0xff000000
    v_mov_b32 v19, 0xff000000
    v_mov_b32 v20, 0xff000000
    v_mov_b32 v21, 0xff000000
    v_mov_b32 v22, 0xff000000
    v_mov_b32 v23, 0xff000000
    v_mov_b32 v24, 0xff000000
    v_mov_b32 v25, 0xff000000
Lc_44:
    s_waitcnt lgkmcnt(2)
    s_nop 0
    v_mfma_f32_32x32x16_bf16 v[48:63], v[36:39], v[96:99], v[10:25]
    ds_read_b128 v[40:43], v102 offset:2048
    s_mov_b64 exec, s[20:21]
    ds_read_b128 v[104:107], v103 offset:3072
    ds_read_b128 v[108:111], v103 offset:3584
    s_mov_b64 exec, -1
    v_exp_f32 v64, v64
    v_exp_f32 v65, v65
    v_exp_f32 v66, v66
    v_exp_f32 v67, v67
    v_exp_f32 v68, v68
    v_exp_f32 v69, v69
    v_exp_f32 v70, v70
    v_exp_f32 v71, v71
    v_cvt_pk_bf16_f32 v28, v64, v65
    v_cvt_pk_bf16_f32 v29, v66, v67
    v_cvt_pk_bf16_f32 v30, v68, v69
    v_cvt_pk_bf16_f32 v31, v70, v71
    s_waitcnt lgkmcnt(3)
    s_nop 0
    v_mfma_f32_32x32x16_bf16 v[128:143], v[112:115], v[28:31], v[128:143]
    v_exp_f32 v72, v72
    v_exp_f32 v73, v73
    v_exp_f32 v74, v74
    v_exp_f32 v75, v75
    v_exp_f32 v76, v76
    v_exp_f32 v77, v77
    v_exp_f32 v78, v78
    v_exp_f32 v79, v79
    v_cvt_pk_bf16_f32 v32, v72, v73
    v_cvt_pk_bf16_f32 v33, v74, v75
    v_cvt_pk_bf16_f32 v34, v76, v77
    v_cvt_pk_bf16_f32 v35, v78, v79
    s_nop 1
    v_mfma_f32_32x32x16_bf16 v[128:143], v[116:119], v[32:35], v[128:143]
    s_cmp_lg_u32 s19, 5
    s_cbranch_scc1 Lc_45
    v_mov_b32 v10, 0xff000000
    v_mov_b32 v11, 0xff000000
    v_mov_b32 v12, 0xff000000
    v_mov_b32 v13, 0xff000000
    v_mov_b32 v14, 0xff000000
    v_mov_b32 v15, 0xff000000
    v_mov_b32 v16, 0xff000000
    v_mov_b32 v17, 0xff000000
    v_mov_b32 v18, 0xff000000
    v_mov_b32 v19, 0xff000000
    v_mov_b32 v20, 0xff000000
    v_mov_b32 v21, 0xff000000
    v_mov_b32 v22, 0xff000000
    v_mov_b32 v23, 0xff000000
    v_mov_b32 v24, 0xff000000
    v_mov_b32 v25, 0xff000000
Lc_45:
    s_waitcnt lgkmcnt(2)
    s_nop 0
    v_mfma_f32_32x32x16_bf16 v[64:79], v[40:43], v[96:99], v[10:25]
    ds_read_b128 v[36:39], v102 offset:1024
    s_mov_b64 exec, s[20:21]
    ds_read_b128 v[112:115], v103 offset:2048
    ds_read_b128 v[116:119], v103 offset:2560
    s_mov_b64 exec, -1
    v_exp_f32 v48, v48
    v_exp_f32 v49, v49
    v_exp_f32 v50, v50
    v_exp_f32 v51, v51
    v_exp_f32 v52, v52
    v_exp_f32 v53, v53
    v_exp_f32 v54, v54
    v_exp_f32 v55, v55
    v_cvt_pk_bf16_f32 v28, v48, v49
    v_cvt_pk_bf16_f32 v29, v50, v51
    v_cvt_pk_bf16_f32 v30, v52, v53
    v_cvt_pk_bf16_f32 v31, v54, v55
    s_waitcnt lgkmcnt(3)
    s_nop 0
    v_mfma_f32_32x32x16_bf16 v[128:143], v[104:107], v[28:31], v[128:143]
    v_exp_f32 v56, v56
    v_exp_f32 v57, v57
    v_exp_f32 v58, v58
    v_exp_f32 v59, v59
    v_exp_f32 v60, v60
    v_exp_f32 v61, v61
    v_exp_f32 v62, v62
    v_exp_f32 v63, v63
    v_cvt_pk_bf16_f32 v32, v56, v57
    v_cvt_pk_bf16_f32 v33, v58, v59
    v_cvt_pk_bf16_f32 v34, v60, v61
    v_cvt_pk_bf16_f32 v35, v62, v63
    s_nop 1
    v_mfma_f32_32x32x16_bf16 v[128:143], v[108:111], v[32:35], v[128:143]
    s_cmp_lg_u32 s19, 6
    s_cbranch_scc1 Lc_46
    v_mov_b32 v10, 0xff000000
    v_mov_b32 v11, 0xff000000
    v_mov_b32 v12, 0xff000000
    v_mov_b32 v13, 0xff000000
    v_mov_b32 v14, 0xff000000
    v_mov_b32 v15, 0xff000000
    v_mov_b32 v16, 0xff000000
    v_mov_b32 v17, 0xff000000
    v_mov_b32 v18, 0xff000000
    v_mov_b32 v19, 0xff000000
    v_mov_b32 v20, 0xff000000
    v_mov_b32 v21, 0xff000000
    v_mov_b32 v22, 0xff000000
    v_mov_b32 v23, 0xff000000
    v_mov_b32 v24, 0xff000000
    v_mov_b32 v25, 0xff000000
Lc_46:
    s_waitcnt lgkmcnt(2)
    s_nop 0
    v_mfma_f32_32x32x16_bf16 v[48:63], v[36:39], v[96:99], v[10:25]
    ds_read_b128 v[40:43], v102 offset:0
    s_mov_b64 exec, s[20:21]
    ds_read_b128 v[104:107], v103 offset:1024
    ds_read_b128 v[108:111], v103 offset:1536
    s_mov_b64 exec, -1
    v_exp_f32 v64, v64
    v_exp_f32 v65, v65
    v_exp_f32 v66, v66
    v_exp_f32 v67, v67
    v_exp_f32 v68, v68
    v_exp_f32 v69, v69
    v_exp_f32 v70, v70
    v_exp_f32 v71, v71
    v_cvt_pk_bf16_f32 v28, v64, v65
    v_cvt_pk_bf16_f32 v29, v66, v67
    v_cvt_pk_bf16_f32 v30, v68, v69
    v_cvt_pk_bf16_f32 v31, v70, v71
    s_waitcnt lgkmcnt(3)
    s_nop 0
    v_mfma_f32_32x32x16_bf16 v[128:143], v[112:115], v[28:31], v[128:143]
    v_exp_f32 v72, v72
    v_exp_f32 v73, v73
    v_exp_f32 v74, v74
    v_exp_f32 v75, v75
    v_exp_f32 v76, v76
    v_exp_f32 v77, v77
    v_exp_f32 v78, v78
    v_exp_f32 v79, v79
    v_cvt_pk_bf16_f32 v32, v72, v73
    v_cvt_pk_bf16_f32 v33, v74, v75
    v_cvt_pk_bf16_f32 v34, v76, v77
    v_cvt_pk_bf16_f32 v35, v78, v79
    s_nop 1
    v_mfma_f32_32x32x16_bf16 v[128:143], v[116:119], v[32:35], v[128:143]
    s_cmp_lg_u32 s19, 7
    s_cbranch_scc1 Lc_47
    v_mov_b32 v10, 0xff000000
    v_mov_b32 v11, 0xff000000
    v_mov_b32 v12, 0xff000000
    v_mov_b32 v13, 0xff000000
    v_mov_b32 v14, 0xff000000
    v_mov_b32 v15, 0xff000000
    v_mov_b32 v16, 0xff000000
    v_mov_b32 v17, 0xff000000
    v_mov_b32 v18, 0xff000000
    v_mov_b32 v19, 0xff000000
    v_mov_b32 v20, 0xff000000
    v_mov_b32 v21, 0xff000000
    v_mov_b32 v22, 0xff000000
    v_mov_b32 v23, 0xff000000
    v_mov_b32 v24, 0xff000000
    v_mov_b32 v25, 0xff000000
Lc_47:
    s_waitcnt lgkmcnt(2)
    s_nop 0
    v_mfma_f32_32x32x16_bf16 v[64:79], v[40:43], v[96:99], v[10:25]
    ds_read_b128 v[36:39], v102 offset:8192
    s_mov_b64 exec, s[20:21]
    ds_read_b128 v[112:115], v103 offset:0
    ds_read_b128 v[116:119], v103 offset:512
    s_mov_b64 exec, -1
    v_exp_f32 v48, v48
    v_exp_f32 v49, v49
    v_exp_f32 v50, v50
    v_exp_f32 v51, v51
    v_exp_f32 v52, v52
    v_exp_f32 v53, v53
    v_exp_f32 v54, v54
    v_exp_f32 v55, v55
    v_cvt_pk_bf16_f32 v28, v48, v49
    v_cvt_pk_bf16_f32 v29, v50, v51
    v_cvt_pk_bf16_f32 v30, v52, v53
    v_cvt_pk_bf16_f32 v31, v54, v55
    s_waitcnt lgkmcnt(3)
    s_nop 0
    v_mfma_f32_32x32x16_bf16 v[128:143], v[104:107], v[28:31], v[128:143]
    v_exp_f32 v56, v56
    v_exp_f32 v57, v57
    v_exp_f32 v58, v58
    v_exp_f32 v59, v59
    v_exp_f32 v60, v60
    v_exp_f32 v61, v61
    v_exp_f32 v62, v62
    v_exp_f32 v63, v63
    v_cvt_pk_bf16_f32 v32, v56, v57
    v_cvt_pk_bf16_f32 v33, v58, v59
    v_cvt_pk_bf16_f32 v34, v60, v61
    v_cvt_pk_bf16_f32 v35, v62, v63
    s_nop 1
    v_mfma_f32_32x32x16_bf16 v[128:143], v[108:111], v[32:35], v[128:143]
    s_cmp_ge_u32 s19, 8
    s_cbranch_scc1 Lc_48
    v_mov_b32 v10, v26
    v_mov_b32 v11, v26
    v_mov_b32 v12, v26
    v_mov_b32 v13, v26
    v_mov_b32 v14, v26
    v_mov_b32 v15, v26
    v_mov_b32 v16, v26
    v_mov_b32 v17, v26
    v_mov_b32 v18, v26
    v_mov_b32 v19, v26
    v_mov_b32 v20, v26
    v_mov_b32 v21, v26
    v_mov_b32 v22, v26
    v_mov_b32 v23, v26
    v_mov_b32 v24, v26
    v_mov_b32 v25, v26
Lc_48:
    s_waitcnt lgkmcnt(2)
    s_nop 0
    v_mfma_f32_32x32x16_bf16 v[48:63], v[36:39], v[96:99], v[10:25]
    s_mov_b64 exec, s[20:21]
    ds_read_b128 v[104:107], v103 offset:8192
    ds_read_b128 v[108:111], v103 offset:8704
    s_mov_b64 exec, -1
    s_nop 7
    v_cndmask_b32 v48, v64, v48, s[44:45]
    v_cndmask_b32 v49, v65, v49, s[46:47]
    v_cndmask_b32 v50, v66, v50, s[48:49]
    v_cndmask_b32 v51, v67, v51, s[50:51]
    v_cndmask_b32 v52, v68, v52, s[52:53]
    v_cndmask_b32 v53, v69, v53, s[54:55]
    v_cndmask_b32 v54, v70, v54, s[56:57]
    v_cndmask_b32 v55, v71, v55, s[58:59]
    v_cndmask_b32 v56, v72, v56, s[60:61]
    v_cndmask_b32 v57, v73, v57, s[62:63]
    v_cndmask_b32 v58, v74, v58, s[64:65]
    v_cndmask_b32 v59, v75, v59, s[66:67]
    v_cndmask_b32 v60, v76, v60, s[68:69]
    v_cndmask_b32 v61, v77, v61, s[70:71]
    v_cndmask_b32 v62, v78, v62, s[72:73]
    v_cndmask_b32 v63, v79, v63, s[74:75]
    v_exp_f32 v48, v48
    v_exp_f32 v49, v49
    v_exp_f32 v50, v50
    v_exp_f32 v51, v51
    v_exp_f32 v52, v52
    v_exp_f32 v53, v53
    v_exp_f32 v54, v54
    v_exp_f32 v55, v55
    v_cvt_pk_bf16_f32 v28, v48, v49
    v_cvt_pk_bf16_f32 v29, v50, v51
    v_cvt_pk_bf16_f32 v30, v52, v53
    v_cvt_pk_bf16_f32 v31, v54, v55
    v_bfi_b32 v88, v120, 0, v28
    v_and_b32 v80, v120, v28
    v_bfi_b32 v89, v121, 0, v29
    v_and_b32 v81, v121, v29
    v_bfi_b32 v90, v122, 0, v30
    v_and_b32 v82, v122, v30
    v_bfi_b32 v91, v123, 0, v31
    v_and_b32 v83, v123, v31
    s_waitcnt lgkmcnt(2)
    v_mfma_f32_32x32x16_bf16 v[128:143], v[112:115], v[88:91], v[128:143]
    s_waitcnt lgkmcnt(0)
    v_mfma_f32_32x32x16_bf16 v[128:143], v[104:107], v[80:83], v[128:143]
    v_exp_f32 v56, v56
    v_exp_f32 v57, v57
    v_exp_f32 v58, v58
    v_exp_f32 v59, v59
    v_exp_f32 v60, v60
    v_exp_f32 v61, v61
    v_exp_f32 v62, v62
    v_exp_f32 v63, v63
    v_cvt_pk_bf16_f32 v32, v56, v57
    v_cvt_pk_bf16_f32 v33, v58, v59
    v_cvt_pk_bf16_f32 v34, v60, v61
    v_cvt_pk_bf16_f32 v35, v62, v63
    v_bfi_b32 v92, v124, 0, v32
    v_and_b32 v84, v124, v32
    v_bfi_b32 v93, v125, 0, v33
    v_and_b32 v85, v125, v33
    v_bfi_b32 v94, v126, 0, v34
    v_and_b32 v86, v126, v34
    v_bfi_b32 v95, v127, 0, v35
    v_and_b32 v87, v127, v35
    s_nop 0
    v_mfma_f32_32x32x16_bf16 v[128:143], v[116:119], v[92:95], v[128:143]
    v_mfma_f32_32x32x16_bf16 v[128:143], v[108:111], v[84:87], v[128:143]
    v_lshrrev_b32 v17, 2, v0
    v_and_b32 v16, 6, v17
    v_and_b32 v18, 3, v0
    v_lshl_add_u32 v16, v16, 1, v18
    v_lshlrev_b32 v16, 3, v16
    s_and_b32 s7, s4, 2
    s_lshl_b32 s7, s7, 5
    v_xor_b32 v16, s7, v16
    v_lshl_add_u32 v10, v17, 7, v16
    s_and_b32 s7, s6, 0xe000
    s_add_u32 s7, s7, 65536
    v_add_u32 v10, s7, v10
    v_xor_b32 v11, 32, v10
    v_xor_b32 v12, 64, v10
    v_xor_b32 v13, 96, v10
    v_lshrrev_b32 v14, 5, v0
    v_lshlrev_b32 v14, 10, v14
    v_subrev_u32 v14, 65536, v14
    s_mov_b32 s44, 262144
    s_mov_b32 s45, 327680
    s_mov_b32 s46, 393216
    s_mov_b32 s47, 0
    s_mov_b32 s48, 65536
    s_branch L_fb_back
.section .rodata,"a"
.p2align 6
.amdhsa_kernel recurrent_scan__sliding_block__glu_gated_bilinear__prompt_kernel
  .amdhsa_next_free_vgpr 256
  .amdhsa_next_free_sgpr 102
  .amdhsa_accum_offset 256
  .amdhsa_group_segment_fixed_size 0
  .amdhsa_kernarg_size 80
  .amdhsa_user_sgpr_count 2
  .amdhsa_user_sgpr_kernarg_segment_ptr 1
  .amdhsa_system_sgpr_workgroup_id_x 1
  .amdhsa_float_denorm_mode_32 3
.end_amdhsa_kernel
```
